```python
import torch

def _softmax(x, axis=-1):
    return torch.softmax(x, dim=axis)
def _gelu(x):
    return torch.nn.functional.gelu(x, approximate="tanh")
def _silu(x):
    return torch.nn.functional.silu(x)
def _sigmoid(x):
    return torch.sigmoid(x)
def _layernorm(x, axis=-1, eps=1e-5):
    m = x.mean(dim=axis, keepdim=True)
    v = x.var(dim=axis, keepdim=True, unbiased=False)
    return (x - m) / torch.sqrt(v + eps)
def _scatter_add(tgt, idx, src, axis=0):
    return tgt.clone().index_add_(axis, idx, src)
def _segment_sum(src, seg, n):
    out = torch.zeros((n,) + src.shape[1:], dtype=src.dtype)
    return out.index_add_(0, seg, src)
def _pad(x, pw):
    flat = tuple(v for pair in reversed(pw) for v in pair)
    return torch.nn.functional.pad(x, flat)

kernel_name = 'gated_mix__ssm_conv_h3__mixer_token_mlp__prompt'

def setup_inputs():

    _w = (lambda a: (lambda t: t.to(torch.bfloat16) if t.is_floating_point() else t)(torch.as_tensor(a)))
    def _A_setup():
        B, S, D = 1, 2048, 640
        ks = 4
        return {
            "q": _w((lambda *s: torch.randn(*s, dtype=torch.bfloat16) * 0.05)(B, S, D)),
            "k": _w((lambda *s: torch.randn(*s, dtype=torch.bfloat16) * 0.4)(B, S, D)),
            "v": _w((lambda *s: torch.randn(*s, dtype=torch.bfloat16) * 0.2)(B, S, D)),
            "shift_k": _w((lambda *s: torch.randn(*s, dtype=torch.bfloat16) * 0.4)(D, ks) * 0.5),
            "ssm_k": _w((lambda *s: torch.randn(*s, dtype=torch.bfloat16) * 0.8)(D, S) * (1.0 / S ** 0.5)),
            "ssm_D": _w((lambda *s: torch.randn(*s, dtype=torch.bfloat16) * 0.2)(D)),
        }
    _A_in = _A_setup()

    def _B_setup():
        B, S, D, F = 1, 2048, 640, 1536
        return {
            "x": _w((lambda *s: torch.randn(*s, dtype=torch.bfloat16) * 0.05)(B, S, D)),
            "w1": _w((lambda *s: torch.randn(*s, dtype=torch.bfloat16) * 0.2)(S, F) * (S ** -0.5)),
            "b1": _w((lambda *s: torch.randn(*s, dtype=torch.bfloat16) * 3.2)(F) * 0.02),
            "w2": _w((lambda *s: torch.randn(*s, dtype=torch.bfloat16) * 0.05)(F, S) * (F ** -0.5)),
            "b2": _w((lambda *s: torch.randn(*s, dtype=torch.bfloat16) * 0.1)(S) * 0.02),
        }
    _B_in = _B_setup()

    return {
        "A_q": _A_in["q"],
        "A_k": _A_in["k"],
        "A_v": _A_in["v"],
        "A_shift_k": _A_in["shift_k"],
        "A_ssm_k": _A_in["ssm_k"],
        "A_ssm_D": _A_in["ssm_D"],
        "B_x": _B_in["x"],
        "B_w1": _B_in["w1"],
        "B_b1": _B_in["b1"],
        "B_w2": _B_in["w2"],
        "B_b2": _B_in["b2"],
        "gate_w": _w((lambda *s: torch.randn(*s, dtype=torch.bfloat16) * 0.05)(640) * 16.0),
    }

def reference(A_q, A_k, A_v, A_shift_k, A_ssm_k, A_ssm_D, B_x, B_w1, B_b1, B_w2, B_b2, gate_w):
    def _A_ref(q, k, v, shift_k, ssm_k, ssm_D):
        B, S, D = q.shape
        ks = shift_k.shape[-1]
        k_pad = _pad(k, ((0, 0), (ks - 1, 0), (0, 0)))
        k_shift = torch.zeros_like(k)
        for t in range(ks):
            k_shift = k_shift + k_pad[:, t:t + S, :] * shift_k[:, ks - 1 - t][None, None, :]
        kv = k_shift * v
        L = 2 * S
        kv_pad = _pad(kv, ((0, 0), (0, S), (0, 0)))
        kf_pad = _pad(ssm_k, ((0, 0), (0, S)))
        kv_f = (lambda x, axes=(-2,-1): torch.fft.rfft2(x.float(), dim=axes))(kv_pad[:, None, :, :], axes=(1, 2))
        kf_f = (lambda x, axes=(-2,-1): torch.fft.rfft2(x.float(), dim=axes))(kf_pad[:, None, :], axes=(1, 2))
        kf_f = (lambda x, *d: x.permute(*d))(kf_f, 1, 2, 0)
        y_f = kv_f * kf_f[None, :, :, :]
        y = (lambda x, s, axes=(-2,-1): torch.fft.irfft2(x, s=s, dim=axes).to(torch.bfloat16))(y_f, (1, L), axes=(1, 2))[:, 0, :S, :]
        y = y + kv * ssm_D[None, None, :]
        return q * y

    def _B_ref(x, w1, b1, w2, b2):
        B, S, D = x.shape
        h = _layernorm(x, axis=-1)
        u = torch.einsum("bsd,sf->bdf", h, w1) + b1
        u = _gelu(u)
        y = torch.einsum("bdf,fs->bds", u, w2) + b2
        return (lambda x, *d: x.permute(*d))(y, 0, 2, 1)

    x = A_q
    g = _sigmoid((x * gate_w).sum(-1, keepdims=True))
    a = _A_ref(x, A_k, A_v, A_shift_k, A_ssm_k, A_ssm_D)
    b = _B_ref(x, B_w1, B_b1, B_w2, B_b2)
    return g * a + (1 - g) * b
```

```asm
; @launch grid=(256,1,1) block=(256,1,1) lds=155072
.amdgcn_target "amdgcn-amd-amdhsa--gfx950"
.text
.globl gated_mix__ssm_conv_h3__mixer_token_mlp__prompt_kernel
.p2align 8
.type gated_mix__ssm_conv_h3__mixer_token_mlp__prompt_kernel,@function
gated_mix__ssm_conv_h3__mixer_token_mlp__prompt_kernel:
    s_load_dwordx16 s[36:51], s[0:1], 0
    s_load_dwordx16 s[52:67], s[0:1], 56
    s_cmp_ge_u32 s2, 256
    s_cbranch_scc1 L_end
    v_lshrrev_b32 v1, 6, v0
    v_and_b32 v0, 63, v0
    v_readfirstlane_b32 s84, v1
    s_lshr_b32 s86, s2, 3
    s_bfe_u32 s85, s2, 0x20001
    s_lshl_b32 s89, s85, 5
    s_add_u32 s89, s89, s86
    s_bitcmp0_b32 s2, 0
    s_cselect_b32 s33, L_Amain-L_pcC, 0
    s_getpc_b64 s[22:23]
L_pcC:
    s_lshl2_add_u32 s34, s86, s84
    v_lshl_add_u32 v42, s34, 1, v0
    v_lshlrev_b32 v42, 7, v42
    v_add_u32 v42, s33, v42
    v_min_u32 v42, L_end-L_pcC, v42
    v_mov_b32 v43, s23
    v_add_co_u32 v42, vcc, s22, v42
    s_mov_b64 exec, 3
    s_nop 0
    v_addc_co_u32 v43, vcc, 0, v43, vcc
    global_load_dword v253, v[42:43], off
    s_mov_b64 exec, -1
    s_mul_i32 s32, s86, 52
    s_lshr_b32 s32, s32, 8
    s_mul_i32 s33, s32, 5
    s_sub_u32 s87, s86, s33
    s_min_u32 s32, s32, 5
    s_mul_i32 s88, s85, 6
    s_add_u32 s88, s88, s32
    s_lshl4_add_u32 s33, s87, s84
    s_mul_i32 s33, s33, 205
    s_lshr_b32 s33, s33, 10
    s_lshl_b32 s68, s33, 10
    s_add_u32 s33, s68, 1024
    s_and_b32 s69, s33, 0x3c00
    s_lshl_b32 s92, s84, 12
    s_mul_i32 s32, s84, 1572864
    s_lshl_b32 s33, s88, 7
    s_add_u32 s32, s32, s33
    v_lshrrev_b32 v42, 3, v0
    v_and_b32 v43, 6, v42
    v_xor_b32 v43, v43, v0
    v_and_b32 v43, 7, v43
    v_mul_u32_u24 v42, 3072, v42
    v_lshl_add_u32 v42, v43, 4, v42
    v_add_u32 v2, s32, v42
    v_add_u32 v3, 23552, v2
    v_add_u32 v4, 23552, v3
    v_add_u32 v5, 23552, v4
    s_mov_b32 s18, 6291456
    s_mov_b32 s19, 0x20000
L_B:
    v_lshlrev_b32 v1, 4, v0
    v_lshrrev_b32 v37, 4, v0
    v_and_b32 v38, 15, v0
    v_bfe_u32 v39, v0, 2, 2
    v_and_b32 v40, 3, v0
    s_lshr_b32 s34, s84, 1
    s_and_b32 s35, s84, 1
    s_lshl_b32 s92, s84, 12
    s_lshr_b32 s32, s89, 1
    s_lshl_b32 s32, s32, 5
    s_and_b32 s33, s89, 1
    s_lshl3_add_u32 s3, s33, s32
    s_lshl2_add_u32 s3, s34, s3
    s_lshl4_add_u32 s3, s35, s3
    v_add_u32 v200, s3, v37
    v_mul_u32_u24 v200, 1280, v200
    v_lshlrev_b32 v201, 4, v38
    v_add_u32 v200, v200, v201
    s_waitcnt lgkmcnt(0)
    s_bitcmp1_b32 s2, 0
    s_cbranch_scc1 L_Bgo
    s_cmp_ge_u32 s86, 30
    s_cselect_b32 s90, 2130706432, 0
    s_waitcnt lgkmcnt(0)
    s_mov_b64 s[16:17], s[50:51]
    s_cbranch_scc1 L_Amain
    s_mul_i32 s21, s68, 96
    s_add_u32 m0, s92, 0
    s_nop 0
    buffer_load_dwordx4 v2, s[16:19], s21 offen offset:0  lds
    buffer_load_dwordx4 v3, s[16:19], s21 offen offset:1024  lds
    buffer_load_dwordx4 v4, s[16:19], s21 offen offset:2048  lds
    buffer_load_dwordx4 v5, s[16:19], s21 offen offset:3072  lds
    s_mul_i32 s21, s69, 96
    s_add_u32 m0, s92, 16384
    s_nop 0
    buffer_load_dwordx4 v2, s[16:19], s21 offen offset:0  lds
    buffer_load_dwordx4 v3, s[16:19], s21 offen offset:1024  lds
    buffer_load_dwordx4 v4, s[16:19], s21 offen offset:2048  lds
    buffer_load_dwordx4 v5, s[16:19], s21 offen offset:3072  lds
    s_branch L_Amain
L_Bgo:
    s_waitcnt lgkmcnt(0)
    global_load_dwordx4 v[160:163], v200, s[36:37] offset:0
    global_load_dwordx4 v[164:167], v200, s[36:37] offset:256
    global_load_dwordx4 v[168:171], v200, s[36:37] offset:512
    global_load_dwordx4 v[172:175], v200, s[36:37] offset:768
    global_load_dwordx4 v[176:179], v200, s[36:37] offset:1024
    s_lshl3_add_u32 s20, s84, s32
    s_mul_i32 s20, s20, 1280
    s_mul_i32 s21, s33, 640
    s_add_u32 s20, s20, s21
    v_add_u32 v60, s20, v1
    s_mul_i32 s20, s84, 4294958336
    s_sub_u32 s20, s20, 5120
    v_add_u32 v61, s20, v60
    s_mul_i32 s94, s84, 5664
    s_mov_b32 s10, 2621440
    s_mov_b32 s11, 0x20000
    s_mov_b32 s14, 2621440
    s_mov_b32 s15, 0x20000
    s_mov_b32 s6, 14680064
    s_mov_b32 s7, 0x20000
    s_mov_b32 s18, 6291456
    s_mov_b32 s19, 0x20000
    s_mov_b32 s26, 2621440
    s_mov_b32 s27, 0x20000
    s_lshl2_add_u32 s20, s33, s84
    s_mul_i32 s20, s20, 80
    v_add_u32 v62, s20, v38
    v_lshlrev_b32 v63, 3, v62
    s_mov_b64 s[8:9], s[38:39]
    s_mov_b64 s[12:13], s[40:41]
    s_mov_b64 s[16:17], s[56:57]
    s_mov_b64 s[24:25], s[44:45]
    s_add_u32 s4, s66, 0
    s_addc_u32 s5, s67, 0
    s_lshl1_add_u32 s32, s89, s35
    s_lshl_b32 s32, s32, 8
    s_mul_i32 s33, s34, 65792
    s_add_u32 s32, s32, s33
    v_mul_u32_u24 v48, 328960, v37
    v_lshl_add_u32 v48, v38, 4, v48
    v_add_u32 v48, s32, v48
    s_mul_i32 s52, s34, 1250048
    s_add_u32 s52, s52, 263168
    s_mov_b32 s53, 1315840
    s_mov_b32 s64, 1447424
    s_mov_b32 s51, 131584
    s_mov_b32 s32, 10223616
    s_mov_b64 exec, 1
    buffer_load_dword v202, v0, s[4:7], s32 offen sc1
    s_mov_b64 exec, -1
    s_and_b32 s87, s86, 3
    s_lshr_b32 s32, s86, 2
    s_lshl3_add_u32 s88, s85, s32
    v_lshl_add_u32 v42, s84, 2, v37
    s_lshl_b32 s32, s89, 4
    v_add_lshl_u32 v49, s32, v42, 2
    v_add_u32 v49, 9961472, v49
    v_mul_u32_u24 v42, 1344, v42
    v_add_u32 v42, 32768, v42
    v_add_u32 v44, v42, v201
    v_mul_u32_u24 v42, 1344, v39
    s_mul_i32 s32, s35, 10752
    s_lshl3_add_u32 s32, s34, s32
    s_add_u32 s32, s32, 32768
    v_lshl_add_u32 v43, v40, 4, s32
    v_add_u32 v42, v42, v43
    v_lshl_add_u32 v46, v37, 8, v42
    v_lshl_add_u32 v47, v37, 6, v42
    v_mul_u32_u24 v42, 5664, v37
    v_mul_u32_u24 v43, 704, v39
    s_mul_i32 s32, s84, 160
    s_add_u32 s32, s32, 65536
    v_add3_u32 v42, v42, v43, s32
    v_lshl_add_u32 v50, v40, 3, v42
    v_sub_u32 v42, v62, v38
    v_lshrrev_b32 v43, 2, v0
    v_add_u32 v42, v42, v43
    v_mul_u32_u24 v51, 4224, v42
    v_lshrrev_b32 v42, 3, v0
    v_xor_b32 v42, v42, v0
    v_and_b32 v42, 3, v42
    v_lshl_add_u32 v51, v42, 4, v51
    v_bfe_u32 v42, v0, 1, 2
    v_xor_b32 v42, v42, v37
    v_lshlrev_b32 v42, 4, v42
    v_lshl_add_u32 v45, v38, 6, v42
    s_mul_i32 s32, s84, 5120
    s_add_u32 s32, s32, 32768
    v_add_u32 v52, s32, v45
    v_add_u32 v53, s32, v1
    s_lshr_b32 s32, s89, 1
    s_lshl_b32 s33, s32, 6
    s_add_u32 s33, s33, 4980736
    v_add_u32 v51, s33, v51
    s_and_b32 s33, s89, 1
    s_lshl_b32 s33, s33, 6
    s_add_u32 s95, s32, s33
    s_mul_i32 s95, s95, 64
    s_lshl2_add_u32 s95, s84, s95
    s_add_u32 s95, s95, 10059776
    s_mul_i32 s23, s89, 32
    s_add_u32 s23, s23, 10027008
    s_mov_b32 s80, 67584
    s_mov_b32 s81, 135168
    s_mov_b32 s82, 202752
    s_mov_b32 s83, 270336
    global_load_dwordx4 v[180:183], v201, s[60:61] offset:0
    global_load_dwordx4 v[184:187], v201, s[60:61] offset:256
    global_load_dwordx4 v[188:191], v201, s[60:61] offset:512
    global_load_dwordx4 v[192:195], v201, s[60:61] offset:768
    global_load_dwordx4 v[196:199], v201, s[60:61] offset:1024
    s_mul_i32 s20, s84, 704
    s_add_u32 m0, s20, 65536
    s_mov_b32 exec_hi, 0xff
    buffer_load_dwordx4 v61, s[8:11], 0 offen  lds
    s_add_u32 m0, s94, 68352
    s_mov_b32 s20, 0
    buffer_load_dwordx4 v60, s[8:11], s20 offen  lds
    s_add_u32 m0, s94, 69056
    s_mov_b32 s20, 1280
    buffer_load_dwordx4 v60, s[8:11], s20 offen  lds
    s_add_u32 m0, s94, 69760
    s_mov_b32 s20, 2560
    buffer_load_dwordx4 v60, s[8:11], s20 offen  lds
    s_add_u32 m0, s94, 70464
    s_mov_b32 s20, 3840
    buffer_load_dwordx4 v60, s[8:11], s20 offen  lds
    s_add_u32 m0, s94, 71200
    s_mov_b32 s20, 5120
    buffer_load_dwordx4 v60, s[8:11], s20 offen  lds
    s_mov_b32 exec_hi, -1
    s_mov_b32 s22, 0x3f803f80
    s_waitcnt vmcnt(16)
    v_dot2_f32_bf16 v64, v160, s22, 0
    v_dot2_f32_bf16 v65, v160, v160, 0
    v_dot2_f32_bf16 v64, v161, s22, v64
    v_dot2_f32_bf16 v65, v161, v161, v65
    v_dot2_f32_bf16 v64, v162, s22, v64
    v_dot2_f32_bf16 v65, v162, v162, v65
    v_dot2_f32_bf16 v64, v163, s22, v64
    v_dot2_f32_bf16 v65, v163, v163, v65
    s_waitcnt vmcnt(15)
    v_dot2_f32_bf16 v64, v164, s22, v64
    v_dot2_f32_bf16 v65, v164, v164, v65
    v_dot2_f32_bf16 v64, v165, s22, v64
    v_dot2_f32_bf16 v65, v165, v165, v65
    v_dot2_f32_bf16 v64, v166, s22, v64
    v_dot2_f32_bf16 v65, v166, v166, v65
    v_dot2_f32_bf16 v64, v167, s22, v64
    v_dot2_f32_bf16 v65, v167, v167, v65
    s_waitcnt vmcnt(14)
    v_dot2_f32_bf16 v64, v168, s22, v64
    v_dot2_f32_bf16 v65, v168, v168, v65
    v_dot2_f32_bf16 v64, v169, s22, v64
    v_dot2_f32_bf16 v65, v169, v169, v65
    v_dot2_f32_bf16 v64, v170, s22, v64
    v_dot2_f32_bf16 v65, v170, v170, v65
    v_dot2_f32_bf16 v64, v171, s22, v64
    v_dot2_f32_bf16 v65, v171, v171, v65
    s_waitcnt vmcnt(13)
    v_dot2_f32_bf16 v64, v172, s22, v64
    v_dot2_f32_bf16 v65, v172, v172, v65
    v_dot2_f32_bf16 v64, v173, s22, v64
    v_dot2_f32_bf16 v65, v173, v173, v65
    v_dot2_f32_bf16 v64, v174, s22, v64
    v_dot2_f32_bf16 v65, v174, v174, v65
    v_dot2_f32_bf16 v64, v175, s22, v64
    v_dot2_f32_bf16 v65, v175, v175, v65
    s_waitcnt vmcnt(12)
    v_dot2_f32_bf16 v64, v176, s22, v64
    v_dot2_f32_bf16 v65, v176, v176, v65
    v_dot2_f32_bf16 v64, v177, s22, v64
    v_dot2_f32_bf16 v65, v177, v177, v65
    v_dot2_f32_bf16 v64, v178, s22, v64
    v_dot2_f32_bf16 v65, v178, v178, v65
    v_dot2_f32_bf16 v64, v179, s22, v64
    v_dot2_f32_bf16 v65, v179, v179, v65
    s_add_u32 m0, s94, 71904
    s_mov_b32 s20, 6400
    s_mov_b32 exec_hi, 0xff
    buffer_load_dwordx4 v60, s[8:11], s20 offen  lds
    s_add_u32 m0, s94, 72608
    s_mov_b32 s20, 7680
    buffer_load_dwordx4 v60, s[8:11], s20 offen  lds
    s_add_u32 m0, s94, 73312
    s_mov_b32 s20, 8960
    buffer_load_dwordx4 v60, s[8:11], s20 offen  lds
    s_add_u32 m0, s94, 91136
    s_mov_b32 s20, 0
    buffer_load_dwordx4 v60, s[12:15], s20 offen  lds
    s_mov_b32 exec_hi, -1
    v_lshlrev_b32 v72, 16, v160
    v_and_b32 v73, 0xffff0000, v160
    v_lshlrev_b32 v74, 16, v161
    v_add_f32_dpp v64, v64, v64 quad_perm:[1,0,3,2] row_mask:0xf bank_mask:0xf
    v_and_b32 v75, 0xffff0000, v161
    v_lshlrev_b32 v76, 16, v162
    v_add_f32_dpp v65, v65, v65 quad_perm:[1,0,3,2] row_mask:0xf bank_mask:0xf
    v_and_b32 v77, 0xffff0000, v162
    v_lshlrev_b32 v78, 16, v163
    v_add_f32_dpp v64, v64, v64 quad_perm:[2,3,0,1] row_mask:0xf bank_mask:0xf
    v_and_b32 v79, 0xffff0000, v163
    v_lshlrev_b32 v80, 16, v164
    v_and_b32 v81, 0xffff0000, v164
    v_add_f32_dpp v65, v65, v65 quad_perm:[2,3,0,1] row_mask:0xf bank_mask:0xf
    v_lshlrev_b32 v82, 16, v165
    v_and_b32 v83, 0xffff0000, v165
    v_add_f32_dpp v64, v64, v64 row_half_mirror row_mask:0xf bank_mask:0xf
    v_lshlrev_b32 v84, 16, v166
    v_and_b32 v85, 0xffff0000, v166
    v_lshlrev_b32 v86, 16, v167
    v_add_f32_dpp v65, v65, v65 row_half_mirror row_mask:0xf bank_mask:0xf
    v_and_b32 v87, 0xffff0000, v167
    v_lshlrev_b32 v88, 16, v168
    v_add_f32_dpp v64, v64, v64 row_mirror row_mask:0xf bank_mask:0xf
    v_and_b32 v89, 0xffff0000, v168
    v_lshlrev_b32 v90, 16, v169
    v_and_b32 v91, 0xffff0000, v169
    v_add_f32_dpp v65, v65, v65 row_mirror row_mask:0xf bank_mask:0xf
    v_lshlrev_b32 v92, 16, v170
    v_and_b32 v93, 0xffff0000, v170
    v_mul_f32 v64, 0x3acccccd, v64
    v_lshlrev_b32 v94, 16, v171
    v_and_b32 v95, 0xffff0000, v171
    v_lshlrev_b32 v96, 16, v172
    v_mul_f32 v65, 0x3acccccd, v65
    v_and_b32 v97, 0xffff0000, v172
    v_lshlrev_b32 v98, 16, v173
    v_fma_f32 v65, -v64, v64, v65
    v_and_b32 v99, 0xffff0000, v173
    v_lshlrev_b32 v100, 16, v174
    v_and_b32 v101, 0xffff0000, v174
    v_max_f32 v65, 0, v65
    v_lshlrev_b32 v102, 16, v175
    v_and_b32 v103, 0xffff0000, v175
    v_add_f32 v65, 0x3727c5ac, v65
    v_lshlrev_b32 v104, 16, v176
    v_and_b32 v105, 0xffff0000, v176
    v_lshlrev_b32 v106, 16, v177
    v_rsq_f32 v66, v65
    v_and_b32 v107, 0xffff0000, v177
    v_lshlrev_b32 v108, 16, v178
    v_mul_f32_e64 v68, -v64, v66
    v_and_b32 v109, 0xffff0000, v178
    v_lshlrev_b32 v110, 16, v179
    v_and_b32 v111, 0xffff0000, v179
    v_pk_fma_f32 v[72:73], v[72:73], v[66:67], v[68:69] op_sel_hi:[1,0,0]
    v_pk_fma_f32 v[74:75], v[74:75], v[66:67], v[68:69] op_sel_hi:[1,0,0]
    v_pk_fma_f32 v[76:77], v[76:77], v[66:67], v[68:69] op_sel_hi:[1,0,0]
    v_pk_fma_f32 v[78:79], v[78:79], v[66:67], v[68:69] op_sel_hi:[1,0,0]
    v_cvt_pk_bf16_f32 v112, v72, v73
    v_cvt_pk_bf16_f32 v113, v74, v75
    v_cvt_pk_bf16_f32 v114, v76, v77
    v_cvt_pk_bf16_f32 v115, v78, v79
    ds_write_b128 v44, v[112:115] offset:0
    v_pk_fma_f32 v[80:81], v[80:81], v[66:67], v[68:69] op_sel_hi:[1,0,0]
    v_pk_fma_f32 v[82:83], v[82:83], v[66:67], v[68:69] op_sel_hi:[1,0,0]
    v_pk_fma_f32 v[84:85], v[84:85], v[66:67], v[68:69] op_sel_hi:[1,0,0]
    v_pk_fma_f32 v[86:87], v[86:87], v[66:67], v[68:69] op_sel_hi:[1,0,0]
    v_cvt_pk_bf16_f32 v116, v80, v81
    v_cvt_pk_bf16_f32 v117, v82, v83
    v_cvt_pk_bf16_f32 v118, v84, v85
    v_cvt_pk_bf16_f32 v119, v86, v87
    ds_write_b128 v44, v[116:119] offset:256
    v_pk_fma_f32 v[88:89], v[88:89], v[66:67], v[68:69] op_sel_hi:[1,0,0]
    v_pk_fma_f32 v[90:91], v[90:91], v[66:67], v[68:69] op_sel_hi:[1,0,0]
    v_pk_fma_f32 v[92:93], v[92:93], v[66:67], v[68:69] op_sel_hi:[1,0,0]
    v_pk_fma_f32 v[94:95], v[94:95], v[66:67], v[68:69] op_sel_hi:[1,0,0]
    v_cvt_pk_bf16_f32 v120, v88, v89
    v_cvt_pk_bf16_f32 v121, v90, v91
    v_cvt_pk_bf16_f32 v122, v92, v93
    v_cvt_pk_bf16_f32 v123, v94, v95
    ds_write_b128 v44, v[120:123] offset:512
    v_pk_fma_f32 v[96:97], v[96:97], v[66:67], v[68:69] op_sel_hi:[1,0,0]
    v_pk_fma_f32 v[98:99], v[98:99], v[66:67], v[68:69] op_sel_hi:[1,0,0]
    v_pk_fma_f32 v[100:101], v[100:101], v[66:67], v[68:69] op_sel_hi:[1,0,0]
    v_pk_fma_f32 v[102:103], v[102:103], v[66:67], v[68:69] op_sel_hi:[1,0,0]
    v_cvt_pk_bf16_f32 v124, v96, v97
    v_cvt_pk_bf16_f32 v125, v98, v99
    v_cvt_pk_bf16_f32 v126, v100, v101
    v_cvt_pk_bf16_f32 v127, v102, v103
    ds_write_b128 v44, v[124:127] offset:768
    v_pk_fma_f32 v[104:105], v[104:105], v[66:67], v[68:69] op_sel_hi:[1,0,0]
    v_pk_fma_f32 v[106:107], v[106:107], v[66:67], v[68:69] op_sel_hi:[1,0,0]
    v_pk_fma_f32 v[108:109], v[108:109], v[66:67], v[68:69] op_sel_hi:[1,0,0]
    v_pk_fma_f32 v[110:111], v[110:111], v[66:67], v[68:69] op_sel_hi:[1,0,0]
    v_cvt_pk_bf16_f32 v128, v104, v105
    v_cvt_pk_bf16_f32 v129, v106, v107
    v_cvt_pk_bf16_f32 v130, v108, v109
    v_cvt_pk_bf16_f32 v131, v110, v111
    ds_write_b128 v44, v[128:131] offset:1024
    s_waitcnt lgkmcnt(0)
    s_barrier
    ds_read_b64_tr_b16 v[64:65], v46 offset:0
    ds_read_b64_tr_b16 v[66:67], v46 offset:5376
    ds_read_b64_tr_b16 v[68:69], v46 offset:64
    ds_read_b64_tr_b16 v[70:71], v46 offset:5440
    ds_read_b64_tr_b16 v[204:205], v47 offset:1024
    ds_read_b64_tr_b16 v[206:207], v47 offset:6400
    ds_read_b64_tr_b16 v[208:209], v46 offset:128
    ds_read_b64_tr_b16 v[210:211], v46 offset:5504
    ds_read_b64_tr_b16 v[212:213], v46 offset:192
    ds_read_b64_tr_b16 v[214:215], v46 offset:5568
    s_cmp_lt_u32 s84, 2
    s_cselect_b32 s65, 2130706432, s52
    s_cselect_b32 s52, s52, 2130706432
    s_waitcnt lgkmcnt(8)
    buffer_store_dwordx4 v[64:67], v48, s[4:7], 0 offen sc1
    s_waitcnt lgkmcnt(6)
    buffer_store_dwordx4 v[68:71], v48, s[4:7], s51 offen sc1
    s_waitcnt lgkmcnt(4)
    buffer_store_dwordx4 v[204:207], v48, s[4:7], s52 offen sc1
    s_waitcnt vmcnt(17)
    v_dot2_f32_bf16 v58, v160, v180, 0
    v_dot2_f32_bf16 v58, v161, v181, v58
    v_dot2_f32_bf16 v58, v162, v182, v58
    v_dot2_f32_bf16 v58, v163, v183, v58
    s_waitcnt vmcnt(16)
    v_dot2_f32_bf16 v58, v164, v184, v58
    v_dot2_f32_bf16 v58, v165, v185, v58
    v_dot2_f32_bf16 v58, v166, v186, v58
    v_dot2_f32_bf16 v58, v167, v187, v58
    s_waitcnt vmcnt(15)
    v_dot2_f32_bf16 v58, v168, v188, v58
    v_dot2_f32_bf16 v58, v169, v189, v58
    v_dot2_f32_bf16 v58, v170, v190, v58
    v_dot2_f32_bf16 v58, v171, v191, v58
    s_waitcnt vmcnt(14)
    v_dot2_f32_bf16 v58, v172, v192, v58
    v_dot2_f32_bf16 v58, v173, v193, v58
    v_dot2_f32_bf16 v58, v174, v194, v58
    v_dot2_f32_bf16 v58, v175, v195, v58
    s_waitcnt vmcnt(13)
    v_dot2_f32_bf16 v58, v176, v196, v58
    v_dot2_f32_bf16 v58, v177, v197, v58
    v_dot2_f32_bf16 v58, v178, v198, v58
    v_dot2_f32_bf16 v58, v179, v199, v58
    s_nop 2
    v_add_f32_dpp v58, v58, v58 quad_perm:[1,0,3,2] row_mask:0xf bank_mask:0xf
    s_nop 1
    v_add_f32_dpp v58, v58, v58 quad_perm:[2,3,0,1] row_mask:0xf bank_mask:0xf
    s_nop 1
    v_add_f32_dpp v58, v58, v58 row_half_mirror row_mask:0xf bank_mask:0xf
    s_nop 1
    v_add_f32_dpp v58, v58, v58 row_mirror row_mask:0xf bank_mask:0xf
    v_mul_f32 v58, 0xbfb8aa3b, v58
    v_exp_f32 v58, v58
    s_nop 0
    v_add_f32 v58, 1.0, v58
    v_rcp_f32 v58, v58
    s_mov_b32 exec_lo, 0x10001
    s_mov_b32 exec_hi, 0x10001
    buffer_store_dword v58, v49, s[4:7], 0 offen sc1
    s_mov_b64 exec, -1
    v_readfirstlane_b32 s91, v202
    s_nop 0
    s_add_u32 s91, s91, 0x9e3779b9
    v_mov_b32 v34, s91
    s_add_u32 m0, s94, 91840
    s_mov_b32 s20, 1280
    s_mov_b32 exec_hi, 0xff
    buffer_load_dwordx4 v60, s[12:15], s20 offen  lds
    s_add_u32 m0, s94, 92544
    s_mov_b32 s20, 2560
    buffer_load_dwordx4 v60, s[12:15], s20 offen  lds
    s_add_u32 m0, s94, 93248
    s_mov_b32 s20, 3840
    buffer_load_dwordx4 v60, s[12:15], s20 offen  lds
    s_mov_b32 exec_hi, -1
    s_waitcnt vmcnt(4)
    s_barrier
    s_cmp_lg_u32 s84, 0
    s_cbranch_scc1 L_nf_f1
    s_mov_b64 exec, 1
    buffer_store_dword v34, v0, s[4:7], s23 offen sc1
    s_mov_b64 exec, -1
L_nf_f1:
    s_add_u32 m0, s94, 93952
    s_mov_b32 s20, 5120
    s_mov_b32 exec_hi, 0xff
    buffer_load_dwordx4 v60, s[12:15], s20 offen  lds
    s_add_u32 m0, s94, 94656
    s_mov_b32 s20, 6400
    buffer_load_dwordx4 v60, s[12:15], s20 offen  lds
    s_add_u32 m0, s94, 95360
    s_mov_b32 s20, 7680
    buffer_load_dwordx4 v60, s[12:15], s20 offen  lds
    s_add_u32 m0, s94, 96064
    s_mov_b32 s20, 8960
    buffer_load_dwordx4 v60, s[12:15], s20 offen  lds
    s_mov_b32 exec_hi, -1
    global_load_dwordx2 v[148:149], v63, s[42:43] offset:0
    global_load_dwordx2 v[150:151], v63, s[42:43] offset:128
    global_load_dwordx2 v[152:153], v63, s[42:43] offset:256
    global_load_dwordx2 v[154:155], v63, s[42:43] offset:384
    global_load_dwordx2 v[156:157], v63, s[42:43] offset:512
    buffer_store_dwordx4 v[204:207], v48, s[4:7], s65 offen sc1
    s_waitcnt lgkmcnt(2)
    buffer_store_dwordx4 v[208:211], v48, s[4:7], s53 offen sc1
    s_waitcnt lgkmcnt(0)
    buffer_store_dwordx4 v[212:215], v48, s[4:7], s64 offen sc1
    s_bfe_u32 s32, s88, 0x10001
    s_mul_i32 s32, s32, 0
    s_add_u32 s32, s32, s87
    s_and_b32 s32, s32, 3
    s_mul_i32 s68, s32, 3072
    s_and_b32 s90, s88, 1
    s_add_u32 s32, s68, 1024
    s_sub_u32 s33, s32, 12288
    s_cselect_b32 s69, s32, s33
    s_add_u32 s32, s68, 2048
    s_sub_u32 s33, s32, 12288
    s_cselect_b32 s70, s32, s33
    s_add_u32 s32, s68, 3072
    s_sub_u32 s33, s32, 12288
    s_cselect_b32 s71, s32, s33
    s_add_u32 s32, s68, 4096
    s_sub_u32 s33, s32, 12288
    s_cselect_b32 s72, s32, s33
    s_add_u32 s32, s68, 5120
    s_sub_u32 s33, s32, 12288
    s_cselect_b32 s73, s32, s33
    s_add_u32 s32, s68, 6144
    s_sub_u32 s33, s32, 12288
    s_cselect_b32 s74, s32, s33
    s_add_u32 s32, s68, 7168
    s_sub_u32 s33, s32, 12288
    s_cselect_b32 s75, s32, s33
    s_add_u32 s32, s68, 8192
    s_sub_u32 s33, s32, 12288
    s_cselect_b32 s76, s32, s33
    s_add_u32 s32, s68, 9216
    s_sub_u32 s33, s32, 12288
    s_cselect_b32 s77, s32, s33
    s_add_u32 s32, s68, 10240
    s_sub_u32 s33, s32, 12288
    s_cselect_b32 s78, s32, s33
    s_add_u32 s32, s68, 11264
    s_sub_u32 s33, s32, 12288
    s_cselect_b32 s79, s32, s33
    s_mul_i32 s32, s84, 1572864
    s_lshl_b32 s33, s88, 7
    s_add_u32 s32, s32, s33
    v_lshrrev_b32 v42, 3, v0
    v_and_b32 v43, 6, v42
    v_xor_b32 v43, v43, v0
    v_and_b32 v43, 7, v43
    v_mul_u32_u24 v42, 4096, v42
    v_lshl_add_u32 v42, v43, 4, v42
    v_add_u32 v2, s32, v42
    v_add_u32 v3, 31744, v2
    v_add_u32 v4, 31744, v3
    v_add_u32 v5, 31744, v4
    s_lshl_b32 s39, s85, 7
    s_lshl1_add_u32 s93, s86, s39
    s_add_u32 s93, s93, 0
    s_add_u32 s39, s89, 512
    s_lshl_b32 s32, s93, 1
    s_load_dword s28, s[46:47], s32
    s_lshl_b32 s31, s93, 12
    s_lshl_b32 s33, s84, 10
    s_add_u32 s31, s31, s33
    s_add_u32 s48, s31, 4096
    s_lshl_b32 s49, s39, 12
    s_add_u32 s49, s49, s33
    s_add_u32 s33, s33, 4980736
    s_mul_i32 s40, s93, 4224
    s_add_u32 s40, s40, s33
    s_add_u32 s41, s40, 4224
    s_mul_i32 s50, s39, 4224
    s_add_u32 s50, s50, s33
    s_lshl_b32 s29, s84, 10
    v_lshrrev_b32 v42, 2, v0
    v_lshlrev_b32 v42, 7, v42
    v_lshl_add_u32 v42, v40, 3, v42
    v_bfe_u32 v43, v0, 3, 2
    v_xor_b32 v43, s84, v43
    v_lshl_add_u32 v42, v43, 5, v42
    v_add_u32 v6, s92, v42
    v_xor_b32 v7, 32, v6
    v_xor_b32 v8, 64, v6
    v_xor_b32 v9, 96, v6
    v_mov_b32 v68, 0
    v_mov_b32 v69, 0
    v_mov_b32 v70, 0
    v_mov_b32 v71, 0
    s_min_u32 s32, s84, 2
    s_mul_i32 s33, s32, 4608
    s_add_u32 s33, s33, 139648
    v_add_u32 v42, s33, v1
    s_mul_i32 s33, s32, 4224
    s_add_u32 s33, s33, 126976
    v_add_u32 v43, s33, v1
    s_mul_i32 s33, s32, 528
    s_add_u32 s33, s33, 153472
    v_mov_b32 v18, s33
    s_mov_b32 exec_hi, 0
    ds_write_b128 v42, v[68:71]
    s_mov_b64 exec, 0x3f
    ds_write_b128 v43, v[68:71]
    s_mov_b64 exec, 1
    ds_write_b128 v18, v[68:71]
    s_mov_b64 exec, -1
    v_lshl_add_u32 v42, v37, 3, v39
    v_lshlrev_b32 v43, 2, v40
    v_sub_u32 v43, v43, v42
    v_lshlrev_b32 v43, 3, v43
    s_mul_i32 s32, s34, 4224
    s_add_u32 s32, s32, 127192
    v_add_u32 v20, s32, v43
    v_add_lshl_u32 v42, v42, v40, 3
    s_mul_i32 s32, s34, 4608
    s_lshl_b32 s33, s35, 7
    s_add_u32 s32, s32, s33
    s_add_u32 s32, s32, 140008
    v_add_u32 v21, s32, v42
    s_mul_i32 s32, s34, 528
    s_lshl4_add_u32 s32, s35, s32
    s_add_u32 s32, s32, 153472
    v_lshlrev_b32 v42, 2, v40
    v_lshl_add_u32 v43, v39, 5, v42
    v_add_u32 v27, s32, v43
    s_add_u32 s32, s32, 4294965776
    v_lshl_add_u32 v25, v0, 5, s32
    s_mul_i32 s32, s84, 3072
    s_add_u32 s32, s32, 114688
    v_lshl_add_u32 v29, v0, 1, s32
    v_add_u32 v30, s32, v1
    v_lshl_add_u32 v42, v40, 1, s32
    v_lshl_add_u32 v252, v39, 7, v42
    v_lshrrev_b32 v42, 3, v0
    v_and_b32 v43, 7, v0
    v_lshlrev_b32 v43, 4, v43
    v_lshl_add_u32 v31, v42, 8, v43
    s_add_u32 s32, s93, s34
    s_mul_i32 s32, s32, 4224
    s_lshl_b32 s33, s35, 7
    s_add_u32 s32, s32, s33
    s_add_u32 s32, s32, 10551296
    v_add_u32 v31, s32, v31
    s_lshl_b32 s32, s34, 4
    s_waitcnt lgkmcnt(0)
    s_lshr_b32 s28, s28, s32
    s_lshl_b32 s28, s28, 16
    s_lshl_b32 s29, s84, 10
    s_cmp_ge_u32 s93, 320
    s_cselect_b32 s32, 1, 0
    v_max_u32 v24, s32, v37
    v_lshl_add_u32 v24, v24, 2, s84
    v_lshl_add_u32 v24, v24, 4, v38
    v_mul_u32_u24 v24, 64, v24
    v_add_u32 v24, 10059776, v24
    s_lshl2_add_u32 s32, s88, s84
    v_lshl_add_u32 v42, s32, 4, v38
    v_lshlrev_b32 v250, 1, v42
    s_mul_i32 s32, s32, 20480
    s_lshl_b32 s33, s87, 8
    s_add_u32 s33, s33, s32
    v_lshrrev_b32 v42, 3, v0
    v_xor_b32 v43, v42, v0
    v_and_b32 v15, 7, v43
    v_mul_u32_u24 v42, 1280, v42
    v_lshl_add_u32 v42, v15, 4, v42
    v_add_u32 v36, s33, v42
    v_add_u32 v15, 10240, v36
    v_and_b32 v43, 3, v43
    v_lshrrev_b32 v42, 2, v0
    v_mul_u32_u24 v42, 1280, v42
    v_lshl_add_u32 v42, v43, 4, v42
    s_lshl_b32 s33, s87, 6
    s_add_u32 s33, s33, s32
    v_add_u32 v41, s33, v42
    s_mul_i32 s56, s84, 5120
    s_add_u32 s56, s56, 65536
    v_lshl_add_u32 v42, s90, 2, v37
    v_xor_b32 v42, v42, v0
    v_and_b32 v42, 7, v42
    v_lshl_add_u32 v43, v38, 7, s56
    v_lshl_add_u32 v23, v42, 4, v43
    v_add_u32 v26, s56, v45
    s_lshl1_add_u32 s32, s88, s34
    s_lshl3_add_u32 s32, s32, s35
    s_lshl_b32 s32, s32, 4
    s_add_u32 s32, s32, 9961472
    v_lshl_add_u32 v42, v39, 5, s32
    v_lshl_add_u32 v253, v40, 2, v42
    s_add_u32 m0, s29, 127072
    s_nop 0
    buffer_load_dwordx4 v1, s[24:27], s31 offen  lds
    s_add_u32 m0, s29, 131296
    s_nop 0
    buffer_load_dwordx4 v1, s[24:27], s48 offen  lds
    s_add_u32 s32, s88, 4
    s_and_b32 s32, s32, 7
    s_mul_i32 s33, s32, 6
    s_cmp_eq_u32 s32, 7
    s_cselect_b32 s22, 2130706432, 0
    s_lshl2_add_u32 s32, s84, s87
    s_mul_i32 s32, s32, 96
    s_add_u32 s32, s32, s33
    s_add_u32 s32, s32, 54
    v_add_lshl_u32 v42, s32, v0, 12
    s_lshl_b32 s32, s85, 10
    s_add_u32 s32, s32, 384
    s_add_u32 s22, s22, s32
    s_mov_b64 exec, 0x3f
    buffer_load_dword v251, v42, s[16:19], s22 offen
    s_mov_b64 exec, -1
    s_mul_i32 s23, s89, 32
    s_lshl2_add_u32 s23, s84, s23
    s_add_u32 s23, s23, 10043392
    s_waitcnt vmcnt(11)
    s_barrier
    ds_read_b64_tr_b16 v[64:65], v50 offset:0
    ds_read_b64_tr_b16 v[66:67], v50 offset:2816
    ds_read_b64_tr_b16 v[68:69], v50 offset:5664
    ds_read_b64_tr_b16 v[70:71], v50 offset:25600
    ds_read_b64_tr_b16 v[72:73], v50 offset:28416
    ds_read_b64_tr_b16 v[74:75], v50 offset:32
    ds_read_b64_tr_b16 v[76:77], v50 offset:2848
    ds_read_b64_tr_b16 v[78:79], v50 offset:5696
    ds_read_b64_tr_b16 v[80:81], v50 offset:25632
    ds_read_b64_tr_b16 v[82:83], v50 offset:28448
    s_mul_i32 s21, s68, 128
    s_add_u32 m0, s92, 0
    s_nop 0
    buffer_load_dwordx4 v2, s[16:19], s21 offen offset:0  lds
    buffer_load_dwordx4 v3, s[16:19], s21 offen offset:1024  lds
    buffer_load_dwordx4 v4, s[16:19], s21 offen offset:2048  lds
    buffer_load_dwordx4 v5, s[16:19], s21 offen offset:3072  lds
    s_waitcnt vmcnt(14)
    v_alignbit_b32 v148, v148, v148, 16
    v_alignbit_b32 v149, v149, v149, 16
    s_waitcnt vmcnt(13)
    v_alignbit_b32 v150, v150, v150, 16
    v_alignbit_b32 v151, v151, v151, 16
    s_waitcnt vmcnt(12)
    v_alignbit_b32 v152, v152, v152, 16
    v_alignbit_b32 v153, v153, v153, 16
    s_waitcnt vmcnt(11)
    v_alignbit_b32 v154, v154, v154, 16
    v_alignbit_b32 v155, v155, v155, 16
    s_waitcnt vmcnt(10)
    v_alignbit_b32 v156, v156, v156, 16
    v_alignbit_b32 v157, v157, v157, 16
    s_waitcnt lgkmcnt(9)
    v_alignbit_b32 v116, v65, v64, 16
    s_waitcnt lgkmcnt(8)
    v_alignbit_b32 v117, v66, v65, 16
    v_alignbit_b32 v118, v67, v66, 16
    s_waitcnt lgkmcnt(7)
    v_alignbit_b32 v119, v68, v67, 16
    v_alignbit_b32 v120, v69, v68, 16
    v_dot2_f32_bf16 v124, v116, v149, 0
    v_dot2_f32_bf16 v125, v65, v149, 0
    v_dot2_f32_bf16 v126, v117, v149, 0
    ds_read_b64_tr_b16 v[84:85], v50 offset:64
    v_dot2_f32_bf16 v127, v66, v149, 0
    v_dot2_f32_bf16 v128, v118, v149, 0
    v_dot2_f32_bf16 v129, v67, v149, 0
    v_dot2_f32_bf16 v130, v119, v149, 0
    v_dot2_f32_bf16 v131, v68, v149, 0
    v_dot2_f32_bf16 v124, v117, v148, v124
    v_dot2_f32_bf16 v125, v66, v148, v125
    v_dot2_f32_bf16 v126, v118, v148, v126
    ds_read_b64_tr_b16 v[86:87], v50 offset:2880
    v_dot2_f32_bf16 v127, v67, v148, v127
    v_dot2_f32_bf16 v128, v119, v148, v128
    v_dot2_f32_bf16 v129, v68, v148, v129
    v_dot2_f32_bf16 v130, v120, v148, v130
    v_dot2_f32_bf16 v131, v69, v148, v131
    s_waitcnt lgkmcnt(8)
    v_lshlrev_b32 v132, 16, v70
    v_and_b32 v133, 0xffff0000, v70
    v_lshlrev_b32 v134, 16, v71
    ds_read_b64_tr_b16 v[88:89], v50 offset:5728
    v_and_b32 v135, 0xffff0000, v71
    s_waitcnt lgkmcnt(8)
    v_lshlrev_b32 v136, 16, v72
    v_and_b32 v137, 0xffff0000, v72
    v_lshlrev_b32 v138, 16, v73
    v_and_b32 v139, 0xffff0000, v73
    v_pk_mul_f32 v[124:125], v[124:125], v[132:133]
    v_pk_mul_f32 v[126:127], v[126:127], v[134:135]
    v_pk_mul_f32 v[128:129], v[128:129], v[136:137]
    ds_read_b64_tr_b16 v[90:91], v50 offset:25664
    v_pk_mul_f32 v[130:131], v[130:131], v[138:139]
    v_cvt_pk_bf16_f32 v160, v124, v125
    v_cvt_pk_bf16_f32 v161, v126, v127
    v_cvt_pk_bf16_f32 v162, v128, v129
    v_cvt_pk_bf16_f32 v163, v130, v131
    ds_write_b128 v52, v[160:163] offset:0
    ds_read_b128 v[160:163], v53 offset:0
    ds_read_b64_tr_b16 v[92:93], v50 offset:28480
    s_waitcnt lgkmcnt(11)
    v_alignbit_b32 v116, v75, v74, 16
    s_waitcnt lgkmcnt(10)
    v_alignbit_b32 v117, v76, v75, 16
    v_alignbit_b32 v118, v77, v76, 16
    s_waitcnt lgkmcnt(9)
    v_alignbit_b32 v119, v78, v77, 16
    v_alignbit_b32 v120, v79, v78, 16
    v_dot2_f32_bf16 v124, v116, v151, 0
    v_dot2_f32_bf16 v125, v75, v151, 0
    v_dot2_f32_bf16 v126, v117, v151, 0
    ds_read_b64_tr_b16 v[94:95], v50 offset:96
    v_dot2_f32_bf16 v127, v76, v151, 0
    v_dot2_f32_bf16 v128, v118, v151, 0
    v_dot2_f32_bf16 v129, v77, v151, 0
    v_dot2_f32_bf16 v130, v119, v151, 0
    v_dot2_f32_bf16 v131, v78, v151, 0
    v_dot2_f32_bf16 v124, v117, v150, v124
    v_dot2_f32_bf16 v125, v76, v150, v125
    v_dot2_f32_bf16 v126, v118, v150, v126
    ds_read_b64_tr_b16 v[96:97], v50 offset:2912
    v_dot2_f32_bf16 v127, v77, v150, v127
    v_dot2_f32_bf16 v128, v119, v150, v128
    v_dot2_f32_bf16 v129, v78, v150, v129
    v_dot2_f32_bf16 v130, v120, v150, v130
    v_dot2_f32_bf16 v131, v79, v150, v131
    s_waitcnt lgkmcnt(10)
    v_lshlrev_b32 v132, 16, v80
    v_and_b32 v133, 0xffff0000, v80
    v_lshlrev_b32 v134, 16, v81
    ds_read_b64_tr_b16 v[98:99], v50 offset:5760
    s_waitcnt lgkmcnt(4)
    buffer_store_dwordx4 v[160:163], v51, s[4:7], 0 offen sc1
    v_and_b32 v135, 0xffff0000, v81
    v_lshlrev_b32 v136, 16, v82
    v_and_b32 v137, 0xffff0000, v82
    v_lshlrev_b32 v138, 16, v83
    v_and_b32 v139, 0xffff0000, v83
    v_pk_mul_f32 v[124:125], v[124:125], v[132:133]
    v_pk_mul_f32 v[126:127], v[126:127], v[134:135]
    ds_read_b64_tr_b16 v[100:101], v50 offset:25696
    v_pk_mul_f32 v[128:129], v[128:129], v[136:137]
    v_pk_mul_f32 v[130:131], v[130:131], v[138:139]
    v_cvt_pk_bf16_f32 v164, v124, v125
    v_cvt_pk_bf16_f32 v165, v126, v127
    v_cvt_pk_bf16_f32 v166, v128, v129
    v_cvt_pk_bf16_f32 v167, v130, v131
    ds_write_b128 v52, v[164:167] offset:1024
    ds_read_b128 v[164:167], v53 offset:1024
    ds_read_b64_tr_b16 v[102:103], v50 offset:28512
    v_alignbit_b32 v116, v85, v84, 16
    v_alignbit_b32 v117, v86, v85, 16
    v_alignbit_b32 v118, v87, v86, 16
    v_alignbit_b32 v119, v88, v87, 16
    v_alignbit_b32 v120, v89, v88, 16
    v_dot2_f32_bf16 v124, v116, v153, 0
    v_dot2_f32_bf16 v125, v85, v153, 0
    v_dot2_f32_bf16 v126, v117, v153, 0
    ds_read_b64_tr_b16 v[104:105], v50 offset:128
    v_dot2_f32_bf16 v127, v86, v153, 0
    v_dot2_f32_bf16 v128, v118, v153, 0
    v_dot2_f32_bf16 v129, v87, v153, 0
    v_dot2_f32_bf16 v130, v119, v153, 0
    v_dot2_f32_bf16 v131, v88, v153, 0
    v_dot2_f32_bf16 v124, v117, v152, v124
    v_dot2_f32_bf16 v125, v86, v152, v125
    v_dot2_f32_bf16 v126, v118, v152, v126
    ds_read_b64_tr_b16 v[106:107], v50 offset:2944
    v_dot2_f32_bf16 v127, v87, v152, v127
    v_dot2_f32_bf16 v128, v119, v152, v128
    v_dot2_f32_bf16 v129, v88, v152, v129
    v_dot2_f32_bf16 v130, v120, v152, v130
    v_dot2_f32_bf16 v131, v89, v152, v131
    v_lshlrev_b32 v132, 16, v90
    v_and_b32 v133, 0xffff0000, v90
    v_lshlrev_b32 v134, 16, v91
    ds_read_b64_tr_b16 v[108:109], v50 offset:5792
    s_waitcnt lgkmcnt(4)
    buffer_store_dwordx4 v[164:167], v51, s[4:7], s80 offen sc1
    v_and_b32 v135, 0xffff0000, v91
    v_lshlrev_b32 v136, 16, v92
    v_and_b32 v137, 0xffff0000, v92
    v_lshlrev_b32 v138, 16, v93
    v_and_b32 v139, 0xffff0000, v93
    v_pk_mul_f32 v[124:125], v[124:125], v[132:133]
    v_pk_mul_f32 v[126:127], v[126:127], v[134:135]
    ds_read_b64_tr_b16 v[110:111], v50 offset:25728
    v_pk_mul_f32 v[128:129], v[128:129], v[136:137]
    v_pk_mul_f32 v[130:131], v[130:131], v[138:139]
    v_cvt_pk_bf16_f32 v168, v124, v125
    v_cvt_pk_bf16_f32 v169, v126, v127
    v_cvt_pk_bf16_f32 v170, v128, v129
    v_cvt_pk_bf16_f32 v171, v130, v131
    ds_write_b128 v52, v[168:171] offset:2048
    ds_read_b128 v[168:171], v53 offset:2048
    ds_read_b64_tr_b16 v[112:113], v50 offset:28544
    s_waitcnt vmcnt(9)
    s_mov_b64 exec, 1
    buffer_store_dword v34, v0, s[4:7], s23 offen sc1
    s_mov_b64 exec, -1
    v_alignbit_b32 v116, v95, v94, 16
    v_alignbit_b32 v117, v96, v95, 16
    v_alignbit_b32 v118, v97, v96, 16
    v_alignbit_b32 v119, v98, v97, 16
    v_alignbit_b32 v120, v99, v98, 16
    v_dot2_f32_bf16 v124, v116, v155, 0
    v_dot2_f32_bf16 v125, v95, v155, 0
    v_dot2_f32_bf16 v126, v117, v155, 0
    v_dot2_f32_bf16 v127, v96, v155, 0
    v_dot2_f32_bf16 v128, v118, v155, 0
    v_dot2_f32_bf16 v129, v97, v155, 0
    v_dot2_f32_bf16 v130, v119, v155, 0
    v_dot2_f32_bf16 v131, v98, v155, 0
    v_dot2_f32_bf16 v124, v117, v154, v124
    v_dot2_f32_bf16 v125, v96, v154, v125
    v_dot2_f32_bf16 v126, v118, v154, v126
    v_dot2_f32_bf16 v127, v97, v154, v127
    v_dot2_f32_bf16 v128, v119, v154, v128
    v_dot2_f32_bf16 v129, v98, v154, v129
    v_dot2_f32_bf16 v130, v120, v154, v130
    v_dot2_f32_bf16 v131, v99, v154, v131
    v_lshlrev_b32 v132, 16, v100
    v_and_b32 v133, 0xffff0000, v100
    v_lshlrev_b32 v134, 16, v101
    s_waitcnt lgkmcnt(1)
    buffer_store_dwordx4 v[168:171], v51, s[4:7], s81 offen sc1
    v_and_b32 v135, 0xffff0000, v101
    v_lshlrev_b32 v136, 16, v102
    v_and_b32 v137, 0xffff0000, v102
    v_lshlrev_b32 v138, 16, v103
    v_and_b32 v139, 0xffff0000, v103
    v_pk_mul_f32 v[124:125], v[124:125], v[132:133]
    v_pk_mul_f32 v[126:127], v[126:127], v[134:135]
    v_pk_mul_f32 v[128:129], v[128:129], v[136:137]
    v_pk_mul_f32 v[130:131], v[130:131], v[138:139]
    v_cvt_pk_bf16_f32 v172, v124, v125
    v_cvt_pk_bf16_f32 v173, v126, v127
    v_cvt_pk_bf16_f32 v174, v128, v129
    v_cvt_pk_bf16_f32 v175, v130, v131
    ds_write_b128 v52, v[172:175] offset:3072
    ds_read_b128 v[172:175], v53 offset:3072
    v_alignbit_b32 v116, v105, v104, 16
    v_alignbit_b32 v117, v106, v105, 16
    v_alignbit_b32 v118, v107, v106, 16
    v_alignbit_b32 v119, v108, v107, 16
    v_alignbit_b32 v120, v109, v108, 16
    v_dot2_f32_bf16 v124, v116, v157, 0
    v_dot2_f32_bf16 v125, v105, v157, 0
    v_dot2_f32_bf16 v126, v117, v157, 0
    v_dot2_f32_bf16 v127, v106, v157, 0
    v_dot2_f32_bf16 v128, v118, v157, 0
    v_dot2_f32_bf16 v129, v107, v157, 0
    v_dot2_f32_bf16 v130, v119, v157, 0
    v_dot2_f32_bf16 v131, v108, v157, 0
    v_dot2_f32_bf16 v124, v117, v156, v124
    v_dot2_f32_bf16 v125, v106, v156, v125
    v_dot2_f32_bf16 v126, v118, v156, v126
    v_dot2_f32_bf16 v127, v107, v156, v127
    v_dot2_f32_bf16 v128, v119, v156, v128
    v_dot2_f32_bf16 v129, v108, v156, v129
    v_dot2_f32_bf16 v130, v120, v156, v130
    v_dot2_f32_bf16 v131, v109, v156, v131
    v_lshlrev_b32 v132, 16, v110
    v_and_b32 v133, 0xffff0000, v110
    v_lshlrev_b32 v134, 16, v111
    s_waitcnt lgkmcnt(0)
    buffer_store_dwordx4 v[172:175], v51, s[4:7], s82 offen sc1
    v_and_b32 v135, 0xffff0000, v111
    v_lshlrev_b32 v136, 16, v112
    v_and_b32 v137, 0xffff0000, v112
    v_lshlrev_b32 v138, 16, v113
    v_and_b32 v139, 0xffff0000, v113
    v_pk_mul_f32 v[124:125], v[124:125], v[132:133]
    v_pk_mul_f32 v[126:127], v[126:127], v[134:135]
    v_pk_mul_f32 v[128:129], v[128:129], v[136:137]
    v_pk_mul_f32 v[130:131], v[130:131], v[138:139]
    v_cvt_pk_bf16_f32 v176, v124, v125
    v_cvt_pk_bf16_f32 v177, v126, v127
    v_cvt_pk_bf16_f32 v178, v128, v129
    v_cvt_pk_bf16_f32 v179, v130, v131
    ds_write_b128 v52, v[176:179] offset:4096
    ds_read_b128 v[176:179], v53 offset:4096
    s_waitcnt lgkmcnt(0)
    buffer_store_dwordx4 v[176:179], v51, s[4:7], s83 offen sc1
    s_mul_i32 s21, s69, 128
    s_add_u32 m0, s92, 16384
    s_nop 0
    buffer_load_dwordx4 v2, s[16:19], s21 offen offset:0  lds
    buffer_load_dwordx4 v3, s[16:19], s21 offen offset:1024  lds
    buffer_load_dwordx4 v4, s[16:19], s21 offen offset:2048  lds
    buffer_load_dwordx4 v5, s[16:19], s21 offen offset:3072  lds
    s_waitcnt vmcnt(4)
    s_barrier
    s_cmp_lg_u32 s84, 0
    s_cbranch_scc1 L_nf_fk
    s_mov_b64 exec, 1
    buffer_store_dword v34, v0, s[4:7], s95 offen sc1
    s_mov_b64 exec, -1
L_nf_fk:
    s_add_u32 s95, s89, 0
    s_mul_i32 s95, s95, 128
    s_lshl1_add_u32 s32, s35, s34
    s_lshl2_add_u32 s95, s32, s95
    s_add_u32 s95, s95, 10158080
    global_load_ushort v17, v250, s[58:59]
    s_mov_b64 s[8:9], s[36:37]
    s_mul_i32 s21, s70, 128
    s_add_u32 m0, s92, 32768
    s_nop 0
    buffer_load_dwordx4 v2, s[16:19], s21 offen offset:0  lds
    buffer_load_dwordx4 v3, s[16:19], s21 offen offset:1024  lds
    buffer_load_dwordx4 v4, s[16:19], s21 offen offset:2048  lds
    buffer_load_dwordx4 v5, s[16:19], s21 offen offset:3072  lds
    s_mul_i32 s21, s71, 128
    s_add_u32 m0, s92, 49152
    s_nop 0
    buffer_load_dwordx4 v2, s[16:19], s21 offen offset:0  lds
    buffer_load_dwordx4 v3, s[16:19], s21 offen offset:1024  lds
    buffer_load_dwordx4 v4, s[16:19], s21 offen offset:2048  lds
    buffer_load_dwordx4 v5, s[16:19], s21 offen offset:3072  lds
    ds_read_b64_tr_b16 a[0:1], v6 offset:0
    ds_read_b64_tr_b16 a[2:3], v6 offset:2048
    ds_read_b64_tr_b16 a[4:5], v7 offset:0
    ds_read_b64_tr_b16 a[6:7], v7 offset:2048
    ds_read_b64_tr_b16 a[8:9], v8 offset:0
    ds_read_b64_tr_b16 a[10:11], v8 offset:2048
    ds_read_b64_tr_b16 a[12:13], v9 offset:0
    ds_read_b64_tr_b16 a[14:15], v9 offset:2048
    s_mul_i32 s21, s72, 128
    s_add_u32 m0, s92, 0
    s_waitcnt lgkmcnt(0)
    buffer_load_dwordx4 v2, s[16:19], s21 offen offset:0  lds
    buffer_load_dwordx4 v3, s[16:19], s21 offen offset:1024  lds
    buffer_load_dwordx4 v4, s[16:19], s21 offen offset:2048  lds
    buffer_load_dwordx4 v5, s[16:19], s21 offen offset:3072  lds
    s_waitcnt vmcnt(13)
    ds_read_b64_tr_b16 a[16:17], v6 offset:16384
    ds_read_b64_tr_b16 a[18:19], v6 offset:18432
    ds_read_b64_tr_b16 a[20:21], v7 offset:16384
    ds_read_b64_tr_b16 a[22:23], v7 offset:18432
    ds_read_b64_tr_b16 a[24:25], v8 offset:16384
    ds_read_b64_tr_b16 a[26:27], v8 offset:18432
    ds_read_b64_tr_b16 a[28:29], v9 offset:16384
    ds_read_b64_tr_b16 a[30:31], v9 offset:18432
    s_mul_i32 s21, s73, 128
    s_add_u32 m0, s92, 16384
    s_waitcnt lgkmcnt(0)
    buffer_load_dwordx4 v2, s[16:19], s21 offen offset:0  lds
    buffer_load_dwordx4 v3, s[16:19], s21 offen offset:1024  lds
    buffer_load_dwordx4 v4, s[16:19], s21 offen offset:2048  lds
    buffer_load_dwordx4 v5, s[16:19], s21 offen offset:3072  lds
    s_waitcnt vmcnt(12)
    ds_read_b64_tr_b16 a[32:33], v6 offset:32768
    ds_read_b64_tr_b16 a[34:35], v6 offset:34816
    ds_read_b64_tr_b16 a[36:37], v7 offset:32768
    ds_read_b64_tr_b16 a[38:39], v7 offset:34816
    ds_read_b64_tr_b16 a[40:41], v8 offset:32768
    ds_read_b64_tr_b16 a[42:43], v8 offset:34816
    ds_read_b64_tr_b16 a[44:45], v9 offset:32768
    ds_read_b64_tr_b16 a[46:47], v9 offset:34816
    s_mul_i32 s21, s74, 128
    s_add_u32 m0, s92, 32768
    s_waitcnt lgkmcnt(0)
    buffer_load_dwordx4 v2, s[16:19], s21 offen offset:0  lds
    buffer_load_dwordx4 v3, s[16:19], s21 offen offset:1024  lds
    buffer_load_dwordx4 v4, s[16:19], s21 offen offset:2048  lds
    buffer_load_dwordx4 v5, s[16:19], s21 offen offset:3072  lds
    s_waitcnt vmcnt(12)
    ds_read_b64_tr_b16 a[48:49], v6 offset:49152
    ds_read_b64_tr_b16 a[50:51], v6 offset:51200
    ds_read_b64_tr_b16 a[52:53], v7 offset:49152
    ds_read_b64_tr_b16 a[54:55], v7 offset:51200
    ds_read_b64_tr_b16 a[56:57], v8 offset:49152
    ds_read_b64_tr_b16 a[58:59], v8 offset:51200
    ds_read_b64_tr_b16 a[60:61], v9 offset:49152
    ds_read_b64_tr_b16 a[62:63], v9 offset:51200
    s_mul_i32 s21, s75, 128
    s_add_u32 m0, s92, 49152
    s_waitcnt lgkmcnt(0)
    buffer_load_dwordx4 v2, s[16:19], s21 offen offset:0  lds
    buffer_load_dwordx4 v3, s[16:19], s21 offen offset:1024  lds
    buffer_load_dwordx4 v4, s[16:19], s21 offen offset:2048  lds
    buffer_load_dwordx4 v5, s[16:19], s21 offen offset:3072  lds
    s_mov_b64 exec, 0xffff
    buffer_load_dword v204, v24, s[4:7], 0 offen sc1
    s_mov_b64 exec, -1
    s_mov_b64 exec, 0xffff
    s_waitcnt vmcnt(0)
    v_cmp_ne_u32 vcc, s91, v204
    s_mov_b32 s3, 0
    s_cbranch_vccz L_pk_Bfk
L_pl_Bfk:
    s_mov_b64 exec, vcc
    buffer_load_dword v204, v24, s[4:7], 0 offen sc1
    s_add_u32 s3, s3, 1
    s_cmp_ge_u32 s3, 0x40000
    s_cbranch_scc1 L_pk_Bfk
    s_waitcnt vmcnt(0)
    v_cmp_ne_u32 vcc, s91, v204
    s_nop 0
    s_cbranch_vccnz L_pl_Bfk
L_pk_Bfk:
    s_mov_b64 exec, -1
    s_add_u32 m0, s29, 140160
    s_nop 0
    buffer_load_dwordx4 v1, s[4:7], s40 offen sc1 lds
    s_add_u32 m0, s29, 144768
    s_nop 0
    buffer_load_dwordx4 v1, s[4:7], s41 offen sc1 lds
    ds_read_b64_tr_b16 a[64:65], v6 offset:0
    ds_read_b64_tr_b16 a[66:67], v6 offset:2048
    ds_read_b64_tr_b16 a[68:69], v7 offset:0
    ds_read_b64_tr_b16 a[70:71], v7 offset:2048
    ds_read_b64_tr_b16 a[72:73], v8 offset:0
    ds_read_b64_tr_b16 a[74:75], v8 offset:2048
    ds_read_b64_tr_b16 a[76:77], v9 offset:0
    ds_read_b64_tr_b16 a[78:79], v9 offset:2048
    s_mul_i32 s21, s76, 128
    s_add_u32 m0, s92, 0
    s_waitcnt lgkmcnt(0)
    buffer_load_dwordx4 v2, s[16:19], s21 offen offset:0  lds
    buffer_load_dwordx4 v3, s[16:19], s21 offen offset:1024  lds
    buffer_load_dwordx4 v4, s[16:19], s21 offen offset:2048  lds
    buffer_load_dwordx4 v5, s[16:19], s21 offen offset:3072  lds
    s_mul_i32 s32, s87, 120
    s_mul_i32 s33, s84, 6
    s_add_u32 s32, s32, s33
    v_mul_u32_u24 v42, 43, v0
    v_lshrrev_b32 v42, 8, v42
    v_mul_u32_u24 v42, 18, v42
    v_add3_u32 v35, s32, v0, v42
    v_mul_u32_u24 v35, 64, v35
    v_add_u32 v35, 10092544, v35
    s_mul_i32 s32, s87, 240
    s_lshl1_add_u32 s32, s33, s32
    s_lshl_b32 s32, s32, 10
    s_add_u32 s32, s32, 2883584
    v_add_u32 v14, s32, v1
    s_mul_i32 s32, s90, 98304
    v_add_u32 v10, s32, v14
    s_sub_u32 s32, 98304, s32
    v_add_u32 v12, s32, v14
    v_add_u32 v11, 49152, v10
    v_add_u32 v13, 49152, v12
    v_add_u32 v14, 196608, v14
    ds_read_b64_tr_b16 a[80:81], v6 offset:16384
    ds_read_b64_tr_b16 a[82:83], v6 offset:18432
    ds_read_b64_tr_b16 a[84:85], v7 offset:16384
    ds_read_b64_tr_b16 a[86:87], v7 offset:18432
    ds_read_b64_tr_b16 a[88:89], v8 offset:16384
    ds_read_b64_tr_b16 a[90:91], v8 offset:18432
    ds_read_b64_tr_b16 a[92:93], v9 offset:16384
    ds_read_b64_tr_b16 a[94:95], v9 offset:18432
    s_mul_i32 s21, s77, 128
    s_add_u32 m0, s92, 16384
    s_waitcnt lgkmcnt(0)
    buffer_load_dwordx4 v2, s[16:19], s21 offen offset:0  lds
    buffer_load_dwordx4 v3, s[16:19], s21 offen offset:1024  lds
    buffer_load_dwordx4 v4, s[16:19], s21 offen offset:2048  lds
    buffer_load_dwordx4 v5, s[16:19], s21 offen offset:3072  lds
    ds_read_b64_tr_b16 a[96:97], v6 offset:32768
    ds_read_b64_tr_b16 a[98:99], v6 offset:34816
    ds_read_b64_tr_b16 a[100:101], v7 offset:32768
    ds_read_b64_tr_b16 a[102:103], v7 offset:34816
    ds_read_b64_tr_b16 a[104:105], v8 offset:32768
    ds_read_b64_tr_b16 a[106:107], v8 offset:34816
    ds_read_b64_tr_b16 a[108:109], v9 offset:32768
    ds_read_b64_tr_b16 a[110:111], v9 offset:34816
    s_mul_i32 s21, s78, 128
    s_add_u32 m0, s92, 32768
    s_waitcnt lgkmcnt(0)
    buffer_load_dwordx4 v2, s[16:19], s21 offen offset:0  lds
    buffer_load_dwordx4 v3, s[16:19], s21 offen offset:1024  lds
    buffer_load_dwordx4 v4, s[16:19], s21 offen offset:2048  lds
    buffer_load_dwordx4 v5, s[16:19], s21 offen offset:3072  lds
    s_waitcnt vmcnt(12)
    s_barrier
    ds_read_b64_tr_b16 v[64:65], v20 offset:32
    ds_read_b64_tr_b16 v[66:67], v20 offset:0
    ds_read_b64_tr_b16 v[128:129], v21 offset:0
    ds_read_b64_tr_b16 v[130:131], v21 offset:32
    ds_read_b64_tr_b16 v[68:69], v20 offset:288
    ds_read_b64_tr_b16 v[70:71], v20 offset:256
    ds_read_b64_tr_b16 v[132:133], v21 offset:256
    ds_read_b64_tr_b16 v[134:135], v21 offset:288
    ds_read_b64_tr_b16 v[72:73], v20 offset:544
    ds_read_b64_tr_b16 v[74:75], v20 offset:512
    ds_read_b64_tr_b16 v[136:137], v21 offset:512
    ds_read_b64_tr_b16 v[138:139], v21 offset:544
    ds_read_b64_tr_b16 v[76:77], v20 offset:800
    ds_read_b64_tr_b16 v[78:79], v20 offset:768
    ds_read_b64_tr_b16 v[140:141], v21 offset:768
    ds_read_b64_tr_b16 v[142:143], v21 offset:800
    s_waitcnt lgkmcnt(15)
    v_and_b32 v43, 0xffff0000, v65
    v_lshlrev_b32 v42, 16, v65
    v_add_f32 v43, s28, v43
    s_mov_b32 exec_lo, 0
    s_mov_b32 exec_hi, 0x1000001
    v_cvt_pk_bf16_f32 v65, v42, v43
    s_mov_b64 exec, -1
    s_waitcnt lgkmcnt(14)
    v_and_b32 v43, 0xffff0000, v67
    v_lshlrev_b32 v42, 16, v67
    v_add_f32 v43, s28, v43
    s_mov_b32 exec_lo, 0
    s_mov_b32 exec_hi, 0x10000010
    v_cvt_pk_bf16_f32 v67, v42, v43
    s_mov_b64 exec, -1
    s_waitcnt lgkmcnt(12)
    v_mfma_f32_16x16x32_bf16 v[192:195], v[64:67], v[128:131], 0
    s_waitcnt lgkmcnt(8)
    v_mfma_f32_16x16x32_bf16 v[196:199], v[64:67], v[132:135], 0
    ds_read_b64_tr_b16 v[80:81], v20 offset:1056
    v_mfma_f32_16x16x32_bf16 v[196:199], v[68:71], v[128:131], v[196:199]
    ds_read_b64_tr_b16 v[82:83], v20 offset:1024
    s_waitcnt lgkmcnt(6)
    v_mfma_f32_16x16x32_bf16 v[200:203], v[64:67], v[136:139], 0
    ds_read_b64_tr_b16 v[144:145], v21 offset:1024
    ds_read_b64_tr_b16 v[146:147], v21 offset:1056
    ds_read_b64_tr_b16 a[112:113], v6 offset:49152
    v_mfma_f32_16x16x32_bf16 v[200:203], v[68:71], v[132:135], v[200:203]
    ds_read_b64_tr_b16 a[114:115], v6 offset:51200
    v_add_f32_dpp v194, v195, v194 wave_shr:1 row_mask:0xf bank_mask:0xf bound_ctrl:0
    v_mfma_f32_16x16x32_bf16 v[200:203], v[72:75], v[128:131], v[200:203]
    ds_read_b64_tr_b16 a[116:117], v7 offset:49152
    s_waitcnt lgkmcnt(7)
    v_mfma_f32_16x16x32_bf16 v[204:207], v[64:67], v[140:143], 0
    ds_read_b64_tr_b16 v[84:85], v20 offset:1312
    v_add_f32_dpp v193, v194, v193 wave_shr:1 row_mask:0xf bank_mask:0xf bound_ctrl:0
    v_mfma_f32_16x16x32_bf16 v[204:207], v[68:71], v[136:139], v[204:207]
    ds_read_b64_tr_b16 v[86:87], v20 offset:1280
    v_add_f32_dpp v216, v193, v192 wave_shr:1 row_mask:0xf bank_mask:0xf bound_ctrl:0
    v_mfma_f32_16x16x32_bf16 v[204:207], v[72:75], v[132:135], v[204:207]
    ds_read_b64_tr_b16 v[148:149], v21 offset:1280
    ds_read_b64_tr_b16 v[150:151], v21 offset:1312
    ds_read_b64_tr_b16 a[118:119], v7 offset:51200
    v_mfma_f32_16x16x32_bf16 v[204:207], v[76:79], v[128:131], v[204:207]
    ds_read_b64_tr_b16 a[120:121], v8 offset:49152
    s_waitcnt lgkmcnt(9)
    v_mfma_f32_16x16x32_bf16 v[208:211], v[64:67], v[144:147], 0
    ds_read_b64_tr_b16 a[122:123], v8 offset:51200
    v_add_f32_dpp v198, v199, v198 wave_shr:1 row_mask:0xf bank_mask:0xf bound_ctrl:0
    v_mfma_f32_16x16x32_bf16 v[208:211], v[68:71], v[140:143], v[208:211]
    ds_read_b64_tr_b16 v[88:89], v20 offset:1568
    v_mov_b32_dpp v199, v195 wave_shl:1 row_mask:0xf bank_mask:0xf
    v_mfma_f32_16x16x32_bf16 v[208:211], v[72:75], v[136:139], v[208:211]
    ds_read_b64_tr_b16 v[90:91], v20 offset:1536
    v_add_f32_dpp v197, v198, v197 wave_shr:1 row_mask:0xf bank_mask:0xf bound_ctrl:0
    v_mfma_f32_16x16x32_bf16 v[208:211], v[76:79], v[132:135], v[208:211]
    ds_read_b64_tr_b16 v[152:153], v21 offset:1536
    v_mov_b32_dpp v198, v194 wave_shl:1 row_mask:0xf bank_mask:0xf
    v_mfma_f32_16x16x32_bf16 v[208:211], v[80:83], v[128:131], v[208:211]
    ds_read_b64_tr_b16 v[154:155], v21 offset:1568
    ds_read_b64_tr_b16 a[124:125], v9 offset:49152
    s_waitcnt lgkmcnt(8)
    v_mfma_f32_16x16x32_bf16 v[212:215], v[64:67], v[148:151], 0
    ds_read_b64_tr_b16 a[126:127], v9 offset:51200
    v_add_f32_dpp v217, v197, v196 wave_shr:1 row_mask:0xf bank_mask:0xf bound_ctrl:0
    v_mfma_f32_16x16x32_bf16 v[212:215], v[68:71], v[144:147], v[212:215]
    v_mov_b32_dpp v197, v193 wave_shl:1 row_mask:0xf bank_mask:0xf
    ds_read_b64_tr_b16 v[92:93], v20 offset:1824
    v_mfma_f32_16x16x32_bf16 v[212:215], v[72:75], v[140:143], v[212:215]
    ds_read_b64_tr_b16 v[94:95], v20 offset:1792
    v_add_f32_dpp v202, v203, v202 wave_shr:1 row_mask:0xf bank_mask:0xf bound_ctrl:0
    v_mfma_f32_16x16x32_bf16 v[212:215], v[76:79], v[136:139], v[212:215]
    ds_read_b64_tr_b16 v[156:157], v21 offset:1792
    v_mov_b32_dpp v203, v199 wave_shl:1 row_mask:0xf bank_mask:0xf
    v_mfma_f32_16x16x32_bf16 v[212:215], v[80:83], v[132:135], v[212:215]
    ds_read_b64_tr_b16 v[158:159], v21 offset:1824
    v_add_f32_dpp v201, v202, v201 wave_shr:1 row_mask:0xf bank_mask:0xf bound_ctrl:0
    v_mfma_f32_16x16x32_bf16 v[212:215], v[84:87], v[128:131], v[212:215]
    s_mul_i32 s21, s79, 128
    s_waitcnt lgkmcnt(6)
    v_mfma_f32_16x16x32_bf16 v[192:195], v[64:67], v[152:155], 0
    s_add_u32 m0, s92, 49152
    v_mov_b32_dpp v202, v198 wave_shl:1 row_mask:0xf bank_mask:0xf
    v_mfma_f32_16x16x32_bf16 v[192:195], v[68:71], v[148:151], v[192:195]
    v_add_f32_dpp v218, v201, v200 wave_shr:1 row_mask:0xf bank_mask:0xf bound_ctrl:0
    v_mov_b32_dpp v201, v197 wave_shl:1 row_mask:0xf bank_mask:0xf
    v_mfma_f32_16x16x32_bf16 v[192:195], v[72:75], v[144:147], v[192:195]
    ds_read_b64_tr_b16 v[96:97], v20 offset:2080
    v_add_f32_dpp v206, v207, v206 wave_shr:1 row_mask:0xf bank_mask:0xf bound_ctrl:0
    v_mfma_f32_16x16x32_bf16 v[192:195], v[76:79], v[140:143], v[192:195]
    ds_read_b64_tr_b16 v[98:99], v20 offset:2048
    v_mov_b32_dpp v207, v203 wave_shl:1 row_mask:0xf bank_mask:0xf
    v_mfma_f32_16x16x32_bf16 v[192:195], v[80:83], v[136:139], v[192:195]
    s_waitcnt lgkmcnt(6)
    buffer_load_dwordx4 v2, s[16:19], s21 offen offset:0  lds
    v_mfma_f32_16x16x32_bf16 v[192:195], v[84:87], v[132:135], v[192:195]
    ds_read_b64_tr_b16 v[160:161], v21 offset:2048
    v_add_f32_dpp v205, v206, v205 wave_shr:1 row_mask:0xf bank_mask:0xf bound_ctrl:0
    v_mfma_f32_16x16x32_bf16 v[192:195], v[88:91], v[128:131], v[192:195]
    ds_read_b64_tr_b16 v[162:163], v21 offset:2080
    s_waitcnt lgkmcnt(4)
    v_mfma_f32_16x16x32_bf16 v[196:199], v[64:67], v[156:159], 0
    v_mov_b32_dpp v206, v202 wave_shl:1 row_mask:0xf bank_mask:0xf
    v_add_f32_dpp v219, v205, v204 wave_shr:1 row_mask:0xf bank_mask:0xf bound_ctrl:0
    v_mfma_f32_16x16x32_bf16 v[196:199], v[68:71], v[152:155], v[196:199]
    v_mov_b32_dpp v205, v201 wave_shl:1 row_mask:0xf bank_mask:0xf
    ds_read_b64_tr_b16 v[100:101], v20 offset:2336
    v_mfma_f32_16x16x32_bf16 v[196:199], v[72:75], v[148:151], v[196:199]
    ds_read_b64_tr_b16 v[102:103], v20 offset:2304
    v_add_f32_dpp v210, v211, v210 wave_shr:1 row_mask:0xf bank_mask:0xf bound_ctrl:0
    v_mfma_f32_16x16x32_bf16 v[196:199], v[76:79], v[144:147], v[196:199]
    buffer_load_dwordx4 v3, s[16:19], s21 offen offset:1024  lds
    ds_read_b64_tr_b16 v[164:165], v21 offset:2304
    v_mfma_f32_16x16x32_bf16 v[196:199], v[80:83], v[140:143], v[196:199]
    ds_read_b64_tr_b16 v[166:167], v21 offset:2336
    v_mov_b32_dpp v211, v207 wave_shl:1 row_mask:0xf bank_mask:0xf
    v_mfma_f32_16x16x32_bf16 v[196:199], v[84:87], v[136:139], v[196:199]
    v_add_f32_dpp v209, v210, v209 wave_shr:1 row_mask:0xf bank_mask:0xf bound_ctrl:0
    v_mov_b32_dpp v210, v206 wave_shl:1 row_mask:0xf bank_mask:0xf
    v_mfma_f32_16x16x32_bf16 v[196:199], v[88:91], v[132:135], v[196:199]
    v_add_f32_dpp v220, v209, v208 wave_shr:1 row_mask:0xf bank_mask:0xf bound_ctrl:0
    v_mov_b32_dpp v209, v205 wave_shl:1 row_mask:0xf bank_mask:0xf
    v_mfma_f32_16x16x32_bf16 v[196:199], v[92:95], v[128:131], v[196:199]
    v_add_f32_dpp v214, v215, v214 wave_shr:1 row_mask:0xf bank_mask:0xf bound_ctrl:0
    s_waitcnt lgkmcnt(4)
    v_mfma_f32_16x16x32_bf16 v[200:203], v[64:67], v[160:163], 0
    v_mov_b32_dpp v215, v211 wave_shl:1 row_mask:0xf bank_mask:0xf
    v_add_f32_dpp v213, v214, v213 wave_shr:1 row_mask:0xf bank_mask:0xf bound_ctrl:0
    v_mfma_f32_16x16x32_bf16 v[200:203], v[68:71], v[156:159], v[200:203]
    buffer_load_dwordx4 v4, s[16:19], s21 offen offset:2048  lds
    v_mov_b32_dpp v214, v210 wave_shl:1 row_mask:0xf bank_mask:0xf
    v_mfma_f32_16x16x32_bf16 v[200:203], v[72:75], v[152:155], v[200:203]
    v_add_f32_dpp v221, v213, v212 wave_shr:1 row_mask:0xf bank_mask:0xf bound_ctrl:0
    v_mov_b32_dpp v213, v209 wave_shl:1 row_mask:0xf bank_mask:0xf
    v_mfma_f32_16x16x32_bf16 v[200:203], v[76:79], v[148:151], v[200:203]
    ds_read_b64_tr_b16 v[104:105], v20 offset:2592
    s_waitcnt vmcnt(11)
    v_mfma_f32_16x16x32_bf16 v[200:203], v[80:83], v[144:147], v[200:203]
    ds_read_b64_tr_b16 v[106:107], v20 offset:2560
    v_add_f32_dpp v194, v195, v194 wave_shr:1 row_mask:0xf bank_mask:0xf bound_ctrl:0
    v_mfma_f32_16x16x32_bf16 v[200:203], v[84:87], v[140:143], v[200:203]
    ds_read_b64_tr_b16 v[168:169], v21 offset:2560
    v_mov_b32_dpp v195, v215 wave_shl:1 row_mask:0xf bank_mask:0xf
    v_mfma_f32_16x16x32_bf16 v[200:203], v[88:91], v[136:139], v[200:203]
    ds_read_b64_tr_b16 v[170:171], v21 offset:2592
    v_add_f32_dpp v193, v194, v193 wave_shr:1 row_mask:0xf bank_mask:0xf bound_ctrl:0
    v_mfma_f32_16x16x32_bf16 v[200:203], v[92:95], v[132:135], v[200:203]
    buffer_load_dwordx4 v5, s[16:19], s21 offen offset:3072  lds
    ds_read_b64_tr_b16 a[128:129], v6 offset:0
    v_mfma_f32_16x16x32_bf16 v[200:203], v[96:99], v[128:131], v[200:203]
    ds_read_b64_tr_b16 a[130:131], v6 offset:2048
    s_waitcnt lgkmcnt(6)
    v_mfma_f32_16x16x32_bf16 v[204:207], v[64:67], v[164:167], 0
    ds_read_b64_tr_b16 a[132:133], v7 offset:0
    v_mov_b32_dpp v194, v214 wave_shl:1 row_mask:0xf bank_mask:0xf
    v_mfma_f32_16x16x32_bf16 v[204:207], v[68:71], v[160:163], v[204:207]
    ds_read_b64_tr_b16 a[134:135], v7 offset:2048
    v_add_f32_dpp v222, v193, v192 wave_shr:1 row_mask:0xf bank_mask:0xf bound_ctrl:0
    v_mfma_f32_16x16x32_bf16 v[204:207], v[72:75], v[156:159], v[204:207]
    ds_read_b64_tr_b16 a[136:137], v8 offset:0
    v_mov_b32_dpp v193, v213 wave_shl:1 row_mask:0xf bank_mask:0xf
    v_mfma_f32_16x16x32_bf16 v[204:207], v[76:79], v[152:155], v[204:207]
    ds_read_b64_tr_b16 a[138:139], v8 offset:2048
    v_add_f32_dpp v198, v199, v198 wave_shr:1 row_mask:0xf bank_mask:0xf bound_ctrl:0
    v_mfma_f32_16x16x32_bf16 v[204:207], v[80:83], v[148:151], v[204:207]
    ds_read_b64_tr_b16 a[140:141], v9 offset:0
    ds_read_b64_tr_b16 a[142:143], v9 offset:2048
    v_mfma_f32_16x16x32_bf16 v[204:207], v[84:87], v[144:147], v[204:207]
    ds_read_b64_tr_b16 v[108:109], v20 offset:2848
    v_mov_b32_dpp v199, v195 wave_shl:1 row_mask:0xf bank_mask:0xf
    v_mfma_f32_16x16x32_bf16 v[204:207], v[88:91], v[140:143], v[204:207]
    ds_read_b64_tr_b16 v[110:111], v20 offset:2816
    v_add_f32_dpp v197, v198, v197 wave_shr:1 row_mask:0xf bank_mask:0xf bound_ctrl:0
    v_mfma_f32_16x16x32_bf16 v[204:207], v[92:95], v[136:139], v[204:207]
    s_add_u32 m0, s56, 0
    s_nop 0
    buffer_load_dwordx4 v36, s[8:11], 0 offen offset:0 lds
    v_mfma_f32_16x16x32_bf16 v[204:207], v[96:99], v[132:135], v[204:207]
    ds_read_b64_tr_b16 v[172:173], v21 offset:2816
    v_mov_b32_dpp v198, v194 wave_shl:1 row_mask:0xf bank_mask:0xf
    v_mfma_f32_16x16x32_bf16 v[204:207], v[100:103], v[128:131], v[204:207]
    ds_read_b64_tr_b16 v[174:175], v21 offset:2848
    s_waitcnt lgkmcnt(12)
    v_mfma_f32_16x16x32_bf16 v[208:211], v[64:67], v[168:171], 0
    v_add_f32_dpp v223, v197, v196 wave_shr:1 row_mask:0xf bank_mask:0xf bound_ctrl:0
    v_mov_b32_dpp v197, v193 wave_shl:1 row_mask:0xf bank_mask:0xf
    v_mfma_f32_16x16x32_bf16 v[208:211], v[68:71], v[164:167], v[208:211]
    v_add_f32_dpp v202, v203, v202 wave_shr:1 row_mask:0xf bank_mask:0xf bound_ctrl:0
    v_mov_b32_dpp v203, v199 wave_shl:1 row_mask:0xf bank_mask:0xf
    v_mfma_f32_16x16x32_bf16 v[208:211], v[72:75], v[160:163], v[208:211]
    v_add_f32_dpp v201, v202, v201 wave_shr:1 row_mask:0xf bank_mask:0xf bound_ctrl:0
    v_mov_b32_dpp v202, v198 wave_shl:1 row_mask:0xf bank_mask:0xf
    v_mfma_f32_16x16x32_bf16 v[208:211], v[76:79], v[156:159], v[208:211]
    s_add_u32 m0, s56, 1024
    s_nop 0
    buffer_load_dwordx4 v15, s[8:11], 0 offen offset:0 lds
    v_mfma_f32_16x16x32_bf16 v[208:211], v[80:83], v[152:155], v[208:211]
    v_add_f32_dpp v224, v201, v200 wave_shr:1 row_mask:0xf bank_mask:0xf bound_ctrl:0
    v_mov_b32_dpp v201, v197 wave_shl:1 row_mask:0xf bank_mask:0xf
    v_mfma_f32_16x16x32_bf16 v[208:211], v[84:87], v[148:151], v[208:211]
    ds_read_b64_tr_b16 v[112:113], v20 offset:3104
    v_add_f32_dpp v206, v207, v206 wave_shr:1 row_mask:0xf bank_mask:0xf bound_ctrl:0
    v_mfma_f32_16x16x32_bf16 v[208:211], v[88:91], v[144:147], v[208:211]
    ds_read_b64_tr_b16 v[114:115], v20 offset:3072
    v_mov_b32_dpp v207, v203 wave_shl:1 row_mask:0xf bank_mask:0xf
    v_mfma_f32_16x16x32_bf16 v[208:211], v[92:95], v[140:143], v[208:211]
    ds_read_b64_tr_b16 v[176:177], v21 offset:3072
    v_add_f32_dpp v205, v206, v205 wave_shr:1 row_mask:0xf bank_mask:0xf bound_ctrl:0
    v_mfma_f32_16x16x32_bf16 v[208:211], v[96:99], v[136:139], v[208:211]
    ds_read_b64_tr_b16 v[178:179], v21 offset:3104
    v_mov_b32_dpp v206, v202 wave_shl:1 row_mask:0xf bank_mask:0xf
    v_mfma_f32_16x16x32_bf16 v[208:211], v[100:103], v[132:135], v[208:211]
    s_add_u32 m0, s56, 1920
    s_nop 0
    buffer_load_dwordx4 v36, s[8:11], 0 offen offset:128 lds
    v_mfma_f32_16x16x32_bf16 v[208:211], v[104:107], v[128:131], v[208:211]
    v_add_f32_dpp v225, v205, v204 wave_shr:1 row_mask:0xf bank_mask:0xf bound_ctrl:0
    s_waitcnt lgkmcnt(4)
    v_mfma_f32_16x16x32_bf16 v[212:215], v[64:67], v[172:175], 0
    v_mov_b32_dpp v205, v201 wave_shl:1 row_mask:0xf bank_mask:0xf
    ds_read_b64_tr_b16 v[116:117], v20 offset:3360
    v_mfma_f32_16x16x32_bf16 v[212:215], v[68:71], v[168:171], v[212:215]
    ds_read_b64_tr_b16 v[118:119], v20 offset:3328
    s_waitcnt vmcnt(11)
    v_mfma_f32_16x16x32_bf16 v[212:215], v[72:75], v[164:167], v[212:215]
    ds_read_b64_tr_b16 v[180:181], v21 offset:3328
    v_add_f32_dpp v210, v211, v210 wave_shr:1 row_mask:0xf bank_mask:0xf bound_ctrl:0
    v_mfma_f32_16x16x32_bf16 v[212:215], v[76:79], v[160:163], v[212:215]
    ds_read_b64_tr_b16 v[182:183], v21 offset:3360
    v_mov_b32_dpp v211, v207 wave_shl:1 row_mask:0xf bank_mask:0xf
    v_mfma_f32_16x16x32_bf16 v[212:215], v[80:83], v[156:159], v[212:215]
    s_add_u32 m0, s56, 2944
    s_nop 0
    buffer_load_dwordx4 v15, s[8:11], 0 offen offset:128 lds
    v_mfma_f32_16x16x32_bf16 v[212:215], v[84:87], v[152:155], v[212:215]
    v_add_f32_dpp v209, v210, v209 wave_shr:1 row_mask:0xf bank_mask:0xf bound_ctrl:0
    v_mov_b32_dpp v210, v206 wave_shl:1 row_mask:0xf bank_mask:0xf
    v_mfma_f32_16x16x32_bf16 v[212:215], v[88:91], v[148:151], v[212:215]
    v_add_f32_dpp v226, v209, v208 wave_shr:1 row_mask:0xf bank_mask:0xf bound_ctrl:0
    v_mov_b32_dpp v209, v205 wave_shl:1 row_mask:0xf bank_mask:0xf
    v_mfma_f32_16x16x32_bf16 v[212:215], v[92:95], v[144:147], v[212:215]
    ds_read_b64_tr_b16 v[120:121], v20 offset:3616
    v_mfma_f32_16x16x32_bf16 v[212:215], v[96:99], v[140:143], v[212:215]
    ds_read_b64_tr_b16 v[122:123], v20 offset:3584
    v_mfma_f32_16x16x32_bf16 v[212:215], v[100:103], v[136:139], v[212:215]
    ds_read_b64_tr_b16 v[184:185], v21 offset:3584
    v_mfma_f32_16x16x32_bf16 v[212:215], v[104:107], v[132:135], v[212:215]
    s_add_u32 m0, s56, 3072
    s_nop 0
    buffer_load_dwordx4 v41, s[8:11], 0 offen offset:1024 lds
    v_mfma_f32_16x16x32_bf16 v[212:215], v[108:111], v[128:131], v[212:215]
    ds_read_b64_tr_b16 v[186:187], v21 offset:3616
    s_waitcnt lgkmcnt(8)
    v_mfma_f32_16x16x32_bf16 v[192:195], v[64:67], v[176:179], 0
    ds_read_b64_tr_b16 v[124:125], v20 offset:3872
    v_mfma_f32_16x16x32_bf16 v[192:195], v[68:71], v[172:175], v[192:195]
    ds_read_b64_tr_b16 v[126:127], v20 offset:3840
    v_mfma_f32_16x16x32_bf16 v[192:195], v[72:75], v[168:171], v[192:195]
    s_nop 0
    v_add_f32_dpp v214, v215, v214 wave_shr:1 row_mask:0xf bank_mask:0xf bound_ctrl:0
    v_mov_b32_dpp v215, v211 wave_shl:1 row_mask:0xf bank_mask:0xf
    v_mfma_f32_16x16x32_bf16 v[192:195], v[76:79], v[164:167], v[192:195]
    v_add_f32_dpp v213, v214, v213 wave_shr:1 row_mask:0xf bank_mask:0xf bound_ctrl:0
    v_mov_b32_dpp v214, v210 wave_shl:1 row_mask:0xf bank_mask:0xf
    v_mfma_f32_16x16x32_bf16 v[192:195], v[80:83], v[160:163], v[192:195]
    v_add_f32_dpp v227, v213, v212 wave_shr:1 row_mask:0xf bank_mask:0xf bound_ctrl:0
    v_mov_b32_dpp v213, v209 wave_shl:1 row_mask:0xf bank_mask:0xf
    v_mfma_f32_16x16x32_bf16 v[192:195], v[84:87], v[156:159], v[192:195]
    ds_read_b64_tr_b16 v[188:189], v21 offset:3840
    v_mfma_f32_16x16x32_bf16 v[192:195], v[88:91], v[152:155], v[192:195]
    ds_read_b64_tr_b16 v[190:191], v21 offset:3872
    v_mfma_f32_16x16x32_bf16 v[192:195], v[92:95], v[148:151], v[192:195]
    ds_read_b64_tr_b16 a[144:145], v6 offset:16384
    v_mfma_f32_16x16x32_bf16 v[192:195], v[96:99], v[144:147], v[192:195]
    ds_read_b64_tr_b16 a[146:147], v6 offset:18432
    v_mfma_f32_16x16x32_bf16 v[192:195], v[100:103], v[140:143], v[192:195]
    ds_read_b64_tr_b16 a[148:149], v7 offset:16384
    v_mfma_f32_16x16x32_bf16 v[192:195], v[104:107], v[136:139], v[192:195]
    ds_read_b64_tr_b16 a[150:151], v7 offset:18432
    v_mfma_f32_16x16x32_bf16 v[192:195], v[108:111], v[132:135], v[192:195]
    ds_read_b64_tr_b16 a[152:153], v8 offset:16384
    v_mfma_f32_16x16x32_bf16 v[192:195], v[112:115], v[128:131], v[192:195]
    v_mov_b32 v240, v216
    s_waitcnt lgkmcnt(13)
    v_mfma_f32_16x16x32_bf16 v[196:199], v[64:67], v[180:183], 0
    v_mov_b32_dpp v240, v217 row_shr:4 row_mask:0x1 bank_mask:0x2
    v_cvt_pk_bf16_f32 v216, v216, v217
    v_mfma_f32_16x16x32_bf16 v[196:199], v[68:71], v[176:179], v[196:199]
    ds_write_b16 v29, v216 offset:0
    v_mfma_f32_16x16x32_bf16 v[196:199], v[72:75], v[172:175], v[196:199]
    v_add_f32_dpp v194, v195, v194 wave_shr:1 row_mask:0xf bank_mask:0xf bound_ctrl:0
    v_mov_b32_dpp v195, v215 wave_shl:1 row_mask:0xf bank_mask:0xf
    v_mfma_f32_16x16x32_bf16 v[196:199], v[76:79], v[168:171], v[196:199]
    v_add_f32_dpp v193, v194, v193 wave_shr:1 row_mask:0xf bank_mask:0xf bound_ctrl:0
    v_mov_b32_dpp v194, v214 wave_shl:1 row_mask:0xf bank_mask:0xf
    v_mfma_f32_16x16x32_bf16 v[196:199], v[80:83], v[164:167], v[196:199]
    v_add_f32_dpp v228, v193, v192 wave_shr:1 row_mask:0xf bank_mask:0xf bound_ctrl:0
    v_mov_b32_dpp v193, v213 wave_shl:1 row_mask:0xf bank_mask:0xf
    v_mfma_f32_16x16x32_bf16 v[196:199], v[84:87], v[160:163], v[196:199]
    s_mov_b64 exec, 0x3fffffff
    buffer_load_dword v18, v35, s[4:7], 0 offen sc1
    s_mov_b64 exec, -1
    v_mfma_f32_16x16x32_bf16 v[196:199], v[88:91], v[156:159], v[196:199]
    ds_write_b16_d16_hi v29, v216 offset:128
    v_mfma_f32_16x16x32_bf16 v[196:199], v[92:95], v[152:155], v[196:199]
    v_mov_b32_dpp v240, v218 row_shr:8 row_mask:0x1 bank_mask:0x4
    s_nop 1
    v_mov_b32_dpp v240, v219 row_shr:12 row_mask:0x1 bank_mask:0x8
    v_mfma_f32_16x16x32_bf16 v[196:199], v[96:99], v[148:151], v[196:199]
    v_cvt_pk_bf16_f32 v218, v218, v219
    ds_read_b64_tr_b16 a[154:155], v8 offset:18432
    v_mfma_f32_16x16x32_bf16 v[196:199], v[100:103], v[144:147], v[196:199]
    ds_write_b16 v29, v218 offset:256
    v_mfma_f32_16x16x32_bf16 v[196:199], v[104:107], v[140:143], v[196:199]
    ds_write_b16_d16_hi v29, v218 offset:384
    v_mfma_f32_16x16x32_bf16 v[196:199], v[108:111], v[136:139], v[196:199]
    v_mov_b32 v241, v220
    s_nop 1
    v_mov_b32_dpp v241, v221 row_shr:4 row_mask:0x1 bank_mask:0x2
    v_mfma_f32_16x16x32_bf16 v[196:199], v[112:115], v[132:135], v[196:199]
    v_cvt_pk_bf16_f32 v220, v220, v221
    ds_read_b64_tr_b16 a[156:157], v9 offset:16384
    v_mfma_f32_16x16x32_bf16 v[196:199], v[116:119], v[128:131], v[196:199]
    ds_read_b64_tr_b16 a[158:159], v9 offset:18432
    s_waitcnt lgkmcnt(15)
    v_mfma_f32_16x16x32_bf16 v[200:203], v[64:67], v[184:187], 0
    ds_write_b16 v29, v220 offset:512
    v_mfma_f32_16x16x32_bf16 v[200:203], v[68:71], v[180:183], v[200:203]
    ds_write_b16_d16_hi v29, v220 offset:640
    v_mfma_f32_16x16x32_bf16 v[200:203], v[72:75], v[176:179], v[200:203]
    s_nop 0
    v_add_f32_dpp v198, v199, v198 wave_shr:1 row_mask:0xf bank_mask:0xf bound_ctrl:0
    v_mov_b32_dpp v199, v195 wave_shl:1 row_mask:0xf bank_mask:0xf
    v_mfma_f32_16x16x32_bf16 v[200:203], v[76:79], v[172:175], v[200:203]
    v_add_f32_dpp v197, v198, v197 wave_shr:1 row_mask:0xf bank_mask:0xf bound_ctrl:0
    v_mov_b32_dpp v198, v194 wave_shl:1 row_mask:0xf bank_mask:0xf
    v_mfma_f32_16x16x32_bf16 v[200:203], v[80:83], v[168:171], v[200:203]
    v_add_f32_dpp v229, v197, v196 wave_shr:1 row_mask:0xf bank_mask:0xf bound_ctrl:0
    v_mov_b32_dpp v197, v193 wave_shl:1 row_mask:0xf bank_mask:0xf
    v_mfma_f32_16x16x32_bf16 v[200:203], v[84:87], v[164:167], v[200:203]
    v_mov_b32_dpp v241, v222 row_shr:8 row_mask:0x1 bank_mask:0x4
    s_nop 1
    v_mov_b32_dpp v241, v223 row_shr:12 row_mask:0x1 bank_mask:0x8
    v_mfma_f32_16x16x32_bf16 v[200:203], v[88:91], v[160:163], v[200:203]
    v_cvt_pk_bf16_f32 v222, v222, v223
    s_waitcnt vmcnt(10)
    v_mfma_f32_16x16x32_bf16 v[200:203], v[92:95], v[156:159], v[200:203]
    ds_write_b16 v29, v222 offset:768
    v_mfma_f32_16x16x32_bf16 v[200:203], v[96:99], v[152:155], v[200:203]
    ds_write_b16_d16_hi v29, v222 offset:896
    v_mfma_f32_16x16x32_bf16 v[200:203], v[100:103], v[148:151], v[200:203]
    v_mov_b32 v242, v224
    s_nop 1
    v_mov_b32_dpp v242, v225 row_shr:4 row_mask:0x1 bank_mask:0x2
    v_mfma_f32_16x16x32_bf16 v[200:203], v[104:107], v[144:147], v[200:203]
    v_cvt_pk_bf16_f32 v224, v224, v225
    ds_read_b64_tr_b16 a[160:161], v6 offset:32768
    v_mfma_f32_16x16x32_bf16 v[200:203], v[108:111], v[140:143], v[200:203]
    ds_write_b16 v29, v224 offset:1024
    v_mfma_f32_16x16x32_bf16 v[200:203], v[112:115], v[136:139], v[200:203]
    ds_write_b16_d16_hi v29, v224 offset:1152
    v_mfma_f32_16x16x32_bf16 v[200:203], v[116:119], v[132:135], v[200:203]
    v_mov_b32_dpp v242, v226 row_shr:8 row_mask:0x1 bank_mask:0x4
    s_nop 1
    v_mov_b32_dpp v242, v227 row_shr:12 row_mask:0x1 bank_mask:0x8
    v_mfma_f32_16x16x32_bf16 v[200:203], v[120:123], v[128:131], v[200:203]
    v_cvt_pk_bf16_f32 v226, v226, v227
    s_waitcnt lgkmcnt(15)
    v_mfma_f32_16x16x32_bf16 v[204:207], v[64:67], v[188:191], 0
    ds_write_b16 v29, v226 offset:1280
    v_mfma_f32_16x16x32_bf16 v[204:207], v[68:71], v[184:187], v[204:207]
    ds_write_b16_d16_hi v29, v226 offset:1408
    v_mfma_f32_16x16x32_bf16 v[204:207], v[72:75], v[180:183], v[204:207]
    s_nop 0
    v_add_f32_dpp v202, v203, v202 wave_shr:1 row_mask:0xf bank_mask:0xf bound_ctrl:0
    v_mov_b32_dpp v203, v199 wave_shl:1 row_mask:0xf bank_mask:0xf
    v_mfma_f32_16x16x32_bf16 v[204:207], v[76:79], v[176:179], v[204:207]
    v_add_f32_dpp v201, v202, v201 wave_shr:1 row_mask:0xf bank_mask:0xf bound_ctrl:0
    v_mov_b32_dpp v202, v198 wave_shl:1 row_mask:0xf bank_mask:0xf
    v_mfma_f32_16x16x32_bf16 v[204:207], v[80:83], v[172:175], v[204:207]
    s_mov_b64 exec, 0x3fffffff
    s_waitcnt vmcnt(0)
    v_cmp_ne_u32 vcc, s91, v18
    s_mov_b32 s3, 0
    s_cbranch_vccz L_pk_Bfu0
L_pl_Bfu0:
    s_mov_b64 exec, vcc
    buffer_load_dword v18, v35, s[4:7], 0 offen sc1
    s_add_u32 s3, s3, 1
    s_cmp_ge_u32 s3, 0x40000
    s_cbranch_scc1 L_pk_Bfu0
    s_waitcnt vmcnt(0)
    v_cmp_ne_u32 vcc, s91, v18
    s_nop 0
    s_cbranch_vccnz L_pl_Bfu0
L_pk_Bfu0:
    s_mov_b64 exec, -1
    v_mfma_f32_16x16x32_bf16 v[204:207], v[84:87], v[168:171], v[204:207]
    v_add_f32_dpp v230, v201, v200 wave_shr:1 row_mask:0xf bank_mask:0xf bound_ctrl:0
    v_mov_b32_dpp v201, v197 wave_shl:1 row_mask:0xf bank_mask:0xf
    v_mfma_f32_16x16x32_bf16 v[204:207], v[88:91], v[164:167], v[204:207]
    buffer_load_dwordx4 a[192:195], v10, s[4:7], s68 offen sc1
    buffer_load_dwordx4 a[196:199], v10, s[4:7], s69 offen sc1
    v_mfma_f32_16x16x32_bf16 v[204:207], v[92:95], v[160:163], v[204:207]
    buffer_load_dwordx4 a[200:203], v10, s[4:7], s70 offen sc1
    v_mov_b32 v243, v228
    v_mfma_f32_16x16x32_bf16 v[204:207], v[96:99], v[156:159], v[204:207]
    s_nop 0
    v_mov_b32_dpp v243, v229 row_shr:4 row_mask:0x1 bank_mask:0x2
    v_cvt_pk_bf16_f32 v228, v228, v229
    v_mfma_f32_16x16x32_bf16 v[204:207], v[100:103], v[152:155], v[204:207]
    buffer_load_dwordx4 a[204:207], v10, s[4:7], s71 offen sc1
    ds_read_b64_tr_b16 a[162:163], v6 offset:34816
    v_mfma_f32_16x16x32_bf16 v[204:207], v[104:107], v[148:151], v[204:207]
    buffer_load_dwordx4 a[208:211], v10, s[4:7], s72 offen sc1
    ds_read_b64_tr_b16 a[164:165], v7 offset:32768
    v_mfma_f32_16x16x32_bf16 v[204:207], v[108:111], v[144:147], v[204:207]
    buffer_load_dwordx4 a[212:215], v10, s[4:7], s73 offen sc1
    ds_read_b64_tr_b16 a[166:167], v7 offset:34816
    v_mfma_f32_16x16x32_bf16 v[204:207], v[112:115], v[140:143], v[204:207]
    ds_write_b16 v29, v228 offset:1536
    v_mfma_f32_16x16x32_bf16 v[204:207], v[116:119], v[136:139], v[204:207]
    buffer_load_dwordx4 a[216:219], v10, s[4:7], s74 offen sc1
    ds_read_b64_tr_b16 a[168:169], v8 offset:32768
    v_mfma_f32_16x16x32_bf16 v[204:207], v[120:123], v[132:135], v[204:207]
    buffer_load_dwordx4 a[220:223], v10, s[4:7], s75 offen sc1
    ds_read_b64_tr_b16 a[170:171], v8 offset:34816
    v_mfma_f32_16x16x32_bf16 v[204:207], v[124:127], v[128:131], v[204:207]
    ds_write_b16_d16_hi v29, v228 offset:1664
    ds_read_b64_tr_b16 a[172:173], v9 offset:32768
    ds_read_b64_tr_b16 a[174:175], v9 offset:34816
    ds_read_b64_tr_b16 a[176:177], v6 offset:49152
    ds_read_b64_tr_b16 a[178:179], v6 offset:51200
    ds_read_b64_tr_b16 a[180:181], v7 offset:49152
    ds_read_b64_tr_b16 a[182:183], v7 offset:51200
    ds_read_b64_tr_b16 a[184:185], v8 offset:49152
    ds_read_b64_tr_b16 a[186:187], v8 offset:51200
    ds_read_b64_tr_b16 a[188:189], v9 offset:49152
    ds_read_b64_tr_b16 a[190:191], v9 offset:51200
    buffer_load_dword v16, v253, s[4:7], 0 offen sc1
    v_add_f32_dpp v206, v207, v206 wave_shr:1 row_mask:0xf bank_mask:0xf bound_ctrl:0
    v_mov_b32_dpp v207, v203 wave_shl:1 row_mask:0xf bank_mask:0xf
    s_nop 0
    v_add_f32_dpp v205, v206, v205 wave_shr:1 row_mask:0xf bank_mask:0xf bound_ctrl:0
    v_mov_b32_dpp v206, v202 wave_shl:1 row_mask:0xf bank_mask:0xf
    s_nop 0
    v_add_f32_dpp v231, v205, v204 wave_shr:1 row_mask:0xf bank_mask:0xf bound_ctrl:0
    v_mov_b32_dpp v205, v201 wave_shl:1 row_mask:0xf bank_mask:0xf
    s_mov_b32 exec_lo, 0
    s_mov_b32 exec_hi, 0xffff0000
    ds_write_b128 v25, v[204:207]
    s_mov_b64 exec, -1
    s_waitcnt vmcnt(8)
    v_mfma_f32_16x16x32_bf16 v[108:111], a[192:195], a[4:7], 0
    buffer_load_dwordx4 a[224:227], v10, s[4:7], s76 offen sc1
    s_waitcnt vmcnt(8)
    v_mfma_f32_16x16x32_bf16 v[108:111], a[196:199], a[20:23], v[108:111]
    s_xor_b32 s32, s84, 1
    s_mul_i32 s32, s32, 3072
    v_mfma_f32_16x16x32_bf16 v[112:115], a[192:195], a[8:11], 0
    buffer_load_dwordx4 a[228:231], v10, s[4:7], s77 offen sc1
    s_add_u32 s32, s32, 0
    v_mfma_f32_16x16x32_bf16 v[112:115], a[196:199], a[24:27], v[112:115]
    v_add_u32 v2, s32, v1
    v_add_u32 v5, 65536, v2
    v_mfma_f32_16x16x32_bf16 v[116:119], a[192:195], a[12:15], 0
    buffer_load_dwordx4 a[232:235], v10, s[4:7], s78 offen sc1
    s_xor_b32 s32, s84, 2
    v_mfma_f32_16x16x32_bf16 v[116:119], a[196:199], a[28:31], v[116:119]
    s_mul_i32 s32, s32, 3072
    s_add_u32 s32, s32, 1024
    v_mfma_f32_16x16x32_bf16 v[132:135], a[192:195], a[0:3], 0
    buffer_load_dwordx4 a[236:239], v10, s[4:7], s79 offen sc1
    s_waitcnt lgkmcnt(0)
    v_mfma_f32_16x16x32_bf16 v[132:135], a[196:199], a[16:19], v[132:135]
    s_barrier
    s_waitcnt vmcnt(10)
    v_mfma_f32_16x16x32_bf16 v[108:111], a[200:203], a[36:39], v[108:111]
    buffer_load_dwordx4 a[240:243], v11, s[4:7], s68 offen sc1
    s_waitcnt vmcnt(10)
    v_mfma_f32_16x16x32_bf16 v[108:111], a[204:207], a[52:55], v[108:111]
    ds_read2_b32 v[246:247], v27 offset0:1 offset1:33
    v_add_u32 v3, s32, v1
    v_mfma_f32_16x16x32_bf16 v[112:115], a[200:203], a[40:43], v[112:115]
    buffer_load_dwordx4 a[244:247], v11, s[4:7], s69 offen sc1
    ds_read2_b32 v[248:249], v27 offset0:65 offset1:97
    v_mfma_f32_16x16x32_bf16 v[112:115], a[204:207], a[56:59], v[112:115]
    v_mov_b32_dpp v243, v230 row_shr:8 row_mask:0x1 bank_mask:0x4
    s_nop 1
    v_mov_b32_dpp v243, v231 row_shr:12 row_mask:0x1 bank_mask:0x8
    v_mfma_f32_16x16x32_bf16 v[116:119], a[200:203], a[44:47], v[116:119]
    buffer_load_dwordx4 a[248:251], v11, s[4:7], s70 offen sc1
    v_cvt_pk_bf16_f32 v230, v230, v231
    v_mfma_f32_16x16x32_bf16 v[116:119], a[204:207], a[60:63], v[116:119]
    ds_write_b16 v29, v230 offset:1792
    v_mfma_f32_16x16x32_bf16 v[132:135], a[200:203], a[32:35], v[132:135]
    buffer_load_dwordx4 a[252:255], v11, s[4:7], s71 offen sc1
    v_add_u32 v6, 65536, v3
    v_mfma_f32_16x16x32_bf16 v[132:135], a[204:207], a[48:51], v[132:135]
    s_xor_b32 s32, s84, 3
    s_waitcnt vmcnt(12)
    v_mfma_f32_16x16x32_bf16 v[108:111], a[208:211], a[68:71], v[108:111]
    buffer_load_dwordx4 a[192:195], v11, s[4:7], s72 offen sc1
    s_waitcnt vmcnt(12)
    v_mfma_f32_16x16x32_bf16 v[108:111], a[212:215], a[84:87], v[108:111]
    ds_write_b16_d16_hi v29, v230 offset:1920
    v_mfma_f32_16x16x32_bf16 v[112:115], a[208:211], a[72:75], v[112:115]
    buffer_load_dwordx4 a[196:199], v11, s[4:7], s73 offen sc1
    s_waitcnt lgkmcnt(3)
    v_add_f32 v240, v240, v246
    v_mfma_f32_16x16x32_bf16 v[112:115], a[212:215], a[88:91], v[112:115]
    v_add_f32 v241, v241, v247
    v_cvt_pk_bf16_f32 v240, v240, v241
    v_mfma_f32_16x16x32_bf16 v[116:119], a[208:211], a[76:79], v[116:119]
    buffer_load_dwordx4 a[200:203], v11, s[4:7], s74 offen sc1
    s_mul_i32 s32, s32, 3072
    v_mfma_f32_16x16x32_bf16 v[116:119], a[212:215], a[92:95], v[116:119]
    s_mov_b64 exec, 0x7777
    ds_write_b16 v252, v240 offset:0
    ds_write_b16_d16_hi v252, v240 offset:512
    s_mov_b64 exec, -1
    v_mfma_f32_16x16x32_bf16 v[132:135], a[208:211], a[64:67], v[132:135]
    buffer_load_dwordx4 a[204:207], v11, s[4:7], s75 offen sc1
    ds_read_b128 v[216:219], v30 offset:0
    v_mfma_f32_16x16x32_bf16 v[132:135], a[212:215], a[80:83], v[132:135]
    s_waitcnt lgkmcnt(5)
    v_add_f32 v242, v242, v248
    s_waitcnt vmcnt(14)
    v_mfma_f32_16x16x32_bf16 v[108:111], a[216:219], a[100:103], v[108:111]
    v_add_f32 v243, v243, v249
    v_cvt_pk_bf16_f32 v242, v242, v243
    s_mov_b64 exec, 0x7777
    ds_write_b16 v252, v242 offset:1024
    ds_write_b16_d16_hi v252, v242 offset:1536
    s_mov_b64 exec, -1
    ds_read_b128 v[220:223], v30 offset:1024
    s_waitcnt vmcnt(13)
    v_mfma_f32_16x16x32_bf16 v[108:111], a[220:223], a[116:119], v[108:111]
    buffer_load_dwordx4 a[208:211], v11, s[4:7], s76 offen sc1
    s_add_u32 s32, s32, 2048
    v_mfma_f32_16x16x32_bf16 v[112:115], a[216:219], a[104:107], v[112:115]
    v_add_u32 v4, s32, v1
    v_add_u32 v7, 65536, v4
    v_mfma_f32_16x16x32_bf16 v[112:115], a[220:223], a[120:123], v[112:115]
    s_mul_i32 s32, s84, 3072
    v_add_u32 v8, s32, v1
    v_mfma_f32_16x16x32_bf16 v[116:119], a[216:219], a[108:111], v[116:119]
    v_add_u32 v9, 65536, v8
    v_mfma_f32_16x16x32_bf16 v[116:119], a[220:223], a[124:127], v[116:119]
    buffer_load_dwordx4 a[212:215], v11, s[4:7], s77 offen sc1
    v_mfma_f32_16x16x32_bf16 v[132:135], a[216:219], a[96:99], v[132:135]
    s_waitcnt lgkmcnt(3)
    buffer_store_dwordx4 v[216:219], v31, s[4:7], 0 offen sc1
    s_waitcnt lgkmcnt(0)
    buffer_store_dwordx4 v[220:223], v31, s[4:7], 0 offen offset:2048 sc1
    v_mfma_f32_16x16x32_bf16 v[132:135], a[220:223], a[112:115], v[132:135]
    s_waitcnt vmcnt(15)
    v_mfma_f32_16x16x32_bf16 v[108:111], a[224:227], a[132:135], v[108:111]
    s_waitcnt vmcnt(14)
    v_mfma_f32_16x16x32_bf16 v[108:111], a[228:231], a[148:151], v[108:111]
    buffer_load_dwordx4 a[216:219], v11, s[4:7], s78 offen sc1
    v_mfma_f32_16x16x32_bf16 v[112:115], a[224:227], a[136:139], v[112:115]
    v_xor_b32 v32, 64, v23
    v_mfma_f32_16x16x32_bf16 v[112:115], a[228:231], a[152:155], v[112:115]
    ds_read_b128 v[44:47], v23 offset:0
    v_add_u32 v220, 983040, v10
    v_mfma_f32_16x16x32_bf16 v[116:119], a[224:227], a[140:143], v[116:119]
    ds_read_b128 v[48:51], v32 offset:0
    v_add_u32 v221, 983040, v11
    v_mfma_f32_16x16x32_bf16 v[116:119], a[228:231], a[156:159], v[116:119]
    buffer_load_dwordx4 a[220:223], v11, s[4:7], s79 offen sc1
    ds_read_b128 v[52:55], v23 offset:2048
    v_mfma_f32_16x16x32_bf16 v[132:135], a[224:227], a[128:131], v[132:135]
    ds_read_b128 v[56:59], v32 offset:2048
    v_add_u32 v222, 983040, v12
    v_mfma_f32_16x16x32_bf16 v[132:135], a[228:231], a[144:147], v[132:135]
    ds_read_b128 v[60:63], v26 offset:4096
    s_waitcnt vmcnt(15)
    v_mfma_f32_16x16x32_bf16 v[108:111], a[232:235], a[164:167], v[108:111]
    v_subrev_u32 v23, 65536, v23
    s_waitcnt vmcnt(14)
    v_mfma_f32_16x16x32_bf16 v[108:111], a[236:239], a[180:183], v[108:111]
    buffer_load_dwordx4 a[224:227], v12, s[4:7], s68 offen sc1
    v_subrev_u32 v32, 65536, v32
    v_mfma_f32_16x16x32_bf16 v[112:115], a[232:235], a[168:171], v[112:115]
    v_subrev_u32 v26, 65536, v26
    s_sub_u32 s56, s56, 65536
    v_mfma_f32_16x16x32_bf16 v[112:115], a[236:239], a[184:187], v[112:115]
    v_add_u32 v33, s56, v1
    v_add_u32 v223, 983040, v13
    v_mfma_f32_16x16x32_bf16 v[116:119], a[232:235], a[172:175], v[116:119]
    v_add_u32 v224, 983040, v14
    v_add_u32 v35, 30720, v35
    v_mfma_f32_16x16x32_bf16 v[116:119], a[236:239], a[188:191], v[116:119]
    buffer_load_dwordx4 a[228:231], v12, s[4:7], s69 offen sc1
    v_lshrrev_b32 v42, 3, v0
    v_mfma_f32_16x16x32_bf16 v[132:135], a[232:235], a[160:163], v[132:135]
    v_lshl_add_u32 v42, s84, 3, v42
    v_and_b32 v43, 7, v0
    v_mfma_f32_16x16x32_bf16 v[132:135], a[236:239], a[176:179], v[132:135]
    v_lshlrev_b32 v43, 4, v43
    s_waitcnt vmcnt(15)
    v_mfma_f32_16x16x32_bf16 v[120:123], a[240:243], a[4:7], 0
    v_mul_u32_u24 v20, 4224, v42
    s_waitcnt vmcnt(14)
    v_mfma_f32_16x16x32_bf16 v[120:123], a[244:247], a[20:23], v[120:123]
    buffer_load_dwordx4 a[232:235], v12, s[4:7], s70 offen sc1
    v_add_u32 v20, v20, v43
    v_mfma_f32_16x16x32_bf16 v[124:127], a[240:243], a[8:11], 0
    ds_write_b128 v2, v[108:111] offset:0
    v_mfma_f32_16x16x32_bf16 v[124:127], a[244:247], a[24:27], v[124:127]
    ds_write_b128 v3, v[112:115] offset:0
    v_mfma_f32_16x16x32_bf16 v[128:131], a[240:243], a[12:15], 0
    v_mul_u32_u24 v42, 144, v42
    v_add_u32 v42, v42, v43
    v_mfma_f32_16x16x32_bf16 v[128:131], a[244:247], a[28:31], v[128:131]
    buffer_load_dwordx4 a[236:239], v12, s[4:7], s71 offen sc1
    v_add_u32 v21, 126976, v42
    v_mfma_f32_16x16x32_bf16 v[136:139], a[240:243], a[0:3], 0
    ds_write_b128 v4, v[116:119] offset:0
    v_mfma_f32_16x16x32_bf16 v[136:139], a[244:247], a[16:19], v[136:139]
    s_mul_i32 s32, s87, 540672
    s_waitcnt vmcnt(15)
    v_mfma_f32_16x16x32_bf16 v[120:123], a[248:251], a[36:39], v[120:123]
    s_lshl_b32 s33, s88, 7
    s_waitcnt vmcnt(14)
    v_mfma_f32_16x16x32_bf16 v[120:123], a[252:255], a[52:55], v[120:123]
    buffer_load_dwordx4 a[240:243], v12, s[4:7], s72 offen sc1
    s_add_u32 s32, s32, s33
    v_mfma_f32_16x16x32_bf16 v[124:127], a[248:251], a[40:43], v[124:127]
    s_add_u32 s32, s32, 10551296
    s_mul_i32 s33, s90, 135168
    v_mfma_f32_16x16x32_bf16 v[124:127], a[252:255], a[56:59], v[124:127]
    s_add_u32 s80, s32, s33
    s_sub_u32 s81, s32, s33
    v_mfma_f32_16x16x32_bf16 v[128:131], a[248:251], a[44:47], v[128:131]
    s_add_u32 s81, s81, 135168
    s_add_u32 s82, s80, 270336
    v_mfma_f32_16x16x32_bf16 v[128:131], a[252:255], a[60:63], v[128:131]
    buffer_load_dwordx4 a[244:247], v12, s[4:7], s73 offen sc1
    s_add_u32 s83, s81, 270336
    v_mfma_f32_16x16x32_bf16 v[136:139], a[248:251], a[32:35], v[136:139]
    s_mul_i32 s33, s87, 405504
    s_sub_u32 s31, s32, s33
    v_mfma_f32_16x16x32_bf16 v[136:139], a[252:255], a[48:51], v[136:139]
    s_add_u32 s31, s31, 2162688
    s_waitcnt vmcnt(15)
    v_mfma_f32_16x16x32_bf16 v[120:123], a[192:195], a[68:71], v[120:123]
    v_lshl_add_u32 v42, v37, 3, v39
    s_waitcnt vmcnt(14)
    v_mfma_f32_16x16x32_bf16 v[120:123], a[196:199], a[84:87], v[120:123]
    buffer_load_dwordx4 a[248:251], v12, s[4:7], s74 offen sc1
    v_mul_u32_u24 v42, 144, v42
    v_mfma_f32_16x16x32_bf16 v[124:127], a[192:195], a[72:75], v[124:127]
    s_lshl_b32 s32, s84, 5
    s_add_u32 s32, s32, 126976
    v_mfma_f32_16x16x32_bf16 v[124:127], a[196:199], a[88:91], v[124:127]
    v_lshl_add_u32 v22, v40, 3, s32
    v_add_u32 v22, v22, v42
    v_mfma_f32_16x16x32_bf16 v[128:131], a[192:195], a[76:79], v[128:131]
    s_lshl3_add_u32 s32, s87, s84
    s_lshl_b32 s32, s32, 2
    v_mfma_f32_16x16x32_bf16 v[128:131], a[196:199], a[92:95], v[128:131]
    buffer_load_dwordx4 a[252:255], v12, s[4:7], s75 offen sc1
    v_lshl_add_u32 v24, v39, 4, v40
    v_mfma_f32_16x16x32_bf16 v[136:139], a[192:195], a[64:67], v[136:139]
    v_add_u32 v24, s32, v24
    v_mul_u32_u24 v24, 128, v24
    v_mfma_f32_16x16x32_bf16 v[136:139], a[196:199], a[80:83], v[136:139]
    s_and_b32 s33, s88, 1
    s_waitcnt vmcnt(15)
    v_mfma_f32_16x16x32_bf16 v[120:123], a[200:203], a[100:103], v[120:123]
    s_lshl_b32 s33, s33, 3
    s_waitcnt vmcnt(14)
    v_mfma_f32_16x16x32_bf16 v[120:123], a[204:207], a[116:119], v[120:123]
    buffer_load_dwordx4 a[192:195], v12, s[4:7], s76 offen sc1
    s_add_u32 s33, s33, 10158080
    v_mfma_f32_16x16x32_bf16 v[124:127], a[200:203], a[104:107], v[124:127]
    v_add_u32 v24, s33, v24
    s_lshl2_add_u32 s32, s87, s84
    v_mfma_f32_16x16x32_bf16 v[124:127], a[204:207], a[120:123], v[124:127]
    v_and_b32 v42, 7, v0
    v_lshl_add_u32 v225, s32, 3, v42
    v_mfma_f32_16x16x32_bf16 v[128:131], a[200:203], a[108:111], v[128:131]
    v_mul_u32_u24 v225, 128, v225
    s_and_b32 s33, s88, 3
    v_mfma_f32_16x16x32_bf16 v[128:131], a[204:207], a[124:127], v[128:131]
    buffer_load_dwordx4 a[196:199], v12, s[4:7], s77 offen sc1
    s_lshl_b32 s33, s33, 2
    v_mfma_f32_16x16x32_bf16 v[136:139], a[200:203], a[96:99], v[136:139]
    s_add_u32 s33, s33, 10174480
    v_add_u32 v225, s33, v225
    v_mfma_f32_16x16x32_bf16 v[136:139], a[204:207], a[112:115], v[136:139]
    s_lshl2_add_u32 s32, s88, s84
    s_waitcnt vmcnt(15)
    v_mfma_f32_16x16x32_bf16 v[120:123], a[208:211], a[132:135], v[120:123]
    s_waitcnt vmcnt(12)
    v_mfma_f32_16x16x32_bf16 v[120:123], a[212:215], a[148:151], v[120:123]
    buffer_load_dwordx4 a[200:203], v12, s[4:7], s78 offen sc1
    s_mov_b64 exec, 1
    buffer_store_dword v34, v0, s[4:7], s95 offen sc1
    s_mov_b64 exec, -1
    v_mfma_f32_16x16x32_bf16 v[124:127], a[208:211], a[136:139], v[124:127]
    v_lshl_add_u32 v42, s32, 4, v38
    v_mul_u32_u24 v42, 1280, v42
    v_mfma_f32_16x16x32_bf16 v[124:127], a[212:215], a[152:155], v[124:127]
    v_lshl_add_u32 v42, v37, 4, v42
    v_lshl_add_u32 v30, s87, 6, v42
    v_mfma_f32_16x16x32_bf16 v[128:131], a[208:211], a[140:143], v[128:131]
    s_lshl2_add_u32 s32, s87, s90
    v_lshl_add_u32 v25, s32, 6, v42
    v_mfma_f32_16x16x32_bf16 v[128:131], a[212:215], a[156:159], v[128:131]
    buffer_load_dwordx4 a[204:207], v12, s[4:7], s79 offen sc1
    v_xor_b32 v27, 64, v25
    v_mfma_f32_16x16x32_bf16 v[136:139], a[208:211], a[128:131], v[136:139]
    v_lshlrev_b32 v17, 16, v17
    v_sub_f32 v28, 1.0, v16
    v_mfma_f32_16x16x32_bf16 v[136:139], a[212:215], a[144:147], v[136:139]
    v_mul_f32 v17, v17, v28
    s_waitcnt vmcnt(14)
    v_mfma_f32_16x16x32_bf16 v[120:123], a[216:219], a[164:167], v[120:123]
    s_waitcnt lgkmcnt(7)
    v_lshlrev_b32 v228, 16, v44
    s_waitcnt vmcnt(13)
    v_mfma_f32_16x16x32_bf16 v[120:123], a[220:223], a[180:183], v[120:123]
    buffer_load_dwordx4 a[208:211], v13, s[4:7], s68 offen sc1
    v_and_b32 v229, 0xffff0000, v44
    v_mfma_f32_16x16x32_bf16 v[124:127], a[216:219], a[168:171], v[124:127]
    v_mul_f32 v228, v228, v16
    v_mul_f32 v229, v229, v16
    v_mfma_f32_16x16x32_bf16 v[124:127], a[220:223], a[184:187], v[124:127]
    v_lshlrev_b32 v230, 16, v45
    v_and_b32 v231, 0xffff0000, v45
    v_mfma_f32_16x16x32_bf16 v[128:131], a[216:219], a[172:175], v[128:131]
    v_mul_f32 v230, v230, v16
    v_mul_f32 v231, v231, v16
    v_mfma_f32_16x16x32_bf16 v[128:131], a[220:223], a[188:191], v[128:131]
    buffer_load_dwordx4 a[212:215], v13, s[4:7], s69 offen sc1
    v_lshlrev_b32 v232, 16, v46
    v_mfma_f32_16x16x32_bf16 v[136:139], a[216:219], a[160:163], v[136:139]
    v_and_b32 v233, 0xffff0000, v46
    v_mul_f32 v232, v232, v16
    v_mfma_f32_16x16x32_bf16 v[136:139], a[220:223], a[176:179], v[136:139]
    v_mul_f32 v233, v233, v16
    s_waitcnt vmcnt(14)
    v_mfma_f32_16x16x32_bf16 v[108:111], a[224:227], a[4:7], 0
    v_lshlrev_b32 v234, 16, v47
    s_waitcnt vmcnt(13)
    v_mfma_f32_16x16x32_bf16 v[108:111], a[228:231], a[20:23], v[108:111]
    buffer_load_dwordx4 a[216:219], v13, s[4:7], s70 offen sc1
    v_and_b32 v235, 0xffff0000, v47
    v_mfma_f32_16x16x32_bf16 v[112:115], a[224:227], a[8:11], 0
    ds_write_b128 v2, v[120:123] offset:12288
    v_mfma_f32_16x16x32_bf16 v[112:115], a[228:231], a[24:27], v[112:115]
    ds_write_b128 v3, v[124:127] offset:12288
    v_mfma_f32_16x16x32_bf16 v[116:119], a[224:227], a[12:15], 0
    v_mul_f32 v234, v234, v16
    v_mul_f32 v235, v235, v16
    v_mfma_f32_16x16x32_bf16 v[116:119], a[228:231], a[28:31], v[116:119]
    buffer_load_dwordx4 a[220:223], v13, s[4:7], s71 offen sc1
    s_waitcnt lgkmcnt(8)
    v_lshlrev_b32 v236, 16, v48
    v_mfma_f32_16x16x32_bf16 v[140:143], a[224:227], a[0:3], 0
    ds_write_b128 v4, v[128:131] offset:12288
    v_mfma_f32_16x16x32_bf16 v[140:143], a[228:231], a[16:19], v[140:143]
    v_and_b32 v237, 0xffff0000, v48
    s_waitcnt vmcnt(14)
    v_mfma_f32_16x16x32_bf16 v[108:111], a[232:235], a[36:39], v[108:111]
    v_mul_f32 v236, v236, v16
    s_waitcnt vmcnt(13)
    v_mfma_f32_16x16x32_bf16 v[108:111], a[236:239], a[52:55], v[108:111]
    buffer_load_dwordx4 a[224:227], v13, s[4:7], s72 offen sc1
    v_mul_f32 v237, v237, v16
    v_mfma_f32_16x16x32_bf16 v[112:115], a[232:235], a[40:43], v[112:115]
    v_lshlrev_b32 v238, 16, v49
    v_and_b32 v239, 0xffff0000, v49
    v_mfma_f32_16x16x32_bf16 v[112:115], a[236:239], a[56:59], v[112:115]
    v_mul_f32 v238, v238, v16
    v_mul_f32 v239, v239, v16
    v_mfma_f32_16x16x32_bf16 v[116:119], a[232:235], a[44:47], v[116:119]
    v_lshlrev_b32 v240, 16, v50
    v_and_b32 v241, 0xffff0000, v50
    v_mfma_f32_16x16x32_bf16 v[116:119], a[236:239], a[60:63], v[116:119]
    buffer_load_dwordx4 a[228:231], v13, s[4:7], s73 offen sc1
    v_mul_f32 v240, v240, v16
    v_mfma_f32_16x16x32_bf16 v[140:143], a[232:235], a[32:35], v[140:143]
    v_mul_f32 v241, v241, v16
    v_lshlrev_b32 v242, 16, v51
    v_mfma_f32_16x16x32_bf16 v[140:143], a[236:239], a[48:51], v[140:143]
    v_and_b32 v243, 0xffff0000, v51
    s_waitcnt vmcnt(14)
    v_mfma_f32_16x16x32_bf16 v[108:111], a[240:243], a[68:71], v[108:111]
    v_mul_f32 v242, v242, v16
    s_waitcnt vmcnt(13)
    v_mfma_f32_16x16x32_bf16 v[108:111], a[244:247], a[84:87], v[108:111]
    buffer_load_dwordx4 a[232:235], v13, s[4:7], s74 offen sc1
    v_mul_f32 v243, v243, v16
    v_mfma_f32_16x16x32_bf16 v[112:115], a[240:243], a[72:75], v[112:115]
    s_waitcnt lgkmcnt(8)
    v_lshlrev_b32 v244, 16, v52
    v_and_b32 v245, 0xffff0000, v52
    v_mfma_f32_16x16x32_bf16 v[112:115], a[244:247], a[88:91], v[112:115]
    v_mul_f32 v244, v244, v16
    v_mul_f32 v245, v245, v16
    v_mfma_f32_16x16x32_bf16 v[116:119], a[240:243], a[76:79], v[116:119]
    v_lshlrev_b32 v246, 16, v53
    v_and_b32 v247, 0xffff0000, v53
    v_mfma_f32_16x16x32_bf16 v[116:119], a[244:247], a[92:95], v[116:119]
    buffer_load_dwordx4 a[236:239], v13, s[4:7], s75 offen sc1
    v_mul_f32 v246, v246, v16
    v_mfma_f32_16x16x32_bf16 v[140:143], a[240:243], a[64:67], v[140:143]
    v_mul_f32 v247, v247, v16
    v_lshlrev_b32 v248, 16, v54
    v_mfma_f32_16x16x32_bf16 v[140:143], a[244:247], a[80:83], v[140:143]
    v_and_b32 v249, 0xffff0000, v54
    s_waitcnt vmcnt(14)
    v_mfma_f32_16x16x32_bf16 v[108:111], a[248:251], a[100:103], v[108:111]
    v_mul_f32 v248, v248, v16
    s_waitcnt vmcnt(13)
    v_mfma_f32_16x16x32_bf16 v[108:111], a[252:255], a[116:119], v[108:111]
    buffer_load_dwordx4 a[240:243], v13, s[4:7], s76 offen sc1
    v_mul_f32 v249, v249, v16
    v_mfma_f32_16x16x32_bf16 v[112:115], a[248:251], a[104:107], v[112:115]
    v_lshlrev_b32 v250, 16, v55
    v_and_b32 v251, 0xffff0000, v55
    v_mfma_f32_16x16x32_bf16 v[112:115], a[252:255], a[120:123], v[112:115]
    v_mul_f32 v250, v250, v16
    v_mul_f32 v251, v251, v16
    v_mfma_f32_16x16x32_bf16 v[116:119], a[248:251], a[108:111], v[116:119]
    v_mfma_f32_16x16x32_bf16 v[116:119], a[252:255], a[124:127], v[116:119]
    buffer_load_dwordx4 a[244:247], v13, s[4:7], s77 offen sc1
    v_mfma_f32_16x16x32_bf16 v[140:143], a[248:251], a[96:99], v[140:143]
    v_mfma_f32_16x16x32_bf16 v[140:143], a[252:255], a[112:115], v[140:143]
    s_waitcnt vmcnt(14)
    v_mfma_f32_16x16x32_bf16 v[108:111], a[192:195], a[132:135], v[108:111]
    s_waitcnt vmcnt(13)
    v_mfma_f32_16x16x32_bf16 v[108:111], a[196:199], a[148:151], v[108:111]
    buffer_load_dwordx4 a[248:251], v13, s[4:7], s78 offen sc1
    v_mfma_f32_16x16x32_bf16 v[112:115], a[192:195], a[136:139], v[112:115]
    v_mfma_f32_16x16x32_bf16 v[112:115], a[196:199], a[152:155], v[112:115]
    v_mfma_f32_16x16x32_bf16 v[116:119], a[192:195], a[140:143], v[116:119]
    v_mfma_f32_16x16x32_bf16 v[116:119], a[196:199], a[156:159], v[116:119]
    buffer_load_dwordx4 a[252:255], v13, s[4:7], s79 offen sc1
    v_mfma_f32_16x16x32_bf16 v[140:143], a[192:195], a[128:131], v[140:143]
    v_mfma_f32_16x16x32_bf16 v[140:143], a[196:199], a[144:147], v[140:143]
    s_waitcnt vmcnt(14)
    v_mfma_f32_16x16x32_bf16 v[108:111], a[200:203], a[164:167], v[108:111]
    s_waitcnt vmcnt(12)
    v_mfma_f32_16x16x32_bf16 v[108:111], a[204:207], a[180:183], v[108:111]
    buffer_load_dwordx4 a[192:195], v14, s[4:7], s68 offen sc1
    v_mfma_f32_16x16x32_bf16 v[112:115], a[200:203], a[168:171], v[112:115]
    v_mfma_f32_16x16x32_bf16 v[112:115], a[204:207], a[184:187], v[112:115]
    v_mfma_f32_16x16x32_bf16 v[116:119], a[200:203], a[172:175], v[116:119]
    v_mfma_f32_16x16x32_bf16 v[116:119], a[204:207], a[188:191], v[116:119]
    buffer_load_dwordx4 a[196:199], v14, s[4:7], s69 offen sc1
    v_mfma_f32_16x16x32_bf16 v[140:143], a[200:203], a[160:163], v[140:143]
    v_mfma_f32_16x16x32_bf16 v[140:143], a[204:207], a[176:179], v[140:143]
    s_waitcnt vmcnt(13)
    v_mfma_f32_16x16x32_bf16 v[120:123], a[208:211], a[4:7], 0
    s_waitcnt vmcnt(12)
    v_mfma_f32_16x16x32_bf16 v[120:123], a[212:215], a[20:23], v[120:123]
    buffer_load_dwordx4 a[200:203], v14, s[4:7], s70 offen sc1
    v_mfma_f32_16x16x32_bf16 v[124:127], a[208:211], a[8:11], 0
    ds_write_b128 v2, v[108:111] offset:24576
    v_mfma_f32_16x16x32_bf16 v[124:127], a[212:215], a[24:27], v[124:127]
    ds_write_b128 v3, v[112:115] offset:24576
    v_mfma_f32_16x16x32_bf16 v[128:131], a[208:211], a[12:15], 0
    v_mfma_f32_16x16x32_bf16 v[128:131], a[212:215], a[28:31], v[128:131]
    buffer_load_dwordx4 a[204:207], v14, s[4:7], s71 offen sc1
    v_mfma_f32_16x16x32_bf16 v[144:147], a[208:211], a[0:3], 0
    ds_write_b128 v4, v[116:119] offset:24576
    v_mfma_f32_16x16x32_bf16 v[144:147], a[212:215], a[16:19], v[144:147]
    s_waitcnt vmcnt(13)
    v_mfma_f32_16x16x32_bf16 v[120:123], a[216:219], a[36:39], v[120:123]
    s_waitcnt vmcnt(12)
    v_mfma_f32_16x16x32_bf16 v[120:123], a[220:223], a[52:55], v[120:123]
    buffer_load_dwordx4 a[208:211], v14, s[4:7], s72 offen sc1
    v_mfma_f32_16x16x32_bf16 v[124:127], a[216:219], a[40:43], v[124:127]
    v_mfma_f32_16x16x32_bf16 v[124:127], a[220:223], a[56:59], v[124:127]
    v_mfma_f32_16x16x32_bf16 v[128:131], a[216:219], a[44:47], v[128:131]
    v_mfma_f32_16x16x32_bf16 v[128:131], a[220:223], a[60:63], v[128:131]
    buffer_load_dwordx4 a[212:215], v14, s[4:7], s73 offen sc1
    v_mfma_f32_16x16x32_bf16 v[144:147], a[216:219], a[32:35], v[144:147]
    v_mfma_f32_16x16x32_bf16 v[144:147], a[220:223], a[48:51], v[144:147]
    s_waitcnt vmcnt(13)
    v_mfma_f32_16x16x32_bf16 v[120:123], a[224:227], a[68:71], v[120:123]
    s_waitcnt vmcnt(12)
    v_mfma_f32_16x16x32_bf16 v[120:123], a[228:231], a[84:87], v[120:123]
    buffer_load_dwordx4 a[216:219], v14, s[4:7], s74 offen sc1
    v_mfma_f32_16x16x32_bf16 v[124:127], a[224:227], a[72:75], v[124:127]
    v_mfma_f32_16x16x32_bf16 v[124:127], a[228:231], a[88:91], v[124:127]
    v_mfma_f32_16x16x32_bf16 v[128:131], a[224:227], a[76:79], v[128:131]
    v_mfma_f32_16x16x32_bf16 v[128:131], a[228:231], a[92:95], v[128:131]
    buffer_load_dwordx4 a[220:223], v14, s[4:7], s75 offen sc1
    v_mfma_f32_16x16x32_bf16 v[144:147], a[224:227], a[64:67], v[144:147]
    s_mov_b64 exec, 0x3fffffff
    buffer_load_dword v18, v35, s[4:7], 0 offen sc1
    s_mov_b64 exec, -1
    v_mfma_f32_16x16x32_bf16 v[144:147], a[228:231], a[80:83], v[144:147]
    s_mov_b64 exec, 0xff
    buffer_load_dwordx2 v[226:227], v24, s[4:7], 0 offen sc1
    s_mov_b64 exec, -1
    s_waitcnt vmcnt(15)
    v_mfma_f32_16x16x32_bf16 v[120:123], a[232:235], a[100:103], v[120:123]
    s_waitcnt vmcnt(14)
    v_mfma_f32_16x16x32_bf16 v[120:123], a[236:239], a[116:119], v[120:123]
    buffer_load_dwordx4 a[224:227], v14, s[4:7], s76 offen sc1
    v_mfma_f32_16x16x32_bf16 v[124:127], a[232:235], a[104:107], v[124:127]
    v_mfma_f32_16x16x32_bf16 v[124:127], a[236:239], a[120:123], v[124:127]
    v_mfma_f32_16x16x32_bf16 v[128:131], a[232:235], a[108:111], v[128:131]
    v_mfma_f32_16x16x32_bf16 v[128:131], a[236:239], a[124:127], v[128:131]
    buffer_load_dwordx4 a[228:231], v14, s[4:7], s77 offen sc1
    v_mfma_f32_16x16x32_bf16 v[144:147], a[232:235], a[96:99], v[144:147]
    v_mfma_f32_16x16x32_bf16 v[144:147], a[236:239], a[112:115], v[144:147]
    s_waitcnt vmcnt(15)
    v_mfma_f32_16x16x32_bf16 v[120:123], a[240:243], a[132:135], v[120:123]
    s_waitcnt vmcnt(14)
    v_mfma_f32_16x16x32_bf16 v[120:123], a[244:247], a[148:151], v[120:123]
    buffer_load_dwordx4 a[232:235], v14, s[4:7], s78 offen sc1
    v_mfma_f32_16x16x32_bf16 v[124:127], a[240:243], a[136:139], v[124:127]
    v_mfma_f32_16x16x32_bf16 v[124:127], a[244:247], a[152:155], v[124:127]
    v_mfma_f32_16x16x32_bf16 v[128:131], a[240:243], a[140:143], v[128:131]
    v_mfma_f32_16x16x32_bf16 v[128:131], a[244:247], a[156:159], v[128:131]
    buffer_load_dwordx4 a[236:239], v14, s[4:7], s79 offen sc1
    v_mfma_f32_16x16x32_bf16 v[144:147], a[240:243], a[128:131], v[144:147]
    v_mfma_f32_16x16x32_bf16 v[144:147], a[244:247], a[144:147], v[144:147]
    s_waitcnt vmcnt(15)
    v_mfma_f32_16x16x32_bf16 v[120:123], a[248:251], a[164:167], v[120:123]
    s_waitcnt vmcnt(14)
    v_mfma_f32_16x16x32_bf16 v[120:123], a[252:255], a[180:183], v[120:123]
    v_mfma_f32_16x16x32_bf16 v[124:127], a[248:251], a[168:171], v[124:127]
    v_mfma_f32_16x16x32_bf16 v[124:127], a[252:255], a[184:187], v[124:127]
    v_mfma_f32_16x16x32_bf16 v[128:131], a[248:251], a[172:175], v[128:131]
    v_mfma_f32_16x16x32_bf16 v[128:131], a[252:255], a[188:191], v[128:131]
    v_mfma_f32_16x16x32_bf16 v[144:147], a[248:251], a[160:163], v[144:147]
    v_mfma_f32_16x16x32_bf16 v[144:147], a[252:255], a[176:179], v[144:147]
    s_waitcnt vmcnt(13)
    v_mfma_f32_16x16x32_bf16 v[108:111], a[192:195], a[4:7], 0
    s_waitcnt vmcnt(12)
    v_mfma_f32_16x16x32_bf16 v[108:111], a[196:199], a[20:23], v[108:111]
    ds_write_b128 v2, v[120:123] offset:36864
    v_mfma_f32_16x16x32_bf16 v[112:115], a[192:195], a[8:11], 0
    v_mfma_f32_16x16x32_bf16 v[112:115], a[196:199], a[24:27], v[112:115]
    ds_write_b128 v3, v[124:127] offset:36864
    v_mfma_f32_16x16x32_bf16 v[116:119], a[192:195], a[12:15], 0
    v_mfma_f32_16x16x32_bf16 v[116:119], a[196:199], a[28:31], v[116:119]
    v_mfma_f32_16x16x32_bf16 v[148:151], a[192:195], a[0:3], 0
    ds_write_b128 v4, v[128:131] offset:36864
    v_mfma_f32_16x16x32_bf16 v[148:151], a[196:199], a[16:19], v[148:151]
    s_waitcnt vmcnt(11)
    v_mfma_f32_16x16x32_bf16 v[108:111], a[200:203], a[36:39], v[108:111]
    s_waitcnt vmcnt(10)
    v_mfma_f32_16x16x32_bf16 v[108:111], a[204:207], a[52:55], v[108:111]
    v_mfma_f32_16x16x32_bf16 v[112:115], a[200:203], a[40:43], v[112:115]
    v_mfma_f32_16x16x32_bf16 v[112:115], a[204:207], a[56:59], v[112:115]
    s_waitcnt lgkmcnt(0)
    s_barrier
    v_mfma_f32_16x16x32_bf16 v[116:119], a[200:203], a[44:47], v[116:119]
    v_mfma_f32_16x16x32_bf16 v[116:119], a[204:207], a[60:63], v[116:119]
    ds_read_b128 v[172:175], v8 offset:0
    v_mfma_f32_16x16x32_bf16 v[148:151], a[200:203], a[32:35], v[148:151]
    ds_read_b128 v[176:179], v8 offset:1024
    v_mfma_f32_16x16x32_bf16 v[148:151], a[204:207], a[48:51], v[148:151]
    ds_read_b128 v[180:183], v8 offset:2048
    s_waitcnt vmcnt(9)
    v_mfma_f32_16x16x32_bf16 v[108:111], a[208:211], a[68:71], v[108:111]
    ds_read_b128 v[184:187], v8 offset:12288
    s_waitcnt vmcnt(8)
    v_mfma_f32_16x16x32_bf16 v[108:111], a[212:215], a[84:87], v[108:111]
    ds_read_b128 v[188:191], v8 offset:13312
    v_mfma_f32_16x16x32_bf16 v[112:115], a[208:211], a[72:75], v[112:115]
    ds_read_b128 v[192:195], v8 offset:14336
    v_mfma_f32_16x16x32_bf16 v[112:115], a[212:215], a[88:91], v[112:115]
    s_mov_b64 exec, 0x3fffffff
    s_waitcnt vmcnt(5)
    v_cmp_ne_u32 vcc, s91, v18
    s_mov_b32 s3, 0
    s_cbranch_vccz L_pk_Bfu1
L_pl_Bfu1:
    s_mov_b64 exec, vcc
    buffer_load_dword v18, v35, s[4:7], 0 offen sc1
    s_add_u32 s3, s3, 1
    s_cmp_ge_u32 s3, 0x40000
    s_cbranch_scc1 L_pk_Bfu1
    s_waitcnt vmcnt(0)
    v_cmp_ne_u32 vcc, s91, v18
    s_nop 0
    s_cbranch_vccnz L_pl_Bfu1
L_pk_Bfu1:
    s_mov_b64 exec, -1
    buffer_load_dwordx4 a[240:243], v220, s[4:7], s68 offen sc1
    v_mfma_f32_16x16x32_bf16 v[116:119], a[208:211], a[76:79], v[116:119]
    ds_read_b128 v[196:199], v8 offset:24576
    v_mfma_f32_16x16x32_bf16 v[116:119], a[212:215], a[92:95], v[116:119]
    buffer_load_dwordx4 a[244:247], v220, s[4:7], s69 offen sc1
    ds_read_b128 v[200:203], v8 offset:25600
    v_mfma_f32_16x16x32_bf16 v[148:151], a[208:211], a[64:67], v[148:151]
    s_mov_b64 exec, 0xff
    s_waitcnt vmcnt(6)
    v_xor_b32 v226, s91, v226
    v_bitop3_b32 v226, v226, v227, v34 bitop3:0xf6
    v_cmp_ne_u32 vcc, 0, v226
    s_mov_b32 s3, 0
    s_cbranch_vccz L_pk_Bfz0
L_pl_Bfz0:
    s_mov_b64 exec, vcc
    buffer_load_dwordx2 v[226:227], v24, s[4:7], 0 offen sc1
    s_add_u32 s3, s3, 1
    s_cmp_ge_u32 s3, 0x40000
    s_cbranch_scc1 L_pk_Bfz0
    s_waitcnt vmcnt(0)
    v_xor_b32 v226, s91, v226
    v_bitop3_b32 v226, v226, v227, v34 bitop3:0xf6
    v_cmp_ne_u32 vcc, 0, v226
    s_nop 0
    s_cbranch_vccnz L_pl_Bfz0
L_pk_Bfz0:
    s_mov_b64 exec, -1
    v_mfma_f32_16x16x32_bf16 v[148:151], a[212:215], a[80:83], v[148:151]
    buffer_load_dwordx4 a[248:251], v220, s[4:7], s70 offen sc1
    v_mfma_f32_16x16x32_bf16 v[108:111], a[216:219], a[100:103], v[108:111]
    ds_read_b128 v[204:207], v8 offset:26624
    v_mfma_f32_16x16x32_bf16 v[108:111], a[220:223], a[116:119], v[108:111]
    buffer_load_dwordx4 a[252:255], v220, s[4:7], s71 offen sc1
    s_waitcnt lgkmcnt(8)
    v_add_f32 v132, v132, v172
    v_mfma_f32_16x16x32_bf16 v[112:115], a[216:219], a[104:107], v[112:115]
    buffer_load_dwordx4 v[64:67], v20, s[4:7], s80 offen sc1
    v_add_f32 v133, v133, v173
    v_mfma_f32_16x16x32_bf16 v[112:115], a[220:223], a[120:123], v[112:115]
    buffer_load_dwordx4 a[192:195], v220, s[4:7], s72 offen sc1
    v_add_f32 v134, v134, v174
    v_mfma_f32_16x16x32_bf16 v[116:119], a[216:219], a[108:111], v[116:119]
    buffer_load_dwordx4 v[68:71], v20, s[4:7], s81 offen sc1
    v_add_f32 v135, v135, v175
    v_mfma_f32_16x16x32_bf16 v[116:119], a[220:223], a[124:127], v[116:119]
    buffer_load_dwordx4 a[196:199], v220, s[4:7], s73 offen sc1
    s_waitcnt lgkmcnt(7)
    v_add_f32 v132, v132, v176
    v_mfma_f32_16x16x32_bf16 v[148:151], a[216:219], a[96:99], v[148:151]
    v_add_u32 v24, 16384, v24
    v_add_f32 v133, v133, v177
    v_mfma_f32_16x16x32_bf16 v[148:151], a[220:223], a[112:115], v[148:151]
    buffer_load_dwordx4 a[200:203], v220, s[4:7], s74 offen sc1
    s_waitcnt vmcnt(12)
    v_mfma_f32_16x16x32_bf16 v[108:111], a[224:227], a[132:135], v[108:111]
    v_add_f32 v134, v134, v178
    s_waitcnt vmcnt(11)
    v_mfma_f32_16x16x32_bf16 v[108:111], a[228:231], a[148:151], v[108:111]
    buffer_load_dwordx4 a[204:207], v220, s[4:7], s75 offen sc1
    v_add_f32 v135, v135, v179
    v_mfma_f32_16x16x32_bf16 v[112:115], a[224:227], a[136:139], v[112:115]
    s_waitcnt lgkmcnt(6)
    v_add_f32 v132, v132, v180
    v_add_f32 v133, v133, v181
    v_mfma_f32_16x16x32_bf16 v[112:115], a[228:231], a[152:155], v[112:115]
    buffer_load_dwordx4 a[208:211], v220, s[4:7], s76 offen sc1
    v_add_f32 v134, v134, v182
    v_mfma_f32_16x16x32_bf16 v[116:119], a[224:227], a[140:143], v[116:119]
    v_add_f32 v135, v135, v183
    ds_read_b128 v[172:175], v8 offset:36864
    v_mfma_f32_16x16x32_bf16 v[116:119], a[228:231], a[156:159], v[116:119]
    buffer_load_dwordx4 a[212:215], v220, s[4:7], s77 offen sc1
    ds_read_b128 v[176:179], v8 offset:37888
    v_mfma_f32_16x16x32_bf16 v[148:151], a[224:227], a[128:131], v[148:151]
    ds_read_b128 v[180:183], v8 offset:38912
    v_fma_f32 v132, v132, v28, v17
    v_mfma_f32_16x16x32_bf16 v[148:151], a[228:231], a[144:147], v[148:151]
    buffer_load_dwordx4 a[216:219], v220, s[4:7], s78 offen sc1
    s_waitcnt vmcnt(14)
    v_mfma_f32_16x16x32_bf16 v[108:111], a[232:235], a[164:167], v[108:111]
    v_fma_f32 v133, v133, v28, v17
    s_waitcnt vmcnt(13)
    v_mfma_f32_16x16x32_bf16 v[108:111], a[236:239], a[180:183], v[108:111]
    buffer_load_dwordx4 a[220:223], v220, s[4:7], s79 offen sc1
    v_fma_f32 v134, v134, v28, v17
    v_mfma_f32_16x16x32_bf16 v[112:115], a[232:235], a[168:171], v[112:115]
    v_fma_f32 v135, v135, v28, v17
    s_waitcnt lgkmcnt(8)
    v_add_f32 v136, v136, v184
    v_mfma_f32_16x16x32_bf16 v[112:115], a[236:239], a[184:187], v[112:115]
    buffer_load_dwordx4 a[224:227], v221, s[4:7], s68 offen sc1
    v_add_f32 v137, v137, v185
    v_mfma_f32_16x16x32_bf16 v[116:119], a[232:235], a[172:175], v[116:119]
    v_add_f32 v138, v138, v186
    v_add_f32 v139, v139, v187
    v_mfma_f32_16x16x32_bf16 v[116:119], a[236:239], a[188:191], v[116:119]
    buffer_load_dwordx4 a[228:231], v221, s[4:7], s69 offen sc1
    s_waitcnt lgkmcnt(7)
    v_add_f32 v136, v136, v188
    v_mfma_f32_16x16x32_bf16 v[148:151], a[232:235], a[160:163], v[148:151]
    v_add_f32 v137, v137, v189
    v_add_f32 v138, v138, v190
    v_mfma_f32_16x16x32_bf16 v[148:151], a[236:239], a[176:179], v[148:151]
    v_add_f32 v139, v139, v191
    s_waitcnt vmcnt(15)
    v_mfma_f32_16x16x32_bf16 v[120:123], a[240:243], a[4:7], 0
    s_waitcnt lgkmcnt(6)
    v_add_f32 v136, v136, v192
    s_waitcnt vmcnt(14)
    v_mfma_f32_16x16x32_bf16 v[120:123], a[244:247], a[20:23], v[120:123]
    buffer_load_dwordx4 a[232:235], v221, s[4:7], s70 offen sc1
    v_add_f32 v137, v137, v193
    v_mfma_f32_16x16x32_bf16 v[124:127], a[240:243], a[8:11], 0
    ds_write_b128 v2, v[108:111] offset:49152
    v_mfma_f32_16x16x32_bf16 v[124:127], a[244:247], a[24:27], v[124:127]
    ds_write_b128 v3, v[112:115] offset:49152
    v_mfma_f32_16x16x32_bf16 v[128:131], a[240:243], a[12:15], 0
    v_add_f32 v138, v138, v194
    v_add_f32 v139, v139, v195
    v_mfma_f32_16x16x32_bf16 v[128:131], a[244:247], a[28:31], v[128:131]
    buffer_load_dwordx4 a[236:239], v221, s[4:7], s71 offen sc1
    v_fma_f32 v136, v136, v28, v17
    v_mfma_f32_16x16x32_bf16 v[152:155], a[240:243], a[0:3], 0
    ds_write_b128 v4, v[116:119] offset:49152
    v_mfma_f32_16x16x32_bf16 v[152:155], a[244:247], a[16:19], v[152:155]
    v_fma_f32 v137, v137, v28, v17
    s_waitcnt vmcnt(15)
    v_mfma_f32_16x16x32_bf16 v[120:123], a[248:251], a[36:39], v[120:123]
    v_fma_f32 v138, v138, v28, v17
    s_waitcnt vmcnt(14)
    v_mfma_f32_16x16x32_bf16 v[120:123], a[252:255], a[52:55], v[120:123]
    buffer_load_dwordx4 a[240:243], v221, s[4:7], s72 offen sc1
    v_fma_f32 v139, v139, v28, v17
    v_mfma_f32_16x16x32_bf16 v[124:127], a[248:251], a[40:43], v[124:127]
    s_waitcnt lgkmcnt(8)
    v_add_f32 v140, v140, v196
    v_add_f32 v141, v141, v197
    v_mfma_f32_16x16x32_bf16 v[124:127], a[252:255], a[56:59], v[124:127]
    v_add_f32 v142, v142, v198
    v_add_f32 v143, v143, v199
    v_mfma_f32_16x16x32_bf16 v[128:131], a[248:251], a[44:47], v[128:131]
    s_waitcnt lgkmcnt(7)
    v_add_f32 v140, v140, v200
    v_add_f32 v141, v141, v201
    v_mfma_f32_16x16x32_bf16 v[128:131], a[252:255], a[60:63], v[128:131]
    buffer_load_dwordx4 a[244:247], v221, s[4:7], s73 offen sc1
    v_add_f32 v142, v142, v202
    v_mfma_f32_16x16x32_bf16 v[152:155], a[248:251], a[32:35], v[152:155]
    v_add_f32 v143, v143, v203
    s_waitcnt lgkmcnt(6)
    v_add_f32 v140, v140, v204
    v_mfma_f32_16x16x32_bf16 v[152:155], a[252:255], a[48:51], v[152:155]
    v_add_f32 v141, v141, v205
    s_waitcnt vmcnt(14)
    v_mfma_f32_16x16x32_bf16 v[120:123], a[192:195], a[68:71], v[120:123]
    v_add_f32 v142, v142, v206
    s_waitcnt vmcnt(12)
    v_mfma_f32_16x16x32_bf16 v[120:123], a[196:199], a[84:87], v[120:123]
    buffer_load_dwordx4 a[248:251], v221, s[4:7], s74 offen sc1
    v_add_f32 v143, v143, v207
    v_mfma_f32_16x16x32_bf16 v[124:127], a[192:195], a[72:75], v[124:127]
    v_fma_f32 v140, v140, v28, v17
    v_fma_f32 v141, v141, v28, v17
    v_mfma_f32_16x16x32_bf16 v[124:127], a[196:199], a[88:91], v[124:127]
    v_fma_f32 v142, v142, v28, v17
    v_fma_f32 v143, v143, v28, v17
    v_mfma_f32_16x16x32_bf16 v[128:131], a[192:195], a[76:79], v[128:131]
    s_waitcnt lgkmcnt(5)
    v_add_f32 v144, v144, v172
    v_add_f32 v145, v145, v173
    v_mfma_f32_16x16x32_bf16 v[128:131], a[196:199], a[92:95], v[128:131]
    buffer_load_dwordx4 a[252:255], v221, s[4:7], s75 offen sc1
    v_add_f32 v146, v146, v174
    v_mfma_f32_16x16x32_bf16 v[152:155], a[192:195], a[64:67], v[152:155]
    v_add_f32 v147, v147, v175
    s_waitcnt lgkmcnt(4)
    v_add_f32 v144, v144, v176
    v_mfma_f32_16x16x32_bf16 v[152:155], a[196:199], a[80:83], v[152:155]
    v_add_f32 v145, v145, v177
    s_waitcnt vmcnt(13)
    v_mfma_f32_16x16x32_bf16 v[120:123], a[200:203], a[100:103], v[120:123]
    v_add_f32 v146, v146, v178
    s_waitcnt vmcnt(12)
    v_mfma_f32_16x16x32_bf16 v[120:123], a[204:207], a[116:119], v[120:123]
    buffer_load_dwordx4 a[192:195], v221, s[4:7], s76 offen sc1
    v_add_f32 v147, v147, v179
    v_mfma_f32_16x16x32_bf16 v[124:127], a[200:203], a[104:107], v[124:127]
    s_waitcnt lgkmcnt(3)
    v_add_f32 v144, v144, v180
    v_add_f32 v145, v145, v181
    v_mfma_f32_16x16x32_bf16 v[124:127], a[204:207], a[120:123], v[124:127]
    v_add_f32 v146, v146, v182
    v_add_f32 v147, v147, v183
    v_mfma_f32_16x16x32_bf16 v[128:131], a[200:203], a[108:111], v[128:131]
    v_fma_f32 v144, v144, v28, v17
    v_fma_f32 v145, v145, v28, v17
    v_mfma_f32_16x16x32_bf16 v[128:131], a[204:207], a[124:127], v[128:131]
    buffer_load_dwordx4 a[196:199], v221, s[4:7], s77 offen sc1
    v_fma_f32 v146, v146, v28, v17
    v_mfma_f32_16x16x32_bf16 v[152:155], a[200:203], a[96:99], v[152:155]
    v_fma_f32 v147, v147, v28, v17
    v_mfma_f32_16x16x32_bf16 v[152:155], a[204:207], a[112:115], v[152:155]
    s_waitcnt vmcnt(13)
    v_mfma_f32_16x16x32_bf16 v[120:123], a[208:211], a[132:135], v[120:123]
    s_waitcnt vmcnt(12)
    v_mfma_f32_16x16x32_bf16 v[120:123], a[212:215], a[148:151], v[120:123]
    buffer_load_dwordx4 a[200:203], v221, s[4:7], s78 offen sc1
    v_mfma_f32_16x16x32_bf16 v[124:127], a[208:211], a[136:139], v[124:127]
    ds_write_b128 v21, v[64:67] offset:0
    v_mfma_f32_16x16x32_bf16 v[124:127], a[212:215], a[152:155], v[124:127]
    v_mfma_f32_16x16x32_bf16 v[128:131], a[208:211], a[140:143], v[128:131]
    v_mfma_f32_16x16x32_bf16 v[128:131], a[212:215], a[156:159], v[128:131]
    buffer_load_dwordx4 a[204:207], v221, s[4:7], s79 offen sc1
    v_mfma_f32_16x16x32_bf16 v[152:155], a[208:211], a[128:131], v[152:155]
    ds_write_b128 v21, v[68:71] offset:4608
    v_mfma_f32_16x16x32_bf16 v[152:155], a[212:215], a[144:147], v[152:155]
    s_waitcnt vmcnt(13)
    v_mfma_f32_16x16x32_bf16 v[120:123], a[216:219], a[164:167], v[120:123]
    s_waitcnt vmcnt(12)
    v_mfma_f32_16x16x32_bf16 v[120:123], a[220:223], a[180:183], v[120:123]
    buffer_load_dwordx4 a[208:211], v222, s[4:7], s68 offen sc1
    v_mfma_f32_16x16x32_bf16 v[124:127], a[216:219], a[168:171], v[124:127]
    v_mfma_f32_16x16x32_bf16 v[124:127], a[220:223], a[184:187], v[124:127]
    v_mfma_f32_16x16x32_bf16 v[128:131], a[216:219], a[172:175], v[128:131]
    v_mfma_f32_16x16x32_bf16 v[128:131], a[220:223], a[188:191], v[128:131]
    buffer_load_dwordx4 a[212:215], v222, s[4:7], s69 offen sc1
    v_mfma_f32_16x16x32_bf16 v[152:155], a[216:219], a[160:163], v[152:155]
    v_mfma_f32_16x16x32_bf16 v[152:155], a[220:223], a[176:179], v[152:155]
    s_waitcnt vmcnt(13)
    v_mfma_f32_16x16x32_bf16 v[108:111], a[224:227], a[4:7], 0
    s_waitcnt vmcnt(12)
    v_mfma_f32_16x16x32_bf16 v[108:111], a[228:231], a[20:23], v[108:111]
    buffer_load_dwordx4 a[216:219], v222, s[4:7], s70 offen sc1
    v_mfma_f32_16x16x32_bf16 v[112:115], a[224:227], a[8:11], 0
    ds_write_b128 v5, v[120:123] offset:0
    v_mfma_f32_16x16x32_bf16 v[112:115], a[228:231], a[24:27], v[112:115]
    ds_write_b128 v6, v[124:127] offset:0
    v_mfma_f32_16x16x32_bf16 v[116:119], a[224:227], a[12:15], 0
    v_mfma_f32_16x16x32_bf16 v[116:119], a[228:231], a[28:31], v[116:119]
    buffer_load_dwordx4 a[220:223], v222, s[4:7], s71 offen sc1
    v_mfma_f32_16x16x32_bf16 v[156:159], a[224:227], a[0:3], 0
    ds_write_b128 v7, v[128:131] offset:0
    v_mfma_f32_16x16x32_bf16 v[156:159], a[228:231], a[16:19], v[156:159]
    s_waitcnt vmcnt(13)
    v_mfma_f32_16x16x32_bf16 v[108:111], a[232:235], a[36:39], v[108:111]
    s_waitcnt vmcnt(12)
    v_mfma_f32_16x16x32_bf16 v[108:111], a[236:239], a[52:55], v[108:111]
    buffer_load_dwordx4 a[224:227], v222, s[4:7], s72 offen sc1
    v_mfma_f32_16x16x32_bf16 v[112:115], a[232:235], a[40:43], v[112:115]
    v_mfma_f32_16x16x32_bf16 v[112:115], a[236:239], a[56:59], v[112:115]
    s_waitcnt lgkmcnt(0)
    s_barrier
    v_mfma_f32_16x16x32_bf16 v[116:119], a[232:235], a[44:47], v[116:119]
    v_mfma_f32_16x16x32_bf16 v[116:119], a[236:239], a[60:63], v[116:119]
    buffer_load_dwordx4 a[228:231], v222, s[4:7], s73 offen sc1
    ds_read_b64_tr_b16 v[76:77], v22 offset:0
    v_mfma_f32_16x16x32_bf16 v[156:159], a[232:235], a[32:35], v[156:159]
    ds_read_b64_tr_b16 v[78:79], v22 offset:576
    v_mfma_f32_16x16x32_bf16 v[156:159], a[236:239], a[48:51], v[156:159]
    ds_read_b64_tr_b16 v[80:81], v22 offset:4608
    s_waitcnt vmcnt(13)
    v_mfma_f32_16x16x32_bf16 v[108:111], a[240:243], a[68:71], v[108:111]
    ds_read_b64_tr_b16 v[82:83], v22 offset:5184
    s_waitcnt vmcnt(12)
    v_mfma_f32_16x16x32_bf16 v[108:111], a[244:247], a[84:87], v[108:111]
    buffer_load_dwordx4 a[232:235], v222, s[4:7], s74 offen sc1
    ds_read_b128 v[184:187], v8 offset:49152
    v_mfma_f32_16x16x32_bf16 v[112:115], a[240:243], a[72:75], v[112:115]
    ds_read_b128 v[188:191], v8 offset:50176
    v_mfma_f32_16x16x32_bf16 v[112:115], a[244:247], a[88:91], v[112:115]
    ds_read_b128 v[192:195], v8 offset:51200
    v_mfma_f32_16x16x32_bf16 v[116:119], a[240:243], a[76:79], v[116:119]
    ds_read_b128 v[196:199], v9 offset:0
    v_mfma_f32_16x16x32_bf16 v[116:119], a[244:247], a[92:95], v[116:119]
    buffer_load_dwordx4 a[236:239], v222, s[4:7], s75 offen sc1
    ds_read_b128 v[200:203], v9 offset:1024
    v_mfma_f32_16x16x32_bf16 v[156:159], a[240:243], a[64:67], v[156:159]
    ds_read_b128 v[204:207], v9 offset:2048
    s_waitcnt lgkmcnt(9)
    v_lshlrev_b32 v88, 16, v76
    v_mfma_f32_16x16x32_bf16 v[156:159], a[244:247], a[80:83], v[156:159]
    v_and_b32 v89, 0xffff0000, v76
    s_waitcnt vmcnt(13)
    v_mfma_f32_16x16x32_bf16 v[108:111], a[248:251], a[100:103], v[108:111]
    v_fmac_f32 v132, v228, v88
    s_waitcnt vmcnt(12)
    v_mfma_f32_16x16x32_bf16 v[108:111], a[252:255], a[116:119], v[108:111]
    buffer_load_dwordx4 a[240:243], v222, s[4:7], s76 offen sc1
    v_fmac_f32 v133, v229, v89
    v_mfma_f32_16x16x32_bf16 v[112:115], a[248:251], a[104:107], v[112:115]
    v_cvt_pk_bf16_f32 v44, v132, v133
    v_lshlrev_b32 v90, 16, v77
    v_mfma_f32_16x16x32_bf16 v[112:115], a[252:255], a[120:123], v[112:115]
    v_and_b32 v91, 0xffff0000, v77
    v_fmac_f32 v134, v230, v90
    v_mfma_f32_16x16x32_bf16 v[116:119], a[248:251], a[108:111], v[116:119]
    v_fmac_f32 v135, v231, v91
    v_cvt_pk_bf16_f32 v45, v134, v135
    v_mfma_f32_16x16x32_bf16 v[116:119], a[252:255], a[124:127], v[116:119]
    buffer_load_dwordx4 a[244:247], v222, s[4:7], s77 offen sc1
    s_waitcnt lgkmcnt(8)
    v_lshlrev_b32 v88, 16, v78
    v_mfma_f32_16x16x32_bf16 v[156:159], a[248:251], a[96:99], v[156:159]
    v_and_b32 v89, 0xffff0000, v78
    v_fmac_f32 v136, v232, v88
    v_mfma_f32_16x16x32_bf16 v[156:159], a[252:255], a[112:115], v[156:159]
    v_fmac_f32 v137, v233, v89
    s_waitcnt vmcnt(13)
    v_mfma_f32_16x16x32_bf16 v[108:111], a[192:195], a[132:135], v[108:111]
    v_cvt_pk_bf16_f32 v46, v136, v137
    s_waitcnt vmcnt(12)
    v_mfma_f32_16x16x32_bf16 v[108:111], a[196:199], a[148:151], v[108:111]
    buffer_load_dwordx4 a[248:251], v222, s[4:7], s78 offen sc1
    v_lshlrev_b32 v90, 16, v79
    v_mfma_f32_16x16x32_bf16 v[112:115], a[192:195], a[136:139], v[112:115]
    v_and_b32 v91, 0xffff0000, v79
    v_fmac_f32 v138, v234, v90
    v_mfma_f32_16x16x32_bf16 v[112:115], a[196:199], a[152:155], v[112:115]
    v_fmac_f32 v139, v235, v91
    v_cvt_pk_bf16_f32 v47, v138, v139
    v_mfma_f32_16x16x32_bf16 v[116:119], a[192:195], a[140:143], v[116:119]
    s_waitcnt lgkmcnt(5)
    v_add_f32 v148, v148, v184
    v_add_f32 v149, v149, v185
    v_mfma_f32_16x16x32_bf16 v[116:119], a[196:199], a[156:159], v[116:119]
    buffer_load_dwordx4 a[252:255], v222, s[4:7], s79 offen sc1
    s_mov_b64 exec, 0xff
    buffer_load_dwordx2 v[226:227], v24, s[4:7], 0 offen sc1
    s_mov_b64 exec, -1
    v_mfma_f32_16x16x32_bf16 v[156:159], a[192:195], a[128:131], v[156:159]
    v_add_f32 v150, v150, v186
    v_add_f32 v151, v151, v187
    v_mfma_f32_16x16x32_bf16 v[156:159], a[196:199], a[144:147], v[156:159]
    s_waitcnt lgkmcnt(4)
    v_add_f32 v148, v148, v188
    s_waitcnt vmcnt(14)
    v_mfma_f32_16x16x32_bf16 v[108:111], a[200:203], a[164:167], v[108:111]
    v_add_f32 v149, v149, v189
    s_waitcnt vmcnt(13)
    v_mfma_f32_16x16x32_bf16 v[108:111], a[204:207], a[180:183], v[108:111]
    buffer_load_dwordx4 a[192:195], v223, s[4:7], s68 offen sc1
    v_add_f32 v150, v150, v190
    v_mfma_f32_16x16x32_bf16 v[112:115], a[200:203], a[168:171], v[112:115]
    v_add_f32 v151, v151, v191
    s_waitcnt lgkmcnt(3)
    v_add_f32 v148, v148, v192
    v_mfma_f32_16x16x32_bf16 v[112:115], a[204:207], a[184:187], v[112:115]
    v_add_f32 v149, v149, v193
    v_add_f32 v150, v150, v194
    v_mfma_f32_16x16x32_bf16 v[116:119], a[200:203], a[172:175], v[116:119]
    v_add_f32 v151, v151, v195
    v_fma_f32 v148, v148, v28, v17
    v_mfma_f32_16x16x32_bf16 v[116:119], a[204:207], a[188:191], v[116:119]
    buffer_load_dwordx4 a[196:199], v223, s[4:7], s69 offen sc1
    v_fma_f32 v149, v149, v28, v17
    v_mfma_f32_16x16x32_bf16 v[156:159], a[200:203], a[160:163], v[156:159]
    v_fma_f32 v150, v150, v28, v17
    v_fma_f32 v151, v151, v28, v17
    v_mfma_f32_16x16x32_bf16 v[156:159], a[204:207], a[176:179], v[156:159]
    s_waitcnt lgkmcnt(2)
    v_add_f32 v152, v152, v196
    s_waitcnt vmcnt(14)
    v_mfma_f32_16x16x32_bf16 v[120:123], a[208:211], a[4:7], 0
    v_add_f32 v153, v153, v197
    s_waitcnt vmcnt(13)
    v_mfma_f32_16x16x32_bf16 v[120:123], a[212:215], a[20:23], v[120:123]
    buffer_load_dwordx4 a[200:203], v223, s[4:7], s70 offen sc1
    v_add_f32 v154, v154, v198
    v_mfma_f32_16x16x32_bf16 v[124:127], a[208:211], a[8:11], 0
    ds_write_b128 v5, v[108:111] offset:12288
    v_mfma_f32_16x16x32_bf16 v[124:127], a[212:215], a[24:27], v[124:127]
    ds_write_b128 v6, v[112:115] offset:12288
    v_mfma_f32_16x16x32_bf16 v[128:131], a[208:211], a[12:15], 0
    v_add_f32 v155, v155, v199
    s_waitcnt lgkmcnt(3)
    v_add_f32 v152, v152, v200
    v_mfma_f32_16x16x32_bf16 v[128:131], a[212:215], a[28:31], v[128:131]
    buffer_load_dwordx4 a[204:207], v223, s[4:7], s71 offen sc1
    v_add_f32 v153, v153, v201
    v_mfma_f32_16x16x32_bf16 v[160:163], a[208:211], a[0:3], 0
    ds_write_b128 v7, v[116:119] offset:12288
    v_mfma_f32_16x16x32_bf16 v[160:163], a[212:215], a[16:19], v[160:163]
    v_add_f32 v154, v154, v202
    s_waitcnt vmcnt(14)
    v_mfma_f32_16x16x32_bf16 v[120:123], a[216:219], a[36:39], v[120:123]
    v_add_f32 v155, v155, v203
    s_waitcnt vmcnt(13)
    v_mfma_f32_16x16x32_bf16 v[120:123], a[220:223], a[52:55], v[120:123]
    buffer_load_dwordx4 a[208:211], v223, s[4:7], s72 offen sc1
    s_waitcnt lgkmcnt(3)
    v_add_f32 v152, v152, v204
    v_mfma_f32_16x16x32_bf16 v[124:127], a[216:219], a[40:43], v[124:127]
    v_add_f32 v153, v153, v205
    v_add_f32 v154, v154, v206
    v_mfma_f32_16x16x32_bf16 v[124:127], a[220:223], a[56:59], v[124:127]
    v_add_f32 v155, v155, v207
    v_fma_f32 v152, v152, v28, v17
    v_mfma_f32_16x16x32_bf16 v[128:131], a[216:219], a[44:47], v[128:131]
    v_fma_f32 v153, v153, v28, v17
    v_fma_f32 v154, v154, v28, v17
    v_mfma_f32_16x16x32_bf16 v[128:131], a[220:223], a[60:63], v[128:131]
    buffer_load_dwordx4 a[212:215], v223, s[4:7], s73 offen sc1
    v_fma_f32 v155, v155, v28, v17
    v_mfma_f32_16x16x32_bf16 v[160:163], a[216:219], a[32:35], v[160:163]
    ds_write_b128 v23, v[44:47] offset:0
    v_mfma_f32_16x16x32_bf16 v[160:163], a[220:223], a[48:51], v[160:163]
    v_lshlrev_b32 v88, 16, v80
    s_waitcnt vmcnt(14)
    v_mfma_f32_16x16x32_bf16 v[120:123], a[224:227], a[68:71], v[120:123]
    v_and_b32 v89, 0xffff0000, v80
    s_waitcnt vmcnt(13)
    v_mfma_f32_16x16x32_bf16 v[120:123], a[228:231], a[84:87], v[120:123]
    buffer_load_dwordx4 a[216:219], v223, s[4:7], s74 offen sc1
    v_fmac_f32 v140, v236, v88
    v_mfma_f32_16x16x32_bf16 v[124:127], a[224:227], a[72:75], v[124:127]
    v_fmac_f32 v141, v237, v89
    v_cvt_pk_bf16_f32 v48, v140, v141
    v_mfma_f32_16x16x32_bf16 v[124:127], a[228:231], a[88:91], v[124:127]
    v_lshlrev_b32 v90, 16, v81
    v_and_b32 v91, 0xffff0000, v81
    v_mfma_f32_16x16x32_bf16 v[128:131], a[224:227], a[76:79], v[128:131]
    v_fmac_f32 v142, v238, v90
    v_fmac_f32 v143, v239, v91
    v_mfma_f32_16x16x32_bf16 v[128:131], a[228:231], a[92:95], v[128:131]
    buffer_load_dwordx4 a[220:223], v223, s[4:7], s75 offen sc1
    v_cvt_pk_bf16_f32 v49, v142, v143
    v_mfma_f32_16x16x32_bf16 v[160:163], a[224:227], a[64:67], v[160:163]
    v_lshlrev_b32 v88, 16, v82
    v_and_b32 v89, 0xffff0000, v82
    v_mfma_f32_16x16x32_bf16 v[160:163], a[228:231], a[80:83], v[160:163]
    v_fmac_f32 v144, v240, v88
    s_waitcnt vmcnt(14)
    v_mfma_f32_16x16x32_bf16 v[120:123], a[232:235], a[100:103], v[120:123]
    v_fmac_f32 v145, v241, v89
    s_waitcnt vmcnt(13)
    v_mfma_f32_16x16x32_bf16 v[120:123], a[236:239], a[116:119], v[120:123]
    buffer_load_dwordx4 a[224:227], v223, s[4:7], s76 offen sc1
    v_cvt_pk_bf16_f32 v50, v144, v145
    v_mfma_f32_16x16x32_bf16 v[124:127], a[232:235], a[104:107], v[124:127]
    v_lshlrev_b32 v90, 16, v83
    v_and_b32 v91, 0xffff0000, v83
    v_mfma_f32_16x16x32_bf16 v[124:127], a[236:239], a[120:123], v[124:127]
    v_fmac_f32 v146, v242, v90
    v_fmac_f32 v147, v243, v91
    v_mfma_f32_16x16x32_bf16 v[128:131], a[232:235], a[108:111], v[128:131]
    v_cvt_pk_bf16_f32 v51, v146, v147
    v_mfma_f32_16x16x32_bf16 v[128:131], a[236:239], a[124:127], v[128:131]
    buffer_load_dwordx4 a[228:231], v223, s[4:7], s77 offen sc1
    v_mfma_f32_16x16x32_bf16 v[160:163], a[232:235], a[96:99], v[160:163]
    ds_write_b128 v32, v[48:51] offset:0
    v_mfma_f32_16x16x32_bf16 v[160:163], a[236:239], a[112:115], v[160:163]
    ds_read_b128 v[44:47], v33 offset:0
    s_waitcnt vmcnt(14)
    v_mfma_f32_16x16x32_bf16 v[120:123], a[240:243], a[132:135], v[120:123]
    ds_read_b128 v[48:51], v33 offset:1024
    s_waitcnt vmcnt(13)
    v_mfma_f32_16x16x32_bf16 v[120:123], a[244:247], a[148:151], v[120:123]
    buffer_load_dwordx4 a[232:235], v223, s[4:7], s78 offen sc1
    v_lshlrev_b32 v228, 16, v56
    v_mfma_f32_16x16x32_bf16 v[124:127], a[240:243], a[136:139], v[124:127]
    v_and_b32 v229, 0xffff0000, v56
    v_mul_f32 v228, v228, v16
    v_mfma_f32_16x16x32_bf16 v[124:127], a[244:247], a[152:155], v[124:127]
    v_mul_f32 v229, v229, v16
    v_lshlrev_b32 v230, 16, v57
    v_mfma_f32_16x16x32_bf16 v[128:131], a[240:243], a[140:143], v[128:131]
    s_mov_b64 exec, 0xff
    s_waitcnt vmcnt(11)
    v_xor_b32 v226, s91, v226
    v_bitop3_b32 v226, v226, v227, v34 bitop3:0xf6
    v_cmp_ne_u32 vcc, 0, v226
    s_mov_b32 s3, 0
    s_cbranch_vccz L_pk_Bfz1
L_pl_Bfz1:
    s_mov_b64 exec, vcc
    buffer_load_dwordx2 v[226:227], v24, s[4:7], 0 offen sc1
    s_add_u32 s3, s3, 1
    s_cmp_ge_u32 s3, 0x40000
    s_cbranch_scc1 L_pk_Bfz1
    s_waitcnt vmcnt(0)
    v_xor_b32 v226, s91, v226
    v_bitop3_b32 v226, v226, v227, v34 bitop3:0xf6
    v_cmp_ne_u32 vcc, 0, v226
    s_nop 0
    s_cbranch_vccnz L_pl_Bfz1
L_pk_Bfz1:
    s_mov_b64 exec, -1
    v_mfma_f32_16x16x32_bf16 v[128:131], a[244:247], a[156:159], v[128:131]
    buffer_load_dwordx4 a[236:239], v223, s[4:7], s79 offen sc1
    v_and_b32 v231, 0xffff0000, v57
    v_mfma_f32_16x16x32_bf16 v[160:163], a[240:243], a[128:131], v[160:163]
    v_mul_f32 v230, v230, v16
    v_mul_f32 v231, v231, v16
    v_mfma_f32_16x16x32_bf16 v[160:163], a[244:247], a[144:147], v[160:163]
    v_lshlrev_b32 v232, 16, v58
    v_mfma_f32_16x16x32_bf16 v[120:123], a[248:251], a[164:167], v[120:123]
    buffer_load_dwordx4 v[64:67], v20, s[4:7], s82 offen sc1
    v_mfma_f32_16x16x32_bf16 v[120:123], a[252:255], a[180:183], v[120:123]
    buffer_load_dwordx4 a[240:243], v224, s[4:7], s68 offen sc1
    v_and_b32 v233, 0xffff0000, v58
    v_mfma_f32_16x16x32_bf16 v[124:127], a[248:251], a[168:171], v[124:127]
    buffer_load_dwordx4 v[68:71], v20, s[4:7], s83 offen sc1
    v_mul_f32 v232, v232, v16
    v_mfma_f32_16x16x32_bf16 v[124:127], a[252:255], a[184:187], v[124:127]
    v_mul_f32 v233, v233, v16
    v_lshlrev_b32 v234, 16, v59
    v_mfma_f32_16x16x32_bf16 v[128:131], a[248:251], a[172:175], v[128:131]
    v_and_b32 v235, 0xffff0000, v59
    v_mul_f32 v234, v234, v16
    v_mfma_f32_16x16x32_bf16 v[128:131], a[252:255], a[188:191], v[128:131]
    buffer_load_dwordx4 a[244:247], v224, s[4:7], s69 offen sc1
    v_mul_f32 v235, v235, v16
    v_mfma_f32_16x16x32_bf16 v[160:163], a[248:251], a[160:163], v[160:163]
    v_lshlrev_b32 v236, 16, v60
    v_and_b32 v237, 0xffff0000, v60
    v_mfma_f32_16x16x32_bf16 v[160:163], a[252:255], a[176:179], v[160:163]
    v_mul_f32 v236, v236, v16
    s_waitcnt vmcnt(15)
    v_mfma_f32_16x16x32_bf16 v[108:111], a[192:195], a[4:7], 0
    v_mul_f32 v237, v237, v16
    s_waitcnt vmcnt(14)
    v_mfma_f32_16x16x32_bf16 v[108:111], a[196:199], a[20:23], v[108:111]
    buffer_load_dwordx4 a[248:251], v224, s[4:7], s70 offen sc1
    v_lshlrev_b32 v238, 16, v61
    v_mfma_f32_16x16x32_bf16 v[112:115], a[192:195], a[8:11], 0
    ds_write_b128 v5, v[120:123] offset:24576
    v_mfma_f32_16x16x32_bf16 v[112:115], a[196:199], a[24:27], v[112:115]
    ds_write_b128 v6, v[124:127] offset:24576
    v_mfma_f32_16x16x32_bf16 v[116:119], a[192:195], a[12:15], 0
    v_and_b32 v239, 0xffff0000, v61
    v_mul_f32 v238, v238, v16
    v_mfma_f32_16x16x32_bf16 v[116:119], a[196:199], a[28:31], v[116:119]
    buffer_load_dwordx4 a[252:255], v224, s[4:7], s71 offen sc1
    v_mul_f32 v239, v239, v16
    v_mfma_f32_16x16x32_bf16 v[164:167], a[192:195], a[0:3], 0
    s_mov_b64 exec, 0xff
    buffer_load_dword v18, v225, s[4:7], 0 offen sc1
    s_mov_b64 exec, -1
    v_mfma_f32_16x16x32_bf16 v[164:167], a[196:199], a[16:19], v[164:167]
    v_lshlrev_b32 v240, 16, v62
    s_waitcnt vmcnt(16)
    v_mfma_f32_16x16x32_bf16 v[108:111], a[200:203], a[36:39], v[108:111]
    ds_write_b128 v7, v[128:131] offset:24576
    s_waitcnt vmcnt(15)
    v_mfma_f32_16x16x32_bf16 v[108:111], a[204:207], a[52:55], v[108:111]
    buffer_load_dwordx4 a[192:195], v224, s[4:7], s72 offen sc1
    v_and_b32 v241, 0xffff0000, v62
    v_mfma_f32_16x16x32_bf16 v[112:115], a[200:203], a[40:43], v[112:115]
    v_mul_f32 v240, v240, v16
    v_mul_f32 v241, v241, v16
    v_lshlrev_b32 v242, 16, v63
    v_and_b32 v243, 0xffff0000, v63
    v_mul_f32 v242, v242, v16
    v_mul_f32 v243, v243, v16
    v_mfma_f32_16x16x32_bf16 v[112:115], a[204:207], a[56:59], v[112:115]
    s_waitcnt lgkmcnt(0)
    s_barrier
    v_mfma_f32_16x16x32_bf16 v[116:119], a[200:203], a[44:47], v[116:119]
    v_mfma_f32_16x16x32_bf16 v[116:119], a[204:207], a[60:63], v[116:119]
    buffer_load_dwordx4 a[196:199], v224, s[4:7], s73 offen sc1
    ds_read_b128 v[172:175], v9 offset:12288
    v_mfma_f32_16x16x32_bf16 v[164:167], a[200:203], a[32:35], v[164:167]
    ds_read_b128 v[176:179], v9 offset:13312
    v_mfma_f32_16x16x32_bf16 v[164:167], a[204:207], a[48:51], v[164:167]
    ds_read_b128 v[180:183], v9 offset:14336
    s_waitcnt vmcnt(16)
    v_mfma_f32_16x16x32_bf16 v[108:111], a[208:211], a[68:71], v[108:111]
    ds_read_b128 v[184:187], v9 offset:24576
    s_waitcnt vmcnt(15)
    v_mfma_f32_16x16x32_bf16 v[108:111], a[212:215], a[84:87], v[108:111]
    buffer_load_dwordx4 a[200:203], v224, s[4:7], s74 offen sc1
    ds_read_b128 v[188:191], v9 offset:25600
    v_mfma_f32_16x16x32_bf16 v[112:115], a[208:211], a[72:75], v[112:115]
    ds_read_b128 v[192:195], v9 offset:26624
    s_waitcnt lgkmcnt(5)
    v_add_f32 v156, v156, v172
    v_mfma_f32_16x16x32_bf16 v[112:115], a[212:215], a[88:91], v[112:115]
    v_add_f32 v157, v157, v173
    v_add_f32 v158, v158, v174
    v_mfma_f32_16x16x32_bf16 v[116:119], a[208:211], a[76:79], v[116:119]
    v_add_f32 v159, v159, v175
    s_waitcnt lgkmcnt(4)
    v_add_f32 v156, v156, v176
    v_mfma_f32_16x16x32_bf16 v[116:119], a[212:215], a[92:95], v[116:119]
    buffer_load_dwordx4 a[204:207], v224, s[4:7], s75 offen sc1
    v_add_f32 v157, v157, v177
    v_mfma_f32_16x16x32_bf16 v[164:167], a[208:211], a[64:67], v[164:167]
    v_add_f32 v158, v158, v178
    v_add_f32 v159, v159, v179
    v_mfma_f32_16x16x32_bf16 v[164:167], a[212:215], a[80:83], v[164:167]
    s_waitcnt lgkmcnt(3)
    v_add_f32 v156, v156, v180
    s_waitcnt vmcnt(16)
    v_mfma_f32_16x16x32_bf16 v[108:111], a[216:219], a[100:103], v[108:111]
    v_add_f32 v157, v157, v181
    s_waitcnt vmcnt(15)
    v_mfma_f32_16x16x32_bf16 v[108:111], a[220:223], a[116:119], v[108:111]
    buffer_load_dwordx4 a[208:211], v224, s[4:7], s76 offen sc1
    v_add_f32 v158, v158, v182
    v_mfma_f32_16x16x32_bf16 v[112:115], a[216:219], a[104:107], v[112:115]
    v_add_f32 v159, v159, v183
    v_fma_f32 v156, v156, v28, v17
    v_mfma_f32_16x16x32_bf16 v[112:115], a[220:223], a[120:123], v[112:115]
    v_fma_f32 v157, v157, v28, v17
    v_fma_f32 v158, v158, v28, v17
    v_mfma_f32_16x16x32_bf16 v[116:119], a[216:219], a[108:111], v[116:119]
    v_fma_f32 v159, v159, v28, v17
    s_waitcnt lgkmcnt(2)
    v_add_f32 v160, v160, v184
    v_mfma_f32_16x16x32_bf16 v[116:119], a[220:223], a[124:127], v[116:119]
    buffer_load_dwordx4 a[212:215], v224, s[4:7], s77 offen sc1
    v_add_f32 v161, v161, v185
    v_mfma_f32_16x16x32_bf16 v[164:167], a[216:219], a[96:99], v[164:167]
    v_add_f32 v162, v162, v186
    v_add_f32 v163, v163, v187
    v_mfma_f32_16x16x32_bf16 v[164:167], a[220:223], a[112:115], v[164:167]
    s_waitcnt lgkmcnt(1)
    v_add_f32 v160, v160, v188
    s_waitcnt vmcnt(16)
    v_mfma_f32_16x16x32_bf16 v[108:111], a[224:227], a[132:135], v[108:111]
    v_add_f32 v161, v161, v189
    s_waitcnt vmcnt(15)
    v_mfma_f32_16x16x32_bf16 v[108:111], a[228:231], a[148:151], v[108:111]
    buffer_load_dwordx4 a[216:219], v224, s[4:7], s78 offen sc1
    v_add_f32 v162, v162, v190
    v_mfma_f32_16x16x32_bf16 v[112:115], a[224:227], a[136:139], v[112:115]
    s_waitcnt vmcnt(13)
    ds_write_b128 v21, v[64:67] offset:9216
    v_mfma_f32_16x16x32_bf16 v[112:115], a[228:231], a[152:155], v[112:115]
    v_add_f32 v163, v163, v191
    s_waitcnt lgkmcnt(1)
    v_add_f32 v160, v160, v192
    v_mfma_f32_16x16x32_bf16 v[116:119], a[224:227], a[140:143], v[116:119]
    v_add_f32 v161, v161, v193
    v_add_f32 v162, v162, v194
    v_mfma_f32_16x16x32_bf16 v[116:119], a[228:231], a[156:159], v[116:119]
    buffer_load_dwordx4 a[220:223], v224, s[4:7], s79 offen sc1
    v_add_f32 v163, v163, v195
    v_mfma_f32_16x16x32_bf16 v[164:167], a[224:227], a[128:131], v[164:167]
    s_waitcnt vmcnt(12)
    ds_write_b128 v21, v[68:71] offset:13824
    v_mfma_f32_16x16x32_bf16 v[164:167], a[228:231], a[144:147], v[164:167]
    v_fma_f32 v160, v160, v28, v17
    v_mfma_f32_16x16x32_bf16 v[108:111], a[232:235], a[164:167], v[108:111]
    v_fma_f32 v161, v161, v28, v17
    v_mfma_f32_16x16x32_bf16 v[108:111], a[236:239], a[180:183], v[108:111]
    v_fma_f32 v162, v162, v28, v17
    v_fma_f32 v163, v163, v28, v17
    v_mfma_f32_16x16x32_bf16 v[112:115], a[232:235], a[168:171], v[112:115]
    v_mfma_f32_16x16x32_bf16 v[112:115], a[236:239], a[184:187], v[112:115]
    v_mfma_f32_16x16x32_bf16 v[116:119], a[232:235], a[172:175], v[116:119]
    v_mfma_f32_16x16x32_bf16 v[116:119], a[236:239], a[188:191], v[116:119]
    v_mfma_f32_16x16x32_bf16 v[164:167], a[232:235], a[160:163], v[164:167]
    v_mfma_f32_16x16x32_bf16 v[164:167], a[236:239], a[176:179], v[164:167]
    v_mfma_f32_16x16x32_bf16 v[120:123], a[240:243], a[4:7], 0
    s_waitcnt vmcnt(11)
    v_mfma_f32_16x16x32_bf16 v[120:123], a[244:247], a[20:23], v[120:123]
    ds_write_b128 v5, v[108:111] offset:36864
    v_mfma_f32_16x16x32_bf16 v[124:127], a[240:243], a[8:11], 0
    s_mov_b64 exec, 0xff
    s_waitcnt vmcnt(8)
    v_cmp_ne_u32 vcc, s91, v18
    s_mov_b32 s3, 0
    s_cbranch_vccz L_pk_Bfz2
L_pl_Bfz2:
    s_mov_b64 exec, vcc
    buffer_load_dword v18, v225, s[4:7], 0 offen sc1
    s_add_u32 s3, s3, 1
    s_cmp_ge_u32 s3, 0x40000
    s_cbranch_scc1 L_pk_Bfz2
    s_waitcnt vmcnt(0)
    v_cmp_ne_u32 vcc, s91, v18
    s_nop 0
    s_cbranch_vccnz L_pl_Bfz2
L_pk_Bfz2:
    s_mov_b64 exec, -1
    v_mfma_f32_16x16x32_bf16 v[124:127], a[244:247], a[24:27], v[124:127]
    buffer_load_dwordx4 v[72:75], v20, s[4:7], s31 offen sc1
    v_mfma_f32_16x16x32_bf16 v[128:131], a[240:243], a[12:15], 0
    ds_write_b128 v6, v[112:115] offset:36864
    v_mfma_f32_16x16x32_bf16 v[128:131], a[244:247], a[28:31], v[128:131]
    v_mfma_f32_16x16x32_bf16 v[120:123], a[248:251], a[36:39], v[120:123]
    v_mfma_f32_16x16x32_bf16 v[120:123], a[252:255], a[52:55], v[120:123]
    ds_write_b128 v7, v[116:119] offset:36864
    v_mfma_f32_16x16x32_bf16 v[124:127], a[248:251], a[40:43], v[124:127]
    v_mfma_f32_16x16x32_bf16 v[124:127], a[252:255], a[56:59], v[124:127]
    v_mfma_f32_16x16x32_bf16 v[128:131], a[248:251], a[44:47], v[128:131]
    v_mfma_f32_16x16x32_bf16 v[128:131], a[252:255], a[60:63], v[128:131]
    s_waitcnt lgkmcnt(0)
    s_waitcnt vmcnt(8)
    v_mfma_f32_16x16x32_bf16 v[120:123], a[192:195], a[68:71], v[120:123]
    s_barrier
    s_waitcnt vmcnt(7)
    v_mfma_f32_16x16x32_bf16 v[120:123], a[196:199], a[84:87], v[120:123]
    ds_read_b64_tr_b16 v[84:85], v22 offset:9216
    v_mfma_f32_16x16x32_bf16 v[124:127], a[192:195], a[72:75], v[124:127]
    ds_read_b64_tr_b16 v[86:87], v22 offset:9792
    v_mfma_f32_16x16x32_bf16 v[124:127], a[196:199], a[88:91], v[124:127]
    ds_read_b64_tr_b16 v[76:77], v22 offset:13824
    v_mfma_f32_16x16x32_bf16 v[128:131], a[192:195], a[76:79], v[128:131]
    ds_read_b64_tr_b16 v[78:79], v22 offset:14400
    v_mfma_f32_16x16x32_bf16 v[128:131], a[196:199], a[92:95], v[128:131]
    ds_read_b128 v[196:199], v9 offset:36864
    s_waitcnt vmcnt(6)
    v_mfma_f32_16x16x32_bf16 v[120:123], a[200:203], a[100:103], v[120:123]
    global_store_dwordx4 v36, v[44:47], s[62:63] offset:0 sc1
    s_waitcnt vmcnt(6)
    v_mfma_f32_16x16x32_bf16 v[120:123], a[204:207], a[116:119], v[120:123]
    ds_read_b128 v[200:203], v9 offset:37888
    v_mfma_f32_16x16x32_bf16 v[124:127], a[200:203], a[104:107], v[124:127]
    ds_read_b128 v[204:207], v9 offset:38912
    s_waitcnt lgkmcnt(6)
    v_lshlrev_b32 v88, 16, v84
    v_mfma_f32_16x16x32_bf16 v[124:127], a[204:207], a[120:123], v[124:127]
    global_store_dwordx4 v15, v[48:51], s[62:63] offset:0 sc1
    v_and_b32 v89, 0xffff0000, v84
    v_mfma_f32_16x16x32_bf16 v[128:131], a[200:203], a[108:111], v[128:131]
    v_fmac_f32 v152, v244, v88
    v_fmac_f32 v153, v245, v89
    v_mfma_f32_16x16x32_bf16 v[128:131], a[204:207], a[124:127], v[128:131]
    v_cvt_pk_bf16_f32 v52, v152, v153
    s_waitcnt vmcnt(6)
    v_mfma_f32_16x16x32_bf16 v[120:123], a[208:211], a[132:135], v[120:123]
    v_lshlrev_b32 v90, 16, v85
    s_waitcnt vmcnt(5)
    v_mfma_f32_16x16x32_bf16 v[120:123], a[212:215], a[148:151], v[120:123]
    v_and_b32 v91, 0xffff0000, v85
    v_fmac_f32 v154, v246, v90
    v_mfma_f32_16x16x32_bf16 v[124:127], a[208:211], a[136:139], v[124:127]
    v_fmac_f32 v155, v247, v91
    v_cvt_pk_bf16_f32 v53, v154, v155
    v_mfma_f32_16x16x32_bf16 v[124:127], a[212:215], a[152:155], v[124:127]
    s_waitcnt lgkmcnt(2)
    v_add_f32 v164, v164, v196
    v_add_f32 v165, v165, v197
    v_mfma_f32_16x16x32_bf16 v[128:131], a[208:211], a[140:143], v[128:131]
    v_add_f32 v166, v166, v198
    v_add_f32 v167, v167, v199
    v_mfma_f32_16x16x32_bf16 v[128:131], a[212:215], a[156:159], v[128:131]
    s_waitcnt lgkmcnt(1)
    v_add_f32 v164, v164, v200
    s_waitcnt vmcnt(4)
    v_mfma_f32_16x16x32_bf16 v[120:123], a[216:219], a[164:167], v[120:123]
    v_add_f32 v165, v165, v201
    s_waitcnt vmcnt(3)
    v_mfma_f32_16x16x32_bf16 v[120:123], a[220:223], a[180:183], v[120:123]
    v_add_f32 v166, v166, v202
    v_add_f32 v167, v167, v203
    v_mfma_f32_16x16x32_bf16 v[124:127], a[216:219], a[168:171], v[124:127]
    s_waitcnt lgkmcnt(0)
    v_add_f32 v164, v164, v204
    v_add_f32 v165, v165, v205
    v_mfma_f32_16x16x32_bf16 v[124:127], a[220:223], a[184:187], v[124:127]
    v_add_f32 v166, v166, v206
    v_add_f32 v167, v167, v207
    v_mfma_f32_16x16x32_bf16 v[128:131], a[216:219], a[172:175], v[128:131]
    v_fma_f32 v164, v164, v28, v17
    v_fma_f32 v165, v165, v28, v17
    v_mfma_f32_16x16x32_bf16 v[128:131], a[220:223], a[188:191], v[128:131]
    v_fma_f32 v166, v166, v28, v17
    v_fma_f32 v167, v167, v28, v17
    v_mfma_f32_16x16x32_bf16 v[168:171], a[240:243], a[0:3], 0
    v_lshlrev_b32 v88, 16, v86
    v_and_b32 v89, 0xffff0000, v86
    v_mfma_f32_16x16x32_bf16 v[168:171], a[244:247], a[16:19], v[168:171]
    ds_write_b128 v5, v[120:123] offset:49152
    v_mfma_f32_16x16x32_bf16 v[168:171], a[248:251], a[32:35], v[168:171]
    v_fmac_f32 v156, v248, v88
    v_fmac_f32 v157, v249, v89
    v_mfma_f32_16x16x32_bf16 v[168:171], a[252:255], a[48:51], v[168:171]
    ds_write_b128 v6, v[124:127] offset:49152
    v_mfma_f32_16x16x32_bf16 v[168:171], a[192:195], a[64:67], v[168:171]
    v_cvt_pk_bf16_f32 v54, v156, v157
    v_lshlrev_b32 v90, 16, v87
    v_mfma_f32_16x16x32_bf16 v[168:171], a[196:199], a[80:83], v[168:171]
    ds_write_b128 v7, v[128:131] offset:49152
    v_mfma_f32_16x16x32_bf16 v[168:171], a[200:203], a[96:99], v[168:171]
    v_and_b32 v91, 0xffff0000, v87
    v_fmac_f32 v158, v250, v90
    v_mfma_f32_16x16x32_bf16 v[168:171], a[204:207], a[112:115], v[168:171]
    v_fmac_f32 v159, v251, v91
    v_cvt_pk_bf16_f32 v55, v158, v159
    v_mfma_f32_16x16x32_bf16 v[168:171], a[208:211], a[128:131], v[168:171]
    s_waitcnt vmcnt(2)
    ds_write_b128 v21, v[72:75] offset:18432
    v_mfma_f32_16x16x32_bf16 v[168:171], a[212:215], a[144:147], v[168:171]
    global_store_dwordx4 v25, v[52:55], s[62:63] offset:128 sc1
    v_lshlrev_b32 v88, 16, v76
    v_mfma_f32_16x16x32_bf16 v[168:171], a[216:219], a[160:163], v[168:171]
    v_and_b32 v89, 0xffff0000, v76
    v_fmac_f32 v160, v228, v88
    v_mfma_f32_16x16x32_bf16 v[168:171], a[220:223], a[176:179], v[168:171]
    v_fmac_f32 v161, v229, v89
    v_cvt_pk_bf16_f32 v56, v160, v161
    s_waitcnt lgkmcnt(0)
    s_barrier
    ds_read_b64_tr_b16 v[80:81], v22 offset:18432
    ds_read_b64_tr_b16 v[82:83], v22 offset:19008
    ds_read_b128 v[208:211], v9 offset:49152
    ds_read_b128 v[212:215], v9 offset:50176
    ds_read_b128 v[216:219], v9 offset:51200
    v_lshlrev_b32 v90, 16, v77
    v_and_b32 v91, 0xffff0000, v77
    v_fmac_f32 v162, v230, v90
    v_fmac_f32 v163, v231, v91
    v_cvt_pk_bf16_f32 v57, v162, v163
    v_lshlrev_b32 v88, 16, v78
    v_and_b32 v89, 0xffff0000, v78
    v_fmac_f32 v164, v232, v88
    v_fmac_f32 v165, v233, v89
    v_cvt_pk_bf16_f32 v58, v164, v165
    v_lshlrev_b32 v90, 16, v79
    v_and_b32 v91, 0xffff0000, v79
    v_fmac_f32 v166, v234, v90
    v_fmac_f32 v167, v235, v91
    v_cvt_pk_bf16_f32 v59, v166, v167
    global_store_dwordx4 v27, v[56:59], s[62:63] offset:128 sc1
    s_waitcnt lgkmcnt(4)
    v_lshlrev_b32 v88, 16, v80
    v_and_b32 v89, 0xffff0000, v80
    v_fmac_f32 v148, v236, v88
    v_fmac_f32 v149, v237, v89
    v_cvt_pk_bf16_f32 v60, v148, v149
    v_lshlrev_b32 v90, 16, v81
    v_and_b32 v91, 0xffff0000, v81
    v_fmac_f32 v150, v238, v90
    v_fmac_f32 v151, v239, v91
    v_cvt_pk_bf16_f32 v61, v150, v151
    s_waitcnt lgkmcnt(3)
    v_lshlrev_b32 v88, 16, v82
    v_and_b32 v89, 0xffff0000, v82
    v_fma_f32 v240, v240, v88, v17
    v_fma_f32 v241, v241, v89, v17
    v_lshlrev_b32 v90, 16, v83
    v_and_b32 v91, 0xffff0000, v83
    v_fma_f32 v242, v242, v90, v17
    v_fma_f32 v243, v243, v91, v17
    s_waitcnt lgkmcnt(2)
    v_pk_add_f32 v[168:169], v[168:169], v[208:209]
    v_pk_add_f32 v[170:171], v[170:171], v[210:211]
    s_waitcnt lgkmcnt(1)
    v_pk_add_f32 v[168:169], v[168:169], v[212:213]
    v_pk_add_f32 v[170:171], v[170:171], v[214:215]
    s_waitcnt lgkmcnt(0)
    v_pk_add_f32 v[168:169], v[168:169], v[216:217]
    v_pk_add_f32 v[170:171], v[170:171], v[218:219]
    v_pk_fma_f32 v[240:241], v[168:169], v[28:29], v[240:241] op_sel_hi:[1,0,1]
    v_pk_fma_f32 v[242:243], v[170:171], v[28:29], v[242:243] op_sel_hi:[1,0,1]
    v_cvt_pk_bf16_f32 v62, v240, v241
    v_cvt_pk_bf16_f32 v63, v242, v243
    global_store_dwordx4 v30, v[60:63], s[62:63] offset:1024 sc1
    s_endpgm
.p2align 7
L_Amain:
    s_cmp_lt_u32 s86, 30
    s_cbranch_scc1 L_Anh
    s_lshl1_add_u32 s32, s85, 3
    s_and_b32 s32, s32, 7
    s_min_u32 s32, s32, 5
    s_lshr_b32 s3, s32, 1
    s_mul_i32 s3, s3, 0
    s_add_u32 s3, s3, 15
    s_mul_i32 s33, s85, 6
    s_add_u32 s32, s32, s33
    s_lshl_b32 s32, s32, 7
    s_mul_i32 s33, s84, 1572864
    s_add_u32 s20, s32, s33
    v_lshrrev_b32 v42, 5, v0
    v_lshl_add_u32 v42, s87, 1, v42
    v_and_b32 v43, 31, v0
    v_add_u32 v42, 1, v42
    v_lshl_add_u32 v42, v42, 4, s84
    v_mul_u32_u24 v42, 205, v42
    v_lshrrev_b32 v42, 10, v42
    v_add_u32 v42, s3, v42
    v_and_b32 v42, 15, v42
    v_lshl_add_u32 v42, v42, 5, v43
    v_mul_u32_u24 v42, 3072, v42
    buffer_load_dword v250, v42, s[16:19], s20 offen
    v_mov_b32 v42, 4
    v_lshl_add_u32 v43, s87, 4, v38
    v_add_u32 v42, 1, v42
    v_lshl_add_u32 v42, v42, 4, s84
    v_mul_u32_u24 v42, 205, v42
    v_lshrrev_b32 v42, 10, v42
    v_add_u32 v42, s3, v42
    v_and_b32 v42, 15, v42
    v_lshl_add_u32 v42, v42, 5, v43
    v_mul_u32_u24 v42, 3072, v42
    s_mov_b64 exec, 0xffff
    buffer_load_dword v251, v42, s[16:19], s20 offen
    s_mov_b64 exec, -1
L_Anh:
    s_mov_b32 s6, 14680064
    s_mov_b32 s7, 0x20000
    s_mov_b32 s26, 2621440
    s_mov_b32 s27, 0x20000
    s_add_u32 s33, s68, 2048
    s_and_b32 s70, s33, 0x3c00
    s_add_u32 s33, s68, 3072
    s_and_b32 s71, s33, 0x3c00
    s_add_u32 s33, s68, 4096
    s_and_b32 s72, s33, 0x3c00
    s_add_u32 s33, s68, 5120
    s_and_b32 s73, s33, 0x3c00
    s_add_u32 s33, s68, 6144
    s_and_b32 s74, s33, 0x3c00
    s_add_u32 s33, s68, 7168
    s_and_b32 s75, s33, 0x3c00
    s_add_u32 s33, s68, 8192
    s_and_b32 s76, s33, 0x3c00
    s_add_u32 s33, s68, 9216
    s_and_b32 s77, s33, 0x3c00
    s_add_u32 s33, s68, 10240
    s_and_b32 s78, s33, 0x3c00
    s_add_u32 s33, s68, 11264
    s_and_b32 s79, s33, 0x3c00
    s_add_u32 s33, s68, 12288
    s_and_b32 s80, s33, 0x3c00
    s_add_u32 s33, s68, 13312
    s_and_b32 s81, s33, 0x3c00
    s_add_u32 s33, s68, 14336
    s_and_b32 s82, s33, 0x3c00
    s_add_u32 s33, s68, 15360
    s_and_b32 s83, s33, 0x3c00
    s_add_u32 s4, s66, 0
    s_addc_u32 s5, s67, 0
    s_mov_b64 s[24:25], s[44:45]
    v_lshrrev_b32 v42, 2, v0
    v_lshlrev_b32 v42, 7, v42
    v_lshl_add_u32 v42, v40, 3, v42
    v_bfe_u32 v43, v0, 3, 2
    v_lshl_add_u32 v42, v43, 5, v42
    v_add_u32 v6, s92, v42
    v_xor_b32 v7, 32, v6
    v_xor_b32 v8, 64, v6
    v_xor_b32 v9, 96, v6
    s_add_u32 s95, s89, 128
    s_mul_i32 s95, s95, 128
    s_lshl1_add_u32 s32, s35, s34
    s_lshl2_add_u32 s95, s32, s95
    s_add_u32 s95, s95, 10158080
    s_lshl_b32 s39, s85, 7
    s_lshl1_add_u32 s93, s86, s39
    s_add_u32 s93, s93, 64
    s_add_u32 s39, s89, 512
    s_lshl_b32 s32, s93, 1
    s_load_dword s28, s[46:47], s32
    s_lshr_b32 s33, s39, 1
    s_lshl_b32 s29, s33, 2
    s_load_dword s30, s[46:47], s29
    s_lshl_b32 s31, s93, 12
    s_lshl_b32 s33, s84, 10
    s_add_u32 s31, s31, s33
    s_add_u32 s48, s31, 4096
    s_lshl_b32 s49, s39, 12
    s_add_u32 s49, s49, s33
    s_add_u32 s33, s33, 4980736
    s_mul_i32 s40, s93, 4224
    s_add_u32 s40, s40, s33
    s_add_u32 s41, s40, 4224
    s_mul_i32 s50, s39, 4224
    s_add_u32 s50, s50, s33
    v_mov_b32 v68, 0
    v_mov_b32 v69, 0
    v_mov_b32 v70, 0
    v_mov_b32 v71, 0
    s_min_u32 s32, s84, 2
    s_mul_i32 s33, s32, 4608
    s_add_u32 s33, s33, 139648
    v_add_u32 v42, s33, v1
    s_mul_i32 s33, s32, 4224
    s_add_u32 s33, s33, 126976
    v_add_u32 v43, s33, v1
    s_mul_i32 s33, s32, 528
    s_add_u32 s33, s33, 153472
    v_mov_b32 v18, s33
    s_mov_b32 exec_hi, 0
    ds_write_b128 v42, v[68:71]
    s_mov_b64 exec, 0x3f
    ds_write_b128 v43, v[68:71]
    s_mov_b64 exec, 1
    ds_write_b128 v18, v[68:71]
    s_mov_b64 exec, -1
    v_lshl_add_u32 v42, v37, 3, v39
    v_lshlrev_b32 v43, 2, v40
    v_sub_u32 v43, v43, v42
    v_lshlrev_b32 v43, 3, v43
    s_mul_i32 s32, s34, 4224
    s_add_u32 s32, s32, 127192
    v_add_u32 v20, s32, v43
    v_add_u32 v22, 135640, v43
    v_add_lshl_u32 v42, v42, v40, 3
    s_mul_i32 s32, s34, 4608
    s_lshl_b32 s33, s35, 7
    s_add_u32 s32, s32, s33
    s_add_u32 s32, s32, 140008
    v_add_u32 v21, s32, v42
    s_lshl_b32 s32, s84, 7
    s_add_u32 s32, s32, 148968
    v_add_u32 v23, s32, v42
    s_mul_i32 s38, s88, 0
    s_add_u32 s38, s38, s84
    s_and_b32 s38, s38, 3
    s_mul_i32 s3, s87, 263168
    s_lshl_b32 s33, s84, 14
    s_add_u32 s3, s3, s33
    s_add_u32 s3, s3, s90
    s_add_u32 s32, s38, 1
    s_and_b32 s32, s32, 3
    s_mul_i32 s33, s32, 12288
    s_add_u32 s33, s33, 65536
    v_add_u32 v44, s33, v1
    s_mul_i32 s32, s32, 65792
    s_add_u32 s32, s32, s3
    v_add_u32 v10, s32, v1
    v_add_u32 v14, 1315840, v10
    s_add_u32 s32, s38, 2
    s_and_b32 s32, s32, 3
    s_mul_i32 s33, s32, 12288
    s_add_u32 s33, s33, 69632
    v_add_u32 v45, s33, v1
    s_mul_i32 s32, s32, 65792
    s_add_u32 s32, s32, s3
    v_add_u32 v11, s32, v1
    v_add_u32 v15, 1315840, v11
    s_add_u32 s32, s38, 3
    s_and_b32 s32, s32, 3
    s_mul_i32 s33, s32, 12288
    s_add_u32 s33, s33, 73728
    v_add_u32 v46, s33, v1
    s_mul_i32 s32, s32, 65792
    s_add_u32 s32, s32, s3
    v_add_u32 v12, s32, v1
    v_add_u32 v16, 1315840, v12
    s_add_u32 s32, s38, 4
    s_and_b32 s32, s32, 3
    s_mul_i32 s33, s32, 12288
    s_add_u32 s33, s33, 65536
    v_add_u32 v47, s33, v1
    s_mul_i32 s32, s32, 65792
    s_add_u32 s32, s32, s3
    v_add_u32 v13, s32, v1
    v_add_u32 v17, 1315840, v13
    v_lshl_add_u32 v35, s84, 5, v0
    v_mul_u32_u24 v35, 32, v35
    v_add_u32 v35, 10027008, v35
    s_lshl_b32 s32, s88, 7
    v_lshl_add_u32 v50, v37, 3, s32
    s_lshl2_add_u32 s32, s87, s38
    s_mul_i32 s94, s32, 24
    s_add_u32 s94, s94, s88
    s_mul_i32 s94, s94, 64
    s_add_u32 s94, s94, 10092544
    s_add_u32 s94, s94, s90
    s_mul_i32 s32, s32, 48
    s_lshl1_add_u32 s32, s88, s32
    s_lshl_b32 s32, s32, 10
    s_add_u32 s32, s32, 2883584
    s_add_u32 s32, s32, s90
    v_add_u32 v48, s32, v1
    s_mov_b32 s22, 0xbdd2d3e8
    s_mov_b32 s23, 983040
    v_mov_b32 v52, 0xc0135761
    s_mul_i32 s32, s34, 528
    s_lshl4_add_u32 s32, s35, s32
    s_add_u32 s32, s32, 153472
    v_lshlrev_b32 v42, 2, v40
    v_lshl_add_u32 v43, v39, 5, v42
    v_add_u32 v27, s32, v43
    s_add_u32 s32, s32, 4294965776
    v_lshl_add_u32 v25, v0, 5, s32
    s_lshl_b32 s32, s84, 4
    s_add_u32 s32, s32, 154528
    v_lshl_add_u32 v43, v39, 6, v42
    v_add_u32 v28, s32, v43
    s_add_u32 s32, s32, 4294963728
    v_lshl_add_u32 v26, v0, 6, s32
    s_mul_i32 s32, s84, 3072
    s_add_u32 s32, s32, 114688
    v_lshl_add_u32 v29, v0, 1, s32
    v_add_u32 v30, s32, v1
    v_lshl_add_u32 v42, v40, 1, s32
    v_lshl_add_u32 v252, v39, 7, v42
    v_lshrrev_b32 v42, 3, v0
    v_and_b32 v43, 7, v0
    v_lshlrev_b32 v43, 4, v43
    v_lshl_add_u32 v31, v42, 8, v43
    s_add_u32 s32, s93, s34
    s_mul_i32 s32, s32, 4224
    s_lshl_b32 s33, s35, 7
    s_add_u32 s32, s32, s33
    s_add_u32 s32, s32, 10551296
    v_add_u32 v31, s32, v31
    v_lshl_add_u32 v32, v42, 9, v43
    s_mul_i32 s32, s39, 4224
    s_lshl_b32 s33, s84, 7
    s_add_u32 s32, s32, s33
    s_add_u32 s32, s32, 10551296
    v_add_u32 v32, s32, v32
    s_and_b32 s32, s39, 1
    s_lshl_b32 s32, s32, 4
    s_waitcnt lgkmcnt(0)
    s_lshr_b32 s30, s30, s32
    s_lshl_b32 s30, s30, 16
    s_lshl_b32 s32, s34, 4
    s_lshr_b32 s28, s28, s32
    s_lshl_b32 s28, s28, 16
    s_lshl_b32 s29, s84, 10
    s_cmp_ge_u32 s93, 320
    s_cselect_b32 s32, 1, 0
    v_max_u32 v24, s32, v37
    v_lshl_add_u32 v24, v24, 2, s84
    v_lshl_add_u32 v24, v24, 4, v38
    v_mul_u32_u24 v24, 64, v24
    v_add_u32 v24, 10059776, v24
    s_mov_b32 s32, 10223616
    s_mov_b64 exec, 1
    buffer_load_dword v49, v0, s[4:7], s32 offen sc1
    s_mov_b64 exec, -1
    global_load_dwordx2 v[54:55], v50, s[54:55] offset:0
    global_load_dwordx2 v[56:57], v50, s[54:55] offset:32
    global_load_dwordx2 v[58:59], v50, s[54:55] offset:64
    global_load_dwordx2 v[60:61], v50, s[54:55] offset:96
    s_cmp_ge_u32 s86, 30
    s_cbranch_scc1 L_Aspare
    s_mul_i32 s21, s70, 96
    s_add_u32 m0, s92, 32768
    s_nop 0
    buffer_load_dwordx4 v2, s[16:19], s21 offen offset:0  lds
    buffer_load_dwordx4 v3, s[16:19], s21 offen offset:1024  lds
    buffer_load_dwordx4 v4, s[16:19], s21 offen offset:2048  lds
    buffer_load_dwordx4 v5, s[16:19], s21 offen offset:3072  lds
    s_mul_i32 s21, s71, 96
    s_add_u32 m0, s92, 49152
    s_nop 0
    buffer_load_dwordx4 v2, s[16:19], s21 offen offset:0  lds
    buffer_load_dwordx4 v3, s[16:19], s21 offen offset:1024  lds
    buffer_load_dwordx4 v4, s[16:19], s21 offen offset:2048  lds
    buffer_load_dwordx4 v5, s[16:19], s21 offen offset:3072  lds
    s_waitcnt vmcnt(17)
    ds_read_b64_tr_b16 a[0:1], v6 offset:0
    ds_read_b64_tr_b16 a[2:3], v6 offset:2048
    ds_read_b64_tr_b16 a[4:5], v7 offset:0
    ds_read_b64_tr_b16 a[6:7], v7 offset:2048
    ds_read_b64_tr_b16 a[8:9], v8 offset:0
    ds_read_b64_tr_b16 a[10:11], v8 offset:2048
    ds_read_b64_tr_b16 a[12:13], v9 offset:0
    ds_read_b64_tr_b16 a[14:15], v9 offset:2048
    s_mul_i32 s21, s72, 96
    s_add_u32 m0, s92, 0
    s_waitcnt lgkmcnt(0)
    buffer_load_dwordx4 v2, s[16:19], s21 offen offset:0  lds
    buffer_load_dwordx4 v3, s[16:19], s21 offen offset:1024  lds
    buffer_load_dwordx4 v4, s[16:19], s21 offen offset:2048  lds
    buffer_load_dwordx4 v5, s[16:19], s21 offen offset:3072  lds
    s_waitcnt vmcnt(17)
    ds_read_b64_tr_b16 a[16:17], v6 offset:16384
    ds_read_b64_tr_b16 a[18:19], v6 offset:18432
    ds_read_b64_tr_b16 a[20:21], v7 offset:16384
    ds_read_b64_tr_b16 a[22:23], v7 offset:18432
    ds_read_b64_tr_b16 a[24:25], v8 offset:16384
    ds_read_b64_tr_b16 a[26:27], v8 offset:18432
    ds_read_b64_tr_b16 a[28:29], v9 offset:16384
    ds_read_b64_tr_b16 a[30:31], v9 offset:18432
    s_mul_i32 s21, s73, 96
    s_add_u32 m0, s92, 16384
    s_waitcnt lgkmcnt(0)
    buffer_load_dwordx4 v2, s[16:19], s21 offen offset:0  lds
    buffer_load_dwordx4 v3, s[16:19], s21 offen offset:1024  lds
    buffer_load_dwordx4 v4, s[16:19], s21 offen offset:2048  lds
    buffer_load_dwordx4 v5, s[16:19], s21 offen offset:3072  lds
    s_waitcnt vmcnt(12)
    ds_read_b64_tr_b16 a[32:33], v6 offset:32768
    ds_read_b64_tr_b16 a[34:35], v6 offset:34816
    ds_read_b64_tr_b16 a[36:37], v7 offset:32768
    ds_read_b64_tr_b16 a[38:39], v7 offset:34816
    ds_read_b64_tr_b16 a[40:41], v8 offset:32768
    ds_read_b64_tr_b16 a[42:43], v8 offset:34816
    ds_read_b64_tr_b16 a[44:45], v9 offset:32768
    ds_read_b64_tr_b16 a[46:47], v9 offset:34816
    s_mul_i32 s21, s74, 96
    s_add_u32 m0, s92, 32768
    s_waitcnt lgkmcnt(0)
    buffer_load_dwordx4 v2, s[16:19], s21 offen offset:0  lds
    buffer_load_dwordx4 v3, s[16:19], s21 offen offset:1024  lds
    buffer_load_dwordx4 v4, s[16:19], s21 offen offset:2048  lds
    buffer_load_dwordx4 v5, s[16:19], s21 offen offset:3072  lds
    s_waitcnt vmcnt(12)
    ds_read_b64_tr_b16 a[48:49], v6 offset:49152
    ds_read_b64_tr_b16 a[50:51], v6 offset:51200
    ds_read_b64_tr_b16 a[52:53], v7 offset:49152
    ds_read_b64_tr_b16 a[54:55], v7 offset:51200
    ds_read_b64_tr_b16 a[56:57], v8 offset:49152
    ds_read_b64_tr_b16 a[58:59], v8 offset:51200
    ds_read_b64_tr_b16 a[60:61], v9 offset:49152
    ds_read_b64_tr_b16 a[62:63], v9 offset:51200
    s_mul_i32 s21, s75, 96
    s_add_u32 m0, s92, 49152
    s_waitcnt lgkmcnt(0)
    buffer_load_dwordx4 v2, s[16:19], s21 offen offset:0  lds
    buffer_load_dwordx4 v3, s[16:19], s21 offen offset:1024  lds
    buffer_load_dwordx4 v4, s[16:19], s21 offen offset:2048  lds
    buffer_load_dwordx4 v5, s[16:19], s21 offen offset:3072  lds
    v_readfirstlane_b32 s91, v49
    s_nop 0
    s_add_u32 s91, s91, 0x9e3779b9
    v_mov_b32 v34, s91
    v_lshlrev_b32 v112, 16, v54
    v_and_b32 v113, 0xffff0000, v54
    v_lshlrev_b32 v114, 16, v55
    v_and_b32 v115, 0xffff0000, v55
    v_lshlrev_b32 v116, 16, v56
    v_and_b32 v117, 0xffff0000, v56
    v_lshlrev_b32 v118, 16, v57
    v_and_b32 v119, 0xffff0000, v57
    v_lshlrev_b32 v120, 16, v58
    v_and_b32 v121, 0xffff0000, v58
    v_lshlrev_b32 v122, 16, v59
    v_and_b32 v123, 0xffff0000, v59
    v_lshlrev_b32 v124, 16, v60
    v_and_b32 v125, 0xffff0000, v60
    v_lshlrev_b32 v126, 16, v61
    v_and_b32 v127, 0xffff0000, v61
    s_waitcnt vmcnt(12)
    ds_read_b64_tr_b16 a[64:65], v6 offset:0
    ds_read_b64_tr_b16 a[66:67], v6 offset:2048
    ds_read_b64_tr_b16 a[68:69], v7 offset:0
    ds_read_b64_tr_b16 a[70:71], v7 offset:2048
    ds_read_b64_tr_b16 a[72:73], v8 offset:0
    ds_read_b64_tr_b16 a[74:75], v8 offset:2048
    ds_read_b64_tr_b16 a[76:77], v9 offset:0
    ds_read_b64_tr_b16 a[78:79], v9 offset:2048
    s_mul_i32 s21, s76, 96
    s_add_u32 m0, s92, 0
    s_waitcnt lgkmcnt(0)
    buffer_load_dwordx4 v2, s[16:19], s21 offen offset:0  lds
    buffer_load_dwordx4 v3, s[16:19], s21 offen offset:1024  lds
    buffer_load_dwordx4 v4, s[16:19], s21 offen offset:2048  lds
    buffer_load_dwordx4 v5, s[16:19], s21 offen offset:3072  lds
    s_waitcnt vmcnt(12)
    ds_read_b64_tr_b16 a[80:81], v6 offset:16384
    ds_read_b64_tr_b16 a[82:83], v6 offset:18432
    ds_read_b64_tr_b16 a[84:85], v7 offset:16384
    ds_read_b64_tr_b16 a[86:87], v7 offset:18432
    ds_read_b64_tr_b16 a[88:89], v8 offset:16384
    ds_read_b64_tr_b16 a[90:91], v8 offset:18432
    ds_read_b64_tr_b16 a[92:93], v9 offset:16384
    ds_read_b64_tr_b16 a[94:95], v9 offset:18432
    s_mul_i32 s21, s77, 96
    s_add_u32 m0, s92, 16384
    s_waitcnt lgkmcnt(0)
    buffer_load_dwordx4 v2, s[16:19], s21 offen offset:0  lds
    buffer_load_dwordx4 v3, s[16:19], s21 offen offset:1024  lds
    buffer_load_dwordx4 v4, s[16:19], s21 offen offset:2048  lds
    buffer_load_dwordx4 v5, s[16:19], s21 offen offset:3072  lds
    s_waitcnt vmcnt(12)
    ds_read_b64_tr_b16 a[96:97], v6 offset:32768
    ds_read_b64_tr_b16 a[98:99], v6 offset:34816
    ds_read_b64_tr_b16 a[100:101], v7 offset:32768
    ds_read_b64_tr_b16 a[102:103], v7 offset:34816
    ds_read_b64_tr_b16 a[104:105], v8 offset:32768
    ds_read_b64_tr_b16 a[106:107], v8 offset:34816
    ds_read_b64_tr_b16 a[108:109], v9 offset:32768
    ds_read_b64_tr_b16 a[110:111], v9 offset:34816
    s_mul_i32 s21, s78, 96
    s_add_u32 m0, s92, 32768
    s_waitcnt lgkmcnt(0)
    buffer_load_dwordx4 v2, s[16:19], s21 offen offset:0  lds
    buffer_load_dwordx4 v3, s[16:19], s21 offen offset:1024  lds
    buffer_load_dwordx4 v4, s[16:19], s21 offen offset:2048  lds
    buffer_load_dwordx4 v5, s[16:19], s21 offen offset:3072  lds
    s_waitcnt vmcnt(12)
    ds_read_b64_tr_b16 a[112:113], v6 offset:49152
    ds_read_b64_tr_b16 a[114:115], v6 offset:51200
    ds_read_b64_tr_b16 a[116:117], v7 offset:49152
    ds_read_b64_tr_b16 a[118:119], v7 offset:51200
    ds_read_b64_tr_b16 a[120:121], v8 offset:49152
    ds_read_b64_tr_b16 a[122:123], v8 offset:51200
    ds_read_b64_tr_b16 a[124:125], v9 offset:49152
    ds_read_b64_tr_b16 a[126:127], v9 offset:51200
    s_mul_i32 s21, s79, 96
    s_add_u32 m0, s92, 49152
    s_waitcnt lgkmcnt(0)
    buffer_load_dwordx4 v2, s[16:19], s21 offen offset:0  lds
    buffer_load_dwordx4 v3, s[16:19], s21 offen offset:1024  lds
    buffer_load_dwordx4 v4, s[16:19], s21 offen offset:2048  lds
    buffer_load_dwordx4 v5, s[16:19], s21 offen offset:3072  lds
    s_waitcnt vmcnt(12)
    ds_read_b64_tr_b16 a[128:129], v6 offset:0
    ds_read_b64_tr_b16 a[130:131], v6 offset:2048
    ds_read_b64_tr_b16 a[132:133], v7 offset:0
    ds_read_b64_tr_b16 a[134:135], v7 offset:2048
    ds_read_b64_tr_b16 a[136:137], v8 offset:0
    ds_read_b64_tr_b16 a[138:139], v8 offset:2048
    ds_read_b64_tr_b16 a[140:141], v9 offset:0
    ds_read_b64_tr_b16 a[142:143], v9 offset:2048
    s_mul_i32 s21, s80, 96
    s_add_u32 m0, s92, 0
    s_waitcnt lgkmcnt(0)
    buffer_load_dwordx4 v2, s[16:19], s21 offen offset:0  lds
    buffer_load_dwordx4 v3, s[16:19], s21 offen offset:1024  lds
    buffer_load_dwordx4 v4, s[16:19], s21 offen offset:2048  lds
    buffer_load_dwordx4 v5, s[16:19], s21 offen offset:3072  lds
    s_waitcnt vmcnt(12)
    ds_read_b64_tr_b16 a[144:145], v6 offset:16384
    ds_read_b64_tr_b16 a[146:147], v6 offset:18432
    ds_read_b64_tr_b16 a[148:149], v7 offset:16384
    ds_read_b64_tr_b16 a[150:151], v7 offset:18432
    ds_read_b64_tr_b16 a[152:153], v8 offset:16384
    ds_read_b64_tr_b16 a[154:155], v8 offset:18432
    ds_read_b64_tr_b16 a[156:157], v9 offset:16384
    ds_read_b64_tr_b16 a[158:159], v9 offset:18432
    s_mul_i32 s21, s81, 96
    s_add_u32 m0, s92, 16384
    s_waitcnt lgkmcnt(0)
    buffer_load_dwordx4 v2, s[16:19], s21 offen offset:0  lds
    buffer_load_dwordx4 v3, s[16:19], s21 offen offset:1024  lds
    buffer_load_dwordx4 v4, s[16:19], s21 offen offset:2048  lds
    buffer_load_dwordx4 v5, s[16:19], s21 offen offset:3072  lds
    s_waitcnt vmcnt(12)
    ds_read_b64_tr_b16 a[160:161], v6 offset:32768
    ds_read_b64_tr_b16 a[162:163], v6 offset:34816
    ds_read_b64_tr_b16 a[164:165], v7 offset:32768
    ds_read_b64_tr_b16 a[166:167], v7 offset:34816
    ds_read_b64_tr_b16 a[168:169], v8 offset:32768
    ds_read_b64_tr_b16 a[170:171], v8 offset:34816
    ds_read_b64_tr_b16 a[172:173], v9 offset:32768
    ds_read_b64_tr_b16 a[174:175], v9 offset:34816
    s_mov_b32 exec_hi, 0
    buffer_load_dword v248, v35, s[4:7], 0 offen sc1
    s_mov_b64 exec, -1
    s_mul_i32 s21, s82, 96
    s_add_u32 m0, s92, 32768
    s_waitcnt lgkmcnt(0)
    buffer_load_dwordx4 v2, s[16:19], s21 offen offset:0  lds
    buffer_load_dwordx4 v3, s[16:19], s21 offen offset:1024  lds
    buffer_load_dwordx4 v4, s[16:19], s21 offen offset:2048  lds
    buffer_load_dwordx4 v5, s[16:19], s21 offen offset:3072  lds
    s_waitcnt vmcnt(13)
    ds_read_b64_tr_b16 a[176:177], v6 offset:49152
    ds_read_b64_tr_b16 a[178:179], v6 offset:51200
    ds_read_b64_tr_b16 a[180:181], v7 offset:49152
    ds_read_b64_tr_b16 a[182:183], v7 offset:51200
    ds_read_b64_tr_b16 a[184:185], v8 offset:49152
    ds_read_b64_tr_b16 a[186:187], v8 offset:51200
    ds_read_b64_tr_b16 a[188:189], v9 offset:49152
    ds_read_b64_tr_b16 a[190:191], v9 offset:51200
    s_mul_i32 s21, s83, 96
    s_add_u32 m0, s92, 49152
    s_waitcnt lgkmcnt(0)
    buffer_load_dwordx4 v2, s[16:19], s21 offen offset:0  lds
    buffer_load_dwordx4 v3, s[16:19], s21 offen offset:1024  lds
    buffer_load_dwordx4 v4, s[16:19], s21 offen offset:2048  lds
    buffer_load_dwordx4 v5, s[16:19], s21 offen offset:3072  lds
    s_waitcnt vmcnt(13)
    ds_read_b64_tr_b16 a[192:193], v6 offset:0
    ds_read_b64_tr_b16 a[194:195], v6 offset:2048
    ds_read_b64_tr_b16 a[196:197], v7 offset:0
    ds_read_b64_tr_b16 a[198:199], v7 offset:2048
    ds_read_b64_tr_b16 a[200:201], v8 offset:0
    ds_read_b64_tr_b16 a[202:203], v8 offset:2048
    ds_read_b64_tr_b16 a[204:205], v9 offset:0
    ds_read_b64_tr_b16 a[206:207], v9 offset:2048
    s_waitcnt vmcnt(9)
    ds_read_b64_tr_b16 a[208:209], v6 offset:16384
    ds_read_b64_tr_b16 a[210:211], v6 offset:18432
    ds_read_b64_tr_b16 a[212:213], v7 offset:16384
    ds_read_b64_tr_b16 a[214:215], v7 offset:18432
    ds_read_b64_tr_b16 a[216:217], v8 offset:16384
    ds_read_b64_tr_b16 a[218:219], v8 offset:18432
    ds_read_b64_tr_b16 a[220:221], v9 offset:16384
    ds_read_b64_tr_b16 a[222:223], v9 offset:18432
    s_mov_b32 exec_hi, 0
    s_waitcnt vmcnt(8)
    v_cmp_ne_u32 vcc, s91, v248
    s_mov_b32 s3, 0
    s_cbranch_vccz L_pk_Af1
L_pl_Af1:
    s_mov_b64 exec, vcc
    buffer_load_dword v248, v35, s[4:7], 0 offen sc1
    s_add_u32 s3, s3, 1
    s_cmp_ge_u32 s3, 0x40000
    s_cbranch_scc1 L_pk_Af1
    s_waitcnt vmcnt(0)
    v_cmp_ne_u32 vcc, s91, v248
    s_nop 0
    s_cbranch_vccnz L_pl_Af1
L_pk_Af1:
    s_mov_b64 exec, -1
    buffer_load_dwordx4 v[64:67], v10, s[4:7], s68 offen sc1
    buffer_load_dwordx4 v[68:71], v10, s[4:7], s69 offen sc1
    buffer_load_dwordx4 v[72:75], v10, s[4:7], s70 offen sc1
    buffer_load_dwordx4 v[76:79], v10, s[4:7], s71 offen sc1
    s_waitcnt vmcnt(8)
    ds_read_b64_tr_b16 a[224:225], v6 offset:32768
    ds_read_b64_tr_b16 a[226:227], v6 offset:34816
    ds_read_b64_tr_b16 a[228:229], v7 offset:32768
    ds_read_b64_tr_b16 a[230:231], v7 offset:34816
    ds_read_b64_tr_b16 a[232:233], v8 offset:32768
    ds_read_b64_tr_b16 a[234:235], v8 offset:34816
    ds_read_b64_tr_b16 a[236:237], v9 offset:32768
    ds_read_b64_tr_b16 a[238:239], v9 offset:34816
    buffer_load_dwordx4 v[80:83], v10, s[4:7], s72 offen sc1
    buffer_load_dwordx4 v[84:87], v10, s[4:7], s73 offen sc1
    buffer_load_dwordx4 v[88:91], v10, s[4:7], s74 offen sc1
    buffer_load_dwordx4 v[92:95], v10, s[4:7], s75 offen sc1
    s_waitcnt vmcnt(8)
    ds_read_b64_tr_b16 a[240:241], v6 offset:49152
    ds_read_b64_tr_b16 a[242:243], v6 offset:51200
    ds_read_b64_tr_b16 a[244:245], v7 offset:49152
    ds_read_b64_tr_b16 a[246:247], v7 offset:51200
    ds_read_b64_tr_b16 a[248:249], v8 offset:49152
    ds_read_b64_tr_b16 a[250:251], v8 offset:51200
    ds_read_b64_tr_b16 a[252:253], v9 offset:49152
    ds_read_b64_tr_b16 a[254:255], v9 offset:51200
    s_waitcnt vmcnt(7)
    v_mfma_f32_16x16x32_bf16 v[96:99], a[0:3], v[64:67], 0
    buffer_load_dwordx4 v[128:131], v10, s[4:7], s76 offen sc1
    s_waitcnt vmcnt(7)
    v_mfma_f32_16x16x32_bf16 v[96:99], a[16:19], v[68:71], v[96:99]
    v_mfma_f32_16x16x32_bf16 v[100:103], a[4:7], v[64:67], 0
    buffer_load_dwordx4 v[132:135], v10, s[4:7], s77 offen sc1
    v_mfma_f32_16x16x32_bf16 v[100:103], a[20:23], v[68:71], v[100:103]
    v_mfma_f32_16x16x32_bf16 v[104:107], a[8:11], v[64:67], 0
    buffer_load_dwordx4 v[136:139], v10, s[4:7], s78 offen sc1
    v_mfma_f32_16x16x32_bf16 v[104:107], a[24:27], v[68:71], v[104:107]
    v_mfma_f32_16x16x32_bf16 v[108:111], a[12:15], v[64:67], 0
    buffer_load_dwordx4 v[140:143], v10, s[4:7], s79 offen sc1
    v_mfma_f32_16x16x32_bf16 v[108:111], a[28:31], v[68:71], v[108:111]
    s_waitcnt vmcnt(9)
    v_mfma_f32_16x16x32_bf16 v[96:99], a[32:35], v[72:75], v[96:99]
    buffer_load_dwordx4 v[228:231], v10, s[4:7], s80 offen sc1
    s_waitcnt vmcnt(9)
    v_mfma_f32_16x16x32_bf16 v[96:99], a[48:51], v[76:79], v[96:99]
    v_mfma_f32_16x16x32_bf16 v[100:103], a[36:39], v[72:75], v[100:103]
    buffer_load_dwordx4 v[232:235], v10, s[4:7], s81 offen sc1
    v_mfma_f32_16x16x32_bf16 v[100:103], a[52:55], v[76:79], v[100:103]
    v_mfma_f32_16x16x32_bf16 v[104:107], a[40:43], v[72:75], v[104:107]
    buffer_load_dwordx4 v[64:67], v10, s[4:7], s82 offen sc1
    v_mfma_f32_16x16x32_bf16 v[104:107], a[56:59], v[76:79], v[104:107]
    v_mfma_f32_16x16x32_bf16 v[108:111], a[44:47], v[72:75], v[108:111]
    buffer_load_dwordx4 v[68:71], v10, s[4:7], s83 offen sc1
    v_mfma_f32_16x16x32_bf16 v[108:111], a[60:63], v[76:79], v[108:111]
    s_waitcnt vmcnt(11)
    v_mfma_f32_16x16x32_bf16 v[96:99], a[64:67], v[80:83], v[96:99]
    s_waitcnt vmcnt(10)
    v_mfma_f32_16x16x32_bf16 v[96:99], a[80:83], v[84:87], v[96:99]
    buffer_load_dwordx4 v[72:75], v11, s[4:7], s68 offen sc1
    v_mfma_f32_16x16x32_bf16 v[100:103], a[68:71], v[80:83], v[100:103]
    v_mfma_f32_16x16x32_bf16 v[100:103], a[84:87], v[84:87], v[100:103]
    v_mfma_f32_16x16x32_bf16 v[104:107], a[72:75], v[80:83], v[104:107]
    v_mfma_f32_16x16x32_bf16 v[104:107], a[88:91], v[84:87], v[104:107]
    buffer_load_dwordx4 v[76:79], v11, s[4:7], s69 offen sc1
    v_mfma_f32_16x16x32_bf16 v[108:111], a[76:79], v[80:83], v[108:111]
    v_mfma_f32_16x16x32_bf16 v[108:111], a[92:95], v[84:87], v[108:111]
    s_waitcnt vmcnt(11)
    v_mfma_f32_16x16x32_bf16 v[96:99], a[96:99], v[88:91], v[96:99]
    s_waitcnt vmcnt(10)
    v_mfma_f32_16x16x32_bf16 v[96:99], a[112:115], v[92:95], v[96:99]
    buffer_load_dwordx4 v[80:83], v11, s[4:7], s70 offen sc1
    v_mfma_f32_16x16x32_bf16 v[100:103], a[100:103], v[88:91], v[100:103]
    v_mfma_f32_16x16x32_bf16 v[100:103], a[116:119], v[92:95], v[100:103]
    v_mfma_f32_16x16x32_bf16 v[104:107], a[104:107], v[88:91], v[104:107]
    v_mfma_f32_16x16x32_bf16 v[104:107], a[120:123], v[92:95], v[104:107]
    buffer_load_dwordx4 v[84:87], v11, s[4:7], s71 offen sc1
    v_mfma_f32_16x16x32_bf16 v[108:111], a[108:111], v[88:91], v[108:111]
    v_mfma_f32_16x16x32_bf16 v[108:111], a[124:127], v[92:95], v[108:111]
    s_waitcnt vmcnt(11)
    v_mfma_f32_16x16x32_bf16 v[96:99], a[128:131], v[128:131], v[96:99]
    s_waitcnt vmcnt(10)
    v_mfma_f32_16x16x32_bf16 v[96:99], a[144:147], v[132:135], v[96:99]
    buffer_load_dwordx4 v[88:91], v11, s[4:7], s72 offen sc1
    v_mfma_f32_16x16x32_bf16 v[100:103], a[132:135], v[128:131], v[100:103]
    v_mfma_f32_16x16x32_bf16 v[100:103], a[148:151], v[132:135], v[100:103]
    v_mfma_f32_16x16x32_bf16 v[104:107], a[136:139], v[128:131], v[104:107]
    v_mfma_f32_16x16x32_bf16 v[104:107], a[152:155], v[132:135], v[104:107]
    buffer_load_dwordx4 v[92:95], v11, s[4:7], s73 offen sc1
    v_mfma_f32_16x16x32_bf16 v[108:111], a[140:143], v[128:131], v[108:111]
    v_mfma_f32_16x16x32_bf16 v[108:111], a[156:159], v[132:135], v[108:111]
    s_waitcnt vmcnt(11)
    v_mfma_f32_16x16x32_bf16 v[96:99], a[160:163], v[136:139], v[96:99]
    s_waitcnt vmcnt(10)
    v_mfma_f32_16x16x32_bf16 v[96:99], a[176:179], v[140:143], v[96:99]
    buffer_load_dwordx4 v[128:131], v11, s[4:7], s74 offen sc1
    v_mfma_f32_16x16x32_bf16 v[100:103], a[164:167], v[136:139], v[100:103]
    v_mfma_f32_16x16x32_bf16 v[100:103], a[180:183], v[140:143], v[100:103]
    v_mfma_f32_16x16x32_bf16 v[104:107], a[168:171], v[136:139], v[104:107]
    v_mfma_f32_16x16x32_bf16 v[104:107], a[184:187], v[140:143], v[104:107]
    buffer_load_dwordx4 v[132:135], v11, s[4:7], s75 offen sc1
    v_mfma_f32_16x16x32_bf16 v[108:111], a[172:175], v[136:139], v[108:111]
    v_mfma_f32_16x16x32_bf16 v[108:111], a[188:191], v[140:143], v[108:111]
    s_waitcnt vmcnt(11) lgkmcnt(15)
    v_mfma_f32_16x16x32_bf16 v[96:99], a[192:195], v[228:231], v[96:99]
    s_waitcnt vmcnt(10) lgkmcnt(15)
    v_mfma_f32_16x16x32_bf16 v[96:99], a[208:211], v[232:235], v[96:99]
    buffer_load_dwordx4 v[136:139], v11, s[4:7], s76 offen sc1
    v_mfma_f32_16x16x32_bf16 v[100:103], a[196:199], v[228:231], v[100:103]
    s_waitcnt lgkmcnt(15)
    v_mfma_f32_16x16x32_bf16 v[100:103], a[212:215], v[232:235], v[100:103]
    v_mfma_f32_16x16x32_bf16 v[104:107], a[200:203], v[228:231], v[104:107]
    s_waitcnt lgkmcnt(15)
    v_mfma_f32_16x16x32_bf16 v[104:107], a[216:219], v[232:235], v[104:107]
    buffer_load_dwordx4 v[140:143], v11, s[4:7], s77 offen sc1
    v_mfma_f32_16x16x32_bf16 v[108:111], a[204:207], v[228:231], v[108:111]
    s_waitcnt lgkmcnt(15)
    v_mfma_f32_16x16x32_bf16 v[108:111], a[220:223], v[232:235], v[108:111]
    s_waitcnt vmcnt(11) lgkmcnt(14)
    v_mfma_f32_16x16x32_bf16 v[96:99], a[224:227], v[64:67], v[96:99]
    s_waitcnt vmcnt(10) lgkmcnt(6)
    v_mfma_f32_16x16x32_bf16 v[96:99], a[240:243], v[68:71], v[96:99]
    buffer_load_dwordx4 v[228:231], v11, s[4:7], s78 offen sc1
    v_mfma_f32_16x16x32_bf16 v[100:103], a[228:231], v[64:67], v[100:103]
    s_waitcnt lgkmcnt(4)
    v_mfma_f32_16x16x32_bf16 v[100:103], a[244:247], v[68:71], v[100:103]
    v_mfma_f32_16x16x32_bf16 v[104:107], a[232:235], v[64:67], v[104:107]
    s_waitcnt lgkmcnt(2)
    v_mfma_f32_16x16x32_bf16 v[104:107], a[248:251], v[68:71], v[104:107]
    buffer_load_dwordx4 v[232:235], v11, s[4:7], s79 offen sc1
    v_mfma_f32_16x16x32_bf16 v[108:111], a[236:239], v[64:67], v[108:111]
    s_waitcnt lgkmcnt(0)
    v_mfma_f32_16x16x32_bf16 v[108:111], a[252:255], v[68:71], v[108:111]
    s_waitcnt vmcnt(11)
    v_mfma_f32_16x16x32_bf16 v[192:195], a[0:3], v[72:75], 0
    s_waitcnt vmcnt(10)
    v_mfma_f32_16x16x32_bf16 v[192:195], a[16:19], v[76:79], v[192:195]
    buffer_load_dwordx4 v[64:67], v11, s[4:7], s80 offen sc1
    v_mfma_f32_16x16x32_bf16 v[196:199], a[4:7], v[72:75], 0
    ds_write_b128 v44, v[96:99] offset:0
    v_mfma_f32_16x16x32_bf16 v[196:199], a[20:23], v[76:79], v[196:199]
    v_mfma_f32_16x16x32_bf16 v[200:203], a[8:11], v[72:75], 0
    v_mfma_f32_16x16x32_bf16 v[200:203], a[24:27], v[76:79], v[200:203]
    buffer_load_dwordx4 v[68:71], v11, s[4:7], s81 offen sc1
    v_mfma_f32_16x16x32_bf16 v[204:207], a[12:15], v[72:75], 0
    ds_write_b128 v44, v[100:103] offset:1024
    v_mfma_f32_16x16x32_bf16 v[204:207], a[28:31], v[76:79], v[204:207]
    s_waitcnt vmcnt(11)
    v_mfma_f32_16x16x32_bf16 v[192:195], a[32:35], v[80:83], v[192:195]
    s_waitcnt vmcnt(10)
    v_mfma_f32_16x16x32_bf16 v[192:195], a[48:51], v[84:87], v[192:195]
    buffer_load_dwordx4 v[72:75], v11, s[4:7], s82 offen sc1
    v_mfma_f32_16x16x32_bf16 v[196:199], a[36:39], v[80:83], v[196:199]
    ds_write_b128 v44, v[104:107] offset:2048
    v_mfma_f32_16x16x32_bf16 v[196:199], a[52:55], v[84:87], v[196:199]
    v_mfma_f32_16x16x32_bf16 v[200:203], a[40:43], v[80:83], v[200:203]
    v_mfma_f32_16x16x32_bf16 v[200:203], a[56:59], v[84:87], v[200:203]
    buffer_load_dwordx4 v[76:79], v11, s[4:7], s83 offen sc1
    ds_write_b128 v44, v[108:111] offset:3072
    v_mfma_f32_16x16x32_bf16 v[204:207], a[44:47], v[80:83], v[204:207]
    v_mfma_f32_16x16x32_bf16 v[204:207], a[60:63], v[84:87], v[204:207]
    s_waitcnt vmcnt(11)
    v_mfma_f32_16x16x32_bf16 v[192:195], a[64:67], v[88:91], v[192:195]
    s_waitcnt vmcnt(10)
    v_mfma_f32_16x16x32_bf16 v[192:195], a[80:83], v[92:95], v[192:195]
    buffer_load_dwordx4 v[80:83], v12, s[4:7], s68 offen sc1
    v_mfma_f32_16x16x32_bf16 v[196:199], a[68:71], v[88:91], v[196:199]
    v_mfma_f32_16x16x32_bf16 v[196:199], a[84:87], v[92:95], v[196:199]
    v_mfma_f32_16x16x32_bf16 v[200:203], a[72:75], v[88:91], v[200:203]
    v_mfma_f32_16x16x32_bf16 v[200:203], a[88:91], v[92:95], v[200:203]
    buffer_load_dwordx4 v[84:87], v12, s[4:7], s69 offen sc1
    v_mfma_f32_16x16x32_bf16 v[204:207], a[76:79], v[88:91], v[204:207]
    v_mfma_f32_16x16x32_bf16 v[204:207], a[92:95], v[92:95], v[204:207]
    s_waitcnt vmcnt(11)
    v_mfma_f32_16x16x32_bf16 v[192:195], a[96:99], v[128:131], v[192:195]
    s_waitcnt vmcnt(10)
    v_mfma_f32_16x16x32_bf16 v[192:195], a[112:115], v[132:135], v[192:195]
    buffer_load_dwordx4 v[88:91], v12, s[4:7], s70 offen sc1
    v_mfma_f32_16x16x32_bf16 v[196:199], a[100:103], v[128:131], v[196:199]
    v_mfma_f32_16x16x32_bf16 v[196:199], a[116:119], v[132:135], v[196:199]
    v_mfma_f32_16x16x32_bf16 v[200:203], a[104:107], v[128:131], v[200:203]
    v_mfma_f32_16x16x32_bf16 v[200:203], a[120:123], v[132:135], v[200:203]
    buffer_load_dwordx4 v[92:95], v12, s[4:7], s71 offen sc1
    v_mfma_f32_16x16x32_bf16 v[204:207], a[108:111], v[128:131], v[204:207]
    v_mfma_f32_16x16x32_bf16 v[204:207], a[124:127], v[132:135], v[204:207]
    s_waitcnt vmcnt(11)
    v_mfma_f32_16x16x32_bf16 v[192:195], a[128:131], v[136:139], v[192:195]
    s_waitcnt vmcnt(10)
    v_mfma_f32_16x16x32_bf16 v[192:195], a[144:147], v[140:143], v[192:195]
    buffer_load_dwordx4 v[128:131], v12, s[4:7], s72 offen sc1
    v_mfma_f32_16x16x32_bf16 v[196:199], a[132:135], v[136:139], v[196:199]
    v_mfma_f32_16x16x32_bf16 v[196:199], a[148:151], v[140:143], v[196:199]
    v_mfma_f32_16x16x32_bf16 v[200:203], a[136:139], v[136:139], v[200:203]
    v_mfma_f32_16x16x32_bf16 v[200:203], a[152:155], v[140:143], v[200:203]
    buffer_load_dwordx4 v[132:135], v12, s[4:7], s73 offen sc1
    v_mfma_f32_16x16x32_bf16 v[204:207], a[140:143], v[136:139], v[204:207]
    v_mfma_f32_16x16x32_bf16 v[204:207], a[156:159], v[140:143], v[204:207]
    s_waitcnt vmcnt(11)
    v_mfma_f32_16x16x32_bf16 v[192:195], a[160:163], v[228:231], v[192:195]
    s_waitcnt vmcnt(10)
    v_mfma_f32_16x16x32_bf16 v[192:195], a[176:179], v[232:235], v[192:195]
    buffer_load_dwordx4 v[136:139], v12, s[4:7], s74 offen sc1
    v_mfma_f32_16x16x32_bf16 v[196:199], a[164:167], v[228:231], v[196:199]
    v_mfma_f32_16x16x32_bf16 v[196:199], a[180:183], v[232:235], v[196:199]
    v_mfma_f32_16x16x32_bf16 v[200:203], a[168:171], v[228:231], v[200:203]
    v_mfma_f32_16x16x32_bf16 v[200:203], a[184:187], v[232:235], v[200:203]
    buffer_load_dwordx4 v[140:143], v12, s[4:7], s75 offen sc1
    v_mfma_f32_16x16x32_bf16 v[204:207], a[172:175], v[228:231], v[204:207]
    v_mfma_f32_16x16x32_bf16 v[204:207], a[188:191], v[232:235], v[204:207]
    s_waitcnt vmcnt(11)
    v_mfma_f32_16x16x32_bf16 v[192:195], a[192:195], v[64:67], v[192:195]
    s_waitcnt vmcnt(10)
    v_mfma_f32_16x16x32_bf16 v[192:195], a[208:211], v[68:71], v[192:195]
    buffer_load_dwordx4 v[228:231], v12, s[4:7], s76 offen sc1
    v_mfma_f32_16x16x32_bf16 v[196:199], a[196:199], v[64:67], v[196:199]
    v_mfma_f32_16x16x32_bf16 v[196:199], a[212:215], v[68:71], v[196:199]
    v_mfma_f32_16x16x32_bf16 v[200:203], a[200:203], v[64:67], v[200:203]
    v_mfma_f32_16x16x32_bf16 v[200:203], a[216:219], v[68:71], v[200:203]
    buffer_load_dwordx4 v[232:235], v12, s[4:7], s77 offen sc1
    v_mfma_f32_16x16x32_bf16 v[204:207], a[204:207], v[64:67], v[204:207]
    v_mfma_f32_16x16x32_bf16 v[204:207], a[220:223], v[68:71], v[204:207]
    s_waitcnt vmcnt(11)
    v_mfma_f32_16x16x32_bf16 v[192:195], a[224:227], v[72:75], v[192:195]
    s_waitcnt vmcnt(10)
    v_mfma_f32_16x16x32_bf16 v[192:195], a[240:243], v[76:79], v[192:195]
    buffer_load_dwordx4 v[64:67], v12, s[4:7], s78 offen sc1
    v_mfma_f32_16x16x32_bf16 v[196:199], a[228:231], v[72:75], v[196:199]
    v_mfma_f32_16x16x32_bf16 v[196:199], a[244:247], v[76:79], v[196:199]
    v_mfma_f32_16x16x32_bf16 v[200:203], a[232:235], v[72:75], v[200:203]
    v_mfma_f32_16x16x32_bf16 v[200:203], a[248:251], v[76:79], v[200:203]
    buffer_load_dwordx4 v[68:71], v12, s[4:7], s79 offen sc1
    v_mfma_f32_16x16x32_bf16 v[204:207], a[236:239], v[72:75], v[204:207]
    v_mfma_f32_16x16x32_bf16 v[204:207], a[252:255], v[76:79], v[204:207]
    s_waitcnt vmcnt(11)
    v_mfma_f32_16x16x32_bf16 v[96:99], a[0:3], v[80:83], 0
    s_waitcnt vmcnt(10)
    v_mfma_f32_16x16x32_bf16 v[96:99], a[16:19], v[84:87], v[96:99]
    buffer_load_dwordx4 v[72:75], v12, s[4:7], s80 offen sc1
    v_mfma_f32_16x16x32_bf16 v[100:103], a[4:7], v[80:83], 0
    ds_write_b128 v45, v[192:195] offset:0
    v_mfma_f32_16x16x32_bf16 v[100:103], a[20:23], v[84:87], v[100:103]
    v_mfma_f32_16x16x32_bf16 v[104:107], a[8:11], v[80:83], 0
    v_mfma_f32_16x16x32_bf16 v[104:107], a[24:27], v[84:87], v[104:107]
    buffer_load_dwordx4 v[76:79], v12, s[4:7], s81 offen sc1
    v_mfma_f32_16x16x32_bf16 v[108:111], a[12:15], v[80:83], 0
    v_lshl_add_u32 v35, s84, 5, v0
    v_mul_u32_u24 v35, 32, v35
    v_mfma_f32_16x16x32_bf16 v[108:111], a[28:31], v[84:87], v[108:111]
    v_add_u32 v35, 10043392, v35
    s_waitcnt vmcnt(11)
    v_mfma_f32_16x16x32_bf16 v[96:99], a[32:35], v[88:91], v[96:99]
    s_waitcnt vmcnt(10)
    v_mfma_f32_16x16x32_bf16 v[96:99], a[48:51], v[92:95], v[96:99]
    buffer_load_dwordx4 v[80:83], v12, s[4:7], s82 offen sc1
    v_mfma_f32_16x16x32_bf16 v[100:103], a[36:39], v[88:91], v[100:103]
    s_mov_b32 exec_hi, 0
    buffer_load_dwordx4 v[248:251], v35, s[4:7], 0 offen sc1
    s_mov_b64 exec, -1
    v_mfma_f32_16x16x32_bf16 v[100:103], a[52:55], v[92:95], v[100:103]
    ds_write_b128 v45, v[196:199] offset:1024
    v_mfma_f32_16x16x32_bf16 v[104:107], a[40:43], v[88:91], v[104:107]
    ds_write_b128 v45, v[200:203] offset:2048
    v_mfma_f32_16x16x32_bf16 v[104:107], a[56:59], v[92:95], v[104:107]
    buffer_load_dwordx4 v[84:87], v12, s[4:7], s83 offen sc1
    ds_write_b128 v45, v[204:207] offset:3072
    v_mfma_f32_16x16x32_bf16 v[108:111], a[44:47], v[88:91], v[108:111]
    v_mfma_f32_16x16x32_bf16 v[108:111], a[60:63], v[92:95], v[108:111]
    s_waitcnt vmcnt(12)
    v_mfma_f32_16x16x32_bf16 v[96:99], a[64:67], v[128:131], v[96:99]
    s_waitcnt vmcnt(11)
    v_mfma_f32_16x16x32_bf16 v[96:99], a[80:83], v[132:135], v[96:99]
    buffer_load_dwordx4 v[88:91], v13, s[4:7], s68 offen sc1
    v_mfma_f32_16x16x32_bf16 v[100:103], a[68:71], v[128:131], v[100:103]
    v_mfma_f32_16x16x32_bf16 v[100:103], a[84:87], v[132:135], v[100:103]
    v_mfma_f32_16x16x32_bf16 v[104:107], a[72:75], v[128:131], v[104:107]
    v_mfma_f32_16x16x32_bf16 v[104:107], a[88:91], v[132:135], v[104:107]
    buffer_load_dwordx4 v[92:95], v13, s[4:7], s69 offen sc1
    v_mfma_f32_16x16x32_bf16 v[108:111], a[76:79], v[128:131], v[108:111]
    v_mfma_f32_16x16x32_bf16 v[108:111], a[92:95], v[132:135], v[108:111]
    s_waitcnt vmcnt(12)
    v_mfma_f32_16x16x32_bf16 v[96:99], a[96:99], v[136:139], v[96:99]
    s_waitcnt vmcnt(11)
    v_mfma_f32_16x16x32_bf16 v[96:99], a[112:115], v[140:143], v[96:99]
    buffer_load_dwordx4 v[128:131], v13, s[4:7], s70 offen sc1
    v_mfma_f32_16x16x32_bf16 v[100:103], a[100:103], v[136:139], v[100:103]
    v_mfma_f32_16x16x32_bf16 v[100:103], a[116:119], v[140:143], v[100:103]
    v_mfma_f32_16x16x32_bf16 v[104:107], a[104:107], v[136:139], v[104:107]
    v_mfma_f32_16x16x32_bf16 v[104:107], a[120:123], v[140:143], v[104:107]
    buffer_load_dwordx4 v[132:135], v13, s[4:7], s71 offen sc1
    v_mfma_f32_16x16x32_bf16 v[108:111], a[108:111], v[136:139], v[108:111]
    v_mfma_f32_16x16x32_bf16 v[108:111], a[124:127], v[140:143], v[108:111]
    s_waitcnt vmcnt(12)
    v_mfma_f32_16x16x32_bf16 v[96:99], a[128:131], v[228:231], v[96:99]
    s_waitcnt vmcnt(11)
    v_mfma_f32_16x16x32_bf16 v[96:99], a[144:147], v[232:235], v[96:99]
    buffer_load_dwordx4 v[136:139], v13, s[4:7], s72 offen sc1
    v_mfma_f32_16x16x32_bf16 v[100:103], a[132:135], v[228:231], v[100:103]
    v_mfma_f32_16x16x32_bf16 v[100:103], a[148:151], v[232:235], v[100:103]
    v_mfma_f32_16x16x32_bf16 v[104:107], a[136:139], v[228:231], v[104:107]
    v_mfma_f32_16x16x32_bf16 v[104:107], a[152:155], v[232:235], v[104:107]
    buffer_load_dwordx4 v[140:143], v13, s[4:7], s73 offen sc1
    v_mfma_f32_16x16x32_bf16 v[108:111], a[140:143], v[228:231], v[108:111]
    v_mfma_f32_16x16x32_bf16 v[108:111], a[156:159], v[232:235], v[108:111]
    s_waitcnt vmcnt(12)
    v_mfma_f32_16x16x32_bf16 v[96:99], a[160:163], v[64:67], v[96:99]
    s_waitcnt vmcnt(11)
    v_mfma_f32_16x16x32_bf16 v[96:99], a[176:179], v[68:71], v[96:99]
    buffer_load_dwordx4 v[228:231], v13, s[4:7], s74 offen sc1
    v_mfma_f32_16x16x32_bf16 v[100:103], a[164:167], v[64:67], v[100:103]
    v_mfma_f32_16x16x32_bf16 v[100:103], a[180:183], v[68:71], v[100:103]
    v_mfma_f32_16x16x32_bf16 v[104:107], a[168:171], v[64:67], v[104:107]
    v_mfma_f32_16x16x32_bf16 v[104:107], a[184:187], v[68:71], v[104:107]
    buffer_load_dwordx4 v[232:235], v13, s[4:7], s75 offen sc1
    v_mfma_f32_16x16x32_bf16 v[108:111], a[172:175], v[64:67], v[108:111]
    v_mfma_f32_16x16x32_bf16 v[108:111], a[188:191], v[68:71], v[108:111]
    s_waitcnt vmcnt(12)
    v_mfma_f32_16x16x32_bf16 v[96:99], a[192:195], v[72:75], v[96:99]
    s_waitcnt vmcnt(11)
    v_mfma_f32_16x16x32_bf16 v[96:99], a[208:211], v[76:79], v[96:99]
    buffer_load_dwordx4 v[64:67], v13, s[4:7], s76 offen sc1
    v_mfma_f32_16x16x32_bf16 v[100:103], a[196:199], v[72:75], v[100:103]
    v_mfma_f32_16x16x32_bf16 v[100:103], a[212:215], v[76:79], v[100:103]
    v_mfma_f32_16x16x32_bf16 v[104:107], a[200:203], v[72:75], v[104:107]
    v_mfma_f32_16x16x32_bf16 v[104:107], a[216:219], v[76:79], v[104:107]
    buffer_load_dwordx4 v[68:71], v13, s[4:7], s77 offen sc1
    v_mfma_f32_16x16x32_bf16 v[108:111], a[204:207], v[72:75], v[108:111]
    v_mfma_f32_16x16x32_bf16 v[108:111], a[220:223], v[76:79], v[108:111]
    s_waitcnt vmcnt(12)
    v_mfma_f32_16x16x32_bf16 v[96:99], a[224:227], v[80:83], v[96:99]
    s_waitcnt vmcnt(10)
    v_mfma_f32_16x16x32_bf16 v[96:99], a[240:243], v[84:87], v[96:99]
    buffer_load_dwordx4 v[72:75], v13, s[4:7], s78 offen sc1
    v_mfma_f32_16x16x32_bf16 v[100:103], a[228:231], v[80:83], v[100:103]
    v_mfma_f32_16x16x32_bf16 v[100:103], a[244:247], v[84:87], v[100:103]
    v_mfma_f32_16x16x32_bf16 v[104:107], a[232:235], v[80:83], v[104:107]
    v_mfma_f32_16x16x32_bf16 v[104:107], a[248:251], v[84:87], v[104:107]
    buffer_load_dwordx4 v[76:79], v13, s[4:7], s79 offen sc1
    v_mfma_f32_16x16x32_bf16 v[108:111], a[236:239], v[80:83], v[108:111]
    v_mfma_f32_16x16x32_bf16 v[108:111], a[252:255], v[84:87], v[108:111]
    s_waitcnt vmcnt(11)
    v_mfma_f32_16x16x32_bf16 v[192:195], a[0:3], v[88:91], v[112:115]
    s_waitcnt vmcnt(10)
    v_mfma_f32_16x16x32_bf16 v[192:195], a[16:19], v[92:95], v[192:195]
    buffer_load_dwordx4 v[80:83], v13, s[4:7], s80 offen sc1
    v_mfma_f32_16x16x32_bf16 v[196:199], a[4:7], v[88:91], v[116:119]
    ds_write_b128 v46, v[96:99] offset:0
    v_mfma_f32_16x16x32_bf16 v[196:199], a[20:23], v[92:95], v[196:199]
    v_mfma_f32_16x16x32_bf16 v[200:203], a[8:11], v[88:91], v[120:123]
    ds_write_b128 v46, v[100:103] offset:1024
    v_mfma_f32_16x16x32_bf16 v[200:203], a[24:27], v[92:95], v[200:203]
    buffer_load_dwordx4 v[84:87], v13, s[4:7], s81 offen sc1
    v_mfma_f32_16x16x32_bf16 v[204:207], a[12:15], v[88:91], v[124:127]
    v_mfma_f32_16x16x32_bf16 v[204:207], a[28:31], v[92:95], v[204:207]
    s_waitcnt vmcnt(11)
    v_mfma_f32_16x16x32_bf16 v[192:195], a[32:35], v[128:131], v[192:195]
    s_waitcnt vmcnt(10)
    v_mfma_f32_16x16x32_bf16 v[192:195], a[48:51], v[132:135], v[192:195]
    buffer_load_dwordx4 v[88:91], v13, s[4:7], s82 offen sc1
    v_mfma_f32_16x16x32_bf16 v[196:199], a[36:39], v[128:131], v[196:199]
    s_mov_b32 exec_hi, 0
    v_xor_b32 v248, s91, v248
    v_bitop3_b32 v248, v248, v249, v34 bitop3:0xf6
    v_bitop3_b32 v248, v248, v250, v34 bitop3:0xf6
    v_bitop3_b32 v248, v248, v251, v34 bitop3:0xf6
    v_cmp_ne_u32 vcc, 0, v248
    s_mov_b32 s3, 0
    s_cbranch_vccz L_pk_Af2
L_pl_Af2:
    s_mov_b64 exec, vcc
    buffer_load_dwordx4 v[248:251], v35, s[4:7], 0 offen sc1
    s_add_u32 s3, s3, 1
    s_cmp_ge_u32 s3, 0x40000
    s_cbranch_scc1 L_pk_Af2
    s_waitcnt vmcnt(0)
    v_xor_b32 v248, s91, v248
    v_bitop3_b32 v248, v248, v249, v34 bitop3:0xf6
    v_bitop3_b32 v248, v248, v250, v34 bitop3:0xf6
    v_bitop3_b32 v248, v248, v251, v34 bitop3:0xf6
    v_cmp_ne_u32 vcc, 0, v248
    s_nop 0
    s_cbranch_vccnz L_pl_Af2
L_pk_Af2:
    s_mov_b64 exec, -1
    v_mfma_f32_16x16x32_bf16 v[196:199], a[52:55], v[132:135], v[196:199]
    ds_write_b128 v46, v[104:107] offset:2048
    v_mfma_f32_16x16x32_bf16 v[200:203], a[40:43], v[128:131], v[200:203]
    ds_write_b128 v46, v[108:111] offset:3072
    v_mfma_f32_16x16x32_bf16 v[200:203], a[56:59], v[132:135], v[200:203]
    buffer_load_dwordx4 v[92:95], v13, s[4:7], s83 offen sc1
    v_mfma_f32_16x16x32_bf16 v[204:207], a[44:47], v[128:131], v[204:207]
    v_mfma_f32_16x16x32_bf16 v[204:207], a[60:63], v[132:135], v[204:207]
    s_waitcnt lgkmcnt(0)
    s_waitcnt vmcnt(11)
    v_mfma_f32_16x16x32_bf16 v[192:195], a[64:67], v[136:139], v[192:195]
    s_barrier
    s_waitcnt vmcnt(10)
    v_mfma_f32_16x16x32_bf16 v[192:195], a[80:83], v[140:143], v[192:195]
    buffer_load_dwordx4 v[128:131], v14, s[4:7], s68 offen sc1
    ds_read_b128 v[144:147], v47 offset:0
    v_mfma_f32_16x16x32_bf16 v[196:199], a[68:71], v[136:139], v[196:199]
    ds_read_b128 v[148:151], v47 offset:1024
    v_mfma_f32_16x16x32_bf16 v[196:199], a[84:87], v[140:143], v[196:199]
    ds_read_b128 v[152:155], v47 offset:2048
    v_mfma_f32_16x16x32_bf16 v[200:203], a[72:75], v[136:139], v[200:203]
    ds_read_b128 v[156:159], v47 offset:3072
    v_mfma_f32_16x16x32_bf16 v[200:203], a[88:91], v[140:143], v[200:203]
    buffer_load_dwordx4 v[132:135], v14, s[4:7], s69 offen sc1
    ds_read_b128 v[160:163], v47 offset:4096
    v_mfma_f32_16x16x32_bf16 v[204:207], a[76:79], v[136:139], v[204:207]
    ds_read_b128 v[164:167], v47 offset:5120
    v_mfma_f32_16x16x32_bf16 v[204:207], a[92:95], v[140:143], v[204:207]
    ds_read_b128 v[168:171], v47 offset:6144
    s_waitcnt vmcnt(11)
    v_mfma_f32_16x16x32_bf16 v[192:195], a[96:99], v[228:231], v[192:195]
    ds_read_b128 v[172:175], v47 offset:7168
    s_waitcnt vmcnt(10)
    v_mfma_f32_16x16x32_bf16 v[192:195], a[112:115], v[232:235], v[192:195]
    buffer_load_dwordx4 v[136:139], v14, s[4:7], s70 offen sc1
    ds_read_b128 v[176:179], v47 offset:8192
    v_mfma_f32_16x16x32_bf16 v[196:199], a[100:103], v[228:231], v[196:199]
    ds_read_b128 v[180:183], v47 offset:9216
    v_mfma_f32_16x16x32_bf16 v[196:199], a[116:119], v[232:235], v[196:199]
    ds_read_b128 v[184:187], v47 offset:10240
    v_mfma_f32_16x16x32_bf16 v[200:203], a[104:107], v[228:231], v[200:203]
    ds_read_b128 v[188:191], v47 offset:11264
    v_mfma_f32_16x16x32_bf16 v[200:203], a[120:123], v[232:235], v[200:203]
    buffer_load_dwordx4 v[140:143], v14, s[4:7], s71 offen sc1
    v_mfma_f32_16x16x32_bf16 v[204:207], a[108:111], v[228:231], v[204:207]
    v_mfma_f32_16x16x32_bf16 v[204:207], a[124:127], v[232:235], v[204:207]
    s_waitcnt vmcnt(11)
    v_mfma_f32_16x16x32_bf16 v[192:195], a[128:131], v[64:67], v[192:195]
    s_waitcnt lgkmcnt(7)
    v_add_f32 v144, v144, v160
    s_waitcnt vmcnt(10)
    v_mfma_f32_16x16x32_bf16 v[192:195], a[144:147], v[68:71], v[192:195]
    buffer_load_dwordx4 v[228:231], v14, s[4:7], s72 offen sc1
    v_add_f32 v145, v145, v161
    v_mfma_f32_16x16x32_bf16 v[196:199], a[132:135], v[64:67], v[196:199]
    v_add_f32 v146, v146, v162
    v_add_f32 v147, v147, v163
    v_mfma_f32_16x16x32_bf16 v[196:199], a[148:151], v[68:71], v[196:199]
    s_waitcnt lgkmcnt(6)
    v_add_f32 v148, v148, v164
    v_add_f32 v149, v149, v165
    v_mfma_f32_16x16x32_bf16 v[200:203], a[136:139], v[64:67], v[200:203]
    v_add_f32 v150, v150, v166
    v_add_f32 v151, v151, v167
    v_mfma_f32_16x16x32_bf16 v[200:203], a[152:155], v[68:71], v[200:203]
    buffer_load_dwordx4 v[232:235], v14, s[4:7], s73 offen sc1
    s_waitcnt lgkmcnt(5)
    v_add_f32 v152, v152, v168
    v_mfma_f32_16x16x32_bf16 v[204:207], a[140:143], v[64:67], v[204:207]
    v_add_f32 v153, v153, v169
    v_add_f32 v154, v154, v170
    v_mfma_f32_16x16x32_bf16 v[204:207], a[156:159], v[68:71], v[204:207]
    v_add_f32 v155, v155, v171
    s_waitcnt vmcnt(11)
    v_mfma_f32_16x16x32_bf16 v[192:195], a[160:163], v[72:75], v[192:195]
    s_waitcnt lgkmcnt(4)
    v_add_f32 v156, v156, v172
    s_waitcnt vmcnt(10)
    v_mfma_f32_16x16x32_bf16 v[192:195], a[176:179], v[76:79], v[192:195]
    buffer_load_dwordx4 v[64:67], v14, s[4:7], s74 offen sc1
    v_add_f32 v157, v157, v173
    v_mfma_f32_16x16x32_bf16 v[196:199], a[164:167], v[72:75], v[196:199]
    v_add_f32 v158, v158, v174
    v_add_f32 v159, v159, v175
    v_mfma_f32_16x16x32_bf16 v[196:199], a[180:183], v[76:79], v[196:199]
    s_waitcnt lgkmcnt(3)
    v_add_f32 v144, v144, v176
    v_add_f32 v145, v145, v177
    v_mfma_f32_16x16x32_bf16 v[200:203], a[168:171], v[72:75], v[200:203]
    v_add_f32 v146, v146, v178
    v_add_f32 v147, v147, v179
    v_mfma_f32_16x16x32_bf16 v[200:203], a[184:187], v[76:79], v[200:203]
    buffer_load_dwordx4 v[68:71], v14, s[4:7], s75 offen sc1
    s_waitcnt lgkmcnt(2)
    v_add_f32 v148, v148, v180
    v_mfma_f32_16x16x32_bf16 v[204:207], a[172:175], v[72:75], v[204:207]
    v_add_f32 v149, v149, v181
    v_add_f32 v150, v150, v182
    v_mfma_f32_16x16x32_bf16 v[204:207], a[188:191], v[76:79], v[204:207]
    v_add_f32 v151, v151, v183
    s_waitcnt vmcnt(11)
    v_mfma_f32_16x16x32_bf16 v[192:195], a[192:195], v[80:83], v[192:195]
    s_waitcnt lgkmcnt(1)
    v_add_f32 v152, v152, v184
    s_waitcnt vmcnt(10)
    v_mfma_f32_16x16x32_bf16 v[192:195], a[208:211], v[84:87], v[192:195]
    buffer_load_dwordx4 v[72:75], v14, s[4:7], s76 offen sc1
    v_add_f32 v153, v153, v185
    v_mfma_f32_16x16x32_bf16 v[196:199], a[196:199], v[80:83], v[196:199]
    v_add_f32 v154, v154, v186
    v_add_f32 v155, v155, v187
    v_mfma_f32_16x16x32_bf16 v[196:199], a[212:215], v[84:87], v[196:199]
    s_waitcnt lgkmcnt(0)
    v_add_f32 v156, v156, v188
    v_add_f32 v157, v157, v189
    v_mfma_f32_16x16x32_bf16 v[200:203], a[200:203], v[80:83], v[200:203]
    v_add_f32 v158, v158, v190
    v_add_f32 v159, v159, v191
    v_mfma_f32_16x16x32_bf16 v[200:203], a[216:219], v[84:87], v[200:203]
    buffer_load_dwordx4 v[76:79], v14, s[4:7], s77 offen sc1
    v_mfma_f32_16x16x32_bf16 v[204:207], a[204:207], v[80:83], v[204:207]
    v_mfma_f32_16x16x32_bf16 v[204:207], a[220:223], v[84:87], v[204:207]
    s_waitcnt vmcnt(11)
    v_mfma_f32_16x16x32_bf16 v[192:195], a[224:227], v[88:91], v[192:195]
    s_waitcnt vmcnt(10)
    v_mfma_f32_16x16x32_bf16 v[192:195], a[240:243], v[92:95], v[192:195]
    buffer_load_dwordx4 v[80:83], v14, s[4:7], s78 offen sc1
    v_mfma_f32_16x16x32_bf16 v[196:199], a[228:231], v[88:91], v[196:199]
    v_mfma_f32_16x16x32_bf16 v[196:199], a[244:247], v[92:95], v[196:199]
    v_mfma_f32_16x16x32_bf16 v[200:203], a[232:235], v[88:91], v[200:203]
    v_mfma_f32_16x16x32_bf16 v[200:203], a[248:251], v[92:95], v[200:203]
    buffer_load_dwordx4 v[84:87], v14, s[4:7], s79 offen sc1
    v_mfma_f32_16x16x32_bf16 v[204:207], a[236:239], v[88:91], v[204:207]
    v_mfma_f32_16x16x32_bf16 v[204:207], a[252:255], v[92:95], v[204:207]
    buffer_load_dwordx4 v[88:91], v14, s[4:7], s80 offen sc1
    buffer_load_dwordx4 v[92:95], v14, s[4:7], s81 offen sc1
    v_pk_add_f32 v[192:193], v[192:193], v[144:145]
    v_pk_add_f32 v[194:195], v[194:195], v[146:147]
    v_pk_add_f32 v[196:197], v[196:197], v[148:149]
    v_pk_add_f32 v[198:199], v[198:199], v[150:151]
    v_pk_add_f32 v[200:201], v[200:201], v[152:153]
    v_pk_add_f32 v[202:203], v[202:203], v[154:155]
    v_pk_add_f32 v[204:205], v[204:205], v[156:157]
    v_pk_add_f32 v[206:207], v[206:207], v[158:159]
    v_pk_mul_f32 v[160:161], v[192:193], v[192:193]
    v_pk_mul_f32 v[162:163], v[194:195], v[194:195]
    v_pk_mul_f32 v[164:165], v[196:197], v[196:197]
    v_pk_mul_f32 v[166:167], v[198:199], v[198:199]
    v_pk_mul_f32 v[168:169], v[200:201], v[200:201]
    v_pk_mul_f32 v[170:171], v[202:203], v[202:203]
    v_pk_mul_f32 v[172:173], v[204:205], v[204:205]
    v_pk_mul_f32 v[174:175], v[206:207], v[206:207]
    v_pk_fma_f32 v[160:161], v[160:161], s[22:23], v[52:53] op_sel_hi:[1,0,0]
    v_pk_fma_f32 v[162:163], v[162:163], s[22:23], v[52:53] op_sel_hi:[1,0,0]
    v_pk_fma_f32 v[164:165], v[164:165], s[22:23], v[52:53] op_sel_hi:[1,0,0]
    v_pk_fma_f32 v[166:167], v[166:167], s[22:23], v[52:53] op_sel_hi:[1,0,0]
    v_pk_fma_f32 v[168:169], v[168:169], s[22:23], v[52:53] op_sel_hi:[1,0,0]
    v_pk_fma_f32 v[170:171], v[170:171], s[22:23], v[52:53] op_sel_hi:[1,0,0]
    v_pk_fma_f32 v[172:173], v[172:173], s[22:23], v[52:53] op_sel_hi:[1,0,0]
    v_pk_fma_f32 v[174:175], v[174:175], s[22:23], v[52:53] op_sel_hi:[1,0,0]
    v_pk_mul_f32 v[160:161], v[160:161], v[192:193]
    v_pk_mul_f32 v[162:163], v[162:163], v[194:195]
    v_pk_mul_f32 v[164:165], v[164:165], v[196:197]
    v_pk_mul_f32 v[166:167], v[166:167], v[198:199]
    v_pk_mul_f32 v[168:169], v[168:169], v[200:201]
    v_pk_mul_f32 v[170:171], v[170:171], v[202:203]
    v_pk_mul_f32 v[172:173], v[172:173], v[204:205]
    v_pk_mul_f32 v[174:175], v[174:175], v[206:207]
    v_exp_f32 v160, v160
    v_exp_f32 v161, v161
    v_exp_f32 v162, v162
    v_exp_f32 v163, v163
    v_exp_f32 v164, v164
    v_exp_f32 v165, v165
    v_exp_f32 v166, v166
    v_exp_f32 v167, v167
    v_exp_f32 v168, v168
    v_exp_f32 v169, v169
    v_exp_f32 v170, v170
    v_exp_f32 v171, v171
    v_exp_f32 v172, v172
    v_exp_f32 v173, v173
    v_exp_f32 v174, v174
    v_exp_f32 v175, v175
    v_pk_add_f32 v[160:161], v[160:161], 1.0 op_sel_hi:[1,0]
    v_pk_add_f32 v[162:163], v[162:163], 1.0 op_sel_hi:[1,0]
    v_pk_add_f32 v[164:165], v[164:165], 1.0 op_sel_hi:[1,0]
    v_pk_add_f32 v[166:167], v[166:167], 1.0 op_sel_hi:[1,0]
    v_pk_add_f32 v[168:169], v[168:169], 1.0 op_sel_hi:[1,0]
    v_pk_add_f32 v[170:171], v[170:171], 1.0 op_sel_hi:[1,0]
    v_pk_add_f32 v[172:173], v[172:173], 1.0 op_sel_hi:[1,0]
    v_pk_add_f32 v[174:175], v[174:175], 1.0 op_sel_hi:[1,0]
    v_rcp_f32 v160, v160
    v_rcp_f32 v161, v161
    v_rcp_f32 v162, v162
    v_rcp_f32 v163, v163
    v_rcp_f32 v164, v164
    v_rcp_f32 v165, v165
    v_rcp_f32 v166, v166
    v_rcp_f32 v167, v167
    v_rcp_f32 v168, v168
    v_rcp_f32 v169, v169
    v_rcp_f32 v170, v170
    v_rcp_f32 v171, v171
    v_rcp_f32 v172, v172
    v_rcp_f32 v173, v173
    v_rcp_f32 v174, v174
    v_rcp_f32 v175, v175
    v_pk_mul_f32 v[160:161], v[160:161], v[192:193]
    v_pk_mul_f32 v[162:163], v[162:163], v[194:195]
    v_pk_mul_f32 v[164:165], v[164:165], v[196:197]
    v_pk_mul_f32 v[166:167], v[166:167], v[198:199]
    v_pk_mul_f32 v[168:169], v[168:169], v[200:201]
    v_pk_mul_f32 v[170:171], v[170:171], v[202:203]
    v_pk_mul_f32 v[172:173], v[172:173], v[204:205]
    v_pk_mul_f32 v[174:175], v[174:175], v[206:207]
    v_cvt_pk_bf16_f32 v220, v160, v161
    v_cvt_pk_bf16_f32 v221, v162, v163
    v_cvt_pk_bf16_f32 v222, v164, v165
    v_cvt_pk_bf16_f32 v223, v166, v167
    v_cvt_pk_bf16_f32 v224, v168, v169
    v_cvt_pk_bf16_f32 v225, v170, v171
    v_cvt_pk_bf16_f32 v226, v172, v173
    v_cvt_pk_bf16_f32 v227, v174, v175
    buffer_store_dwordx4 v[220:223], v48, s[4:7], 0 offen offset:0 sc1
    buffer_store_dwordx4 v[224:227], v48, s[4:7], 0 offen offset:1024 sc1
    s_mov_b32 exec_hi, 0
    buffer_load_dword v248, v24, s[4:7], 0 offen sc1
    s_mov_b64 exec, -1
    s_waitcnt vmcnt(16)
    v_mfma_f32_16x16x32_bf16 v[96:99], a[0:3], v[128:131], 0
    s_waitcnt vmcnt(15)
    v_mfma_f32_16x16x32_bf16 v[96:99], a[16:19], v[132:135], v[96:99]
    v_mfma_f32_16x16x32_bf16 v[100:103], a[4:7], v[128:131], 0
    v_subrev_u32 v44, 65536, v44
    v_subrev_u32 v45, 65536, v45
    v_mfma_f32_16x16x32_bf16 v[100:103], a[20:23], v[132:135], v[100:103]
    v_subrev_u32 v46, 65536, v46
    v_subrev_u32 v47, 65536, v47
    v_mfma_f32_16x16x32_bf16 v[104:107], a[8:11], v[128:131], 0
    v_mfma_f32_16x16x32_bf16 v[104:107], a[24:27], v[132:135], v[104:107]
    v_mfma_f32_16x16x32_bf16 v[108:111], a[12:15], v[128:131], 0
    v_mfma_f32_16x16x32_bf16 v[108:111], a[28:31], v[132:135], v[108:111]
    s_waitcnt vmcnt(14)
    v_mfma_f32_16x16x32_bf16 v[96:99], a[32:35], v[136:139], v[96:99]
    s_waitcnt vmcnt(13)
    v_mfma_f32_16x16x32_bf16 v[96:99], a[48:51], v[140:143], v[96:99]
    buffer_load_dwordx4 v[128:131], v14, s[4:7], s82 offen sc1
    v_mfma_f32_16x16x32_bf16 v[100:103], a[36:39], v[136:139], v[100:103]
    v_mfma_f32_16x16x32_bf16 v[100:103], a[52:55], v[140:143], v[100:103]
    v_mfma_f32_16x16x32_bf16 v[104:107], a[40:43], v[136:139], v[104:107]
    v_mfma_f32_16x16x32_bf16 v[104:107], a[56:59], v[140:143], v[104:107]
    buffer_load_dwordx4 v[132:135], v14, s[4:7], s83 offen sc1
    v_mfma_f32_16x16x32_bf16 v[108:111], a[44:47], v[136:139], v[108:111]
    v_mfma_f32_16x16x32_bf16 v[108:111], a[60:63], v[140:143], v[108:111]
    s_waitcnt vmcnt(14)
    v_mfma_f32_16x16x32_bf16 v[96:99], a[64:67], v[228:231], v[96:99]
    s_waitcnt vmcnt(13)
    v_mfma_f32_16x16x32_bf16 v[96:99], a[80:83], v[232:235], v[96:99]
    buffer_load_dwordx4 v[136:139], v15, s[4:7], s68 offen sc1
    v_mfma_f32_16x16x32_bf16 v[100:103], a[68:71], v[228:231], v[100:103]
    v_mfma_f32_16x16x32_bf16 v[100:103], a[84:87], v[232:235], v[100:103]
    v_mfma_f32_16x16x32_bf16 v[104:107], a[72:75], v[228:231], v[104:107]
    v_mfma_f32_16x16x32_bf16 v[104:107], a[88:91], v[232:235], v[104:107]
    buffer_load_dwordx4 v[140:143], v15, s[4:7], s69 offen sc1
    v_mfma_f32_16x16x32_bf16 v[108:111], a[76:79], v[228:231], v[108:111]
    v_mfma_f32_16x16x32_bf16 v[108:111], a[92:95], v[232:235], v[108:111]
    s_waitcnt vmcnt(14)
    v_mfma_f32_16x16x32_bf16 v[96:99], a[96:99], v[64:67], v[96:99]
    s_waitcnt vmcnt(13)
    v_mfma_f32_16x16x32_bf16 v[96:99], a[112:115], v[68:71], v[96:99]
    buffer_load_dwordx4 v[228:231], v15, s[4:7], s70 offen sc1
    v_mfma_f32_16x16x32_bf16 v[100:103], a[100:103], v[64:67], v[100:103]
    v_mfma_f32_16x16x32_bf16 v[100:103], a[116:119], v[68:71], v[100:103]
    v_mfma_f32_16x16x32_bf16 v[104:107], a[104:107], v[64:67], v[104:107]
    v_mfma_f32_16x16x32_bf16 v[104:107], a[120:123], v[68:71], v[104:107]
    buffer_load_dwordx4 v[232:235], v15, s[4:7], s71 offen sc1
    v_mfma_f32_16x16x32_bf16 v[108:111], a[108:111], v[64:67], v[108:111]
    v_mfma_f32_16x16x32_bf16 v[108:111], a[124:127], v[68:71], v[108:111]
    s_waitcnt vmcnt(14)
    v_mfma_f32_16x16x32_bf16 v[96:99], a[128:131], v[72:75], v[96:99]
    s_waitcnt vmcnt(13)
    v_mfma_f32_16x16x32_bf16 v[96:99], a[144:147], v[76:79], v[96:99]
    buffer_load_dwordx4 v[64:67], v15, s[4:7], s72 offen sc1
    v_mfma_f32_16x16x32_bf16 v[100:103], a[132:135], v[72:75], v[100:103]
    s_waitcnt vmcnt(8)
    v_mfma_f32_16x16x32_bf16 v[100:103], a[148:151], v[76:79], v[100:103]
    s_mov_b64 exec, 1
    buffer_store_dword v34, v0, s[4:7], s94 offen sc1
    s_mov_b64 exec, -1
    s_add_u32 s94, s94, 30720
    v_mfma_f32_16x16x32_bf16 v[104:107], a[136:139], v[72:75], v[104:107]
    v_mfma_f32_16x16x32_bf16 v[104:107], a[152:155], v[76:79], v[104:107]
    buffer_load_dwordx4 v[68:71], v15, s[4:7], s73 offen sc1
    v_mfma_f32_16x16x32_bf16 v[108:111], a[140:143], v[72:75], v[108:111]
    v_mfma_f32_16x16x32_bf16 v[108:111], a[156:159], v[76:79], v[108:111]
    v_mfma_f32_16x16x32_bf16 v[96:99], a[160:163], v[80:83], v[96:99]
    v_mfma_f32_16x16x32_bf16 v[96:99], a[176:179], v[84:87], v[96:99]
    buffer_load_dwordx4 v[72:75], v15, s[4:7], s74 offen sc1
    v_mfma_f32_16x16x32_bf16 v[100:103], a[164:167], v[80:83], v[100:103]
    v_mfma_f32_16x16x32_bf16 v[100:103], a[180:183], v[84:87], v[100:103]
    v_mfma_f32_16x16x32_bf16 v[104:107], a[168:171], v[80:83], v[104:107]
    v_mfma_f32_16x16x32_bf16 v[104:107], a[184:187], v[84:87], v[104:107]
    buffer_load_dwordx4 v[76:79], v15, s[4:7], s75 offen sc1
    v_mfma_f32_16x16x32_bf16 v[108:111], a[172:175], v[80:83], v[108:111]
    v_mfma_f32_16x16x32_bf16 v[108:111], a[188:191], v[84:87], v[108:111]
    v_mfma_f32_16x16x32_bf16 v[96:99], a[192:195], v[88:91], v[96:99]
    v_mfma_f32_16x16x32_bf16 v[96:99], a[208:211], v[92:95], v[96:99]
    buffer_load_dwordx4 v[80:83], v15, s[4:7], s76 offen sc1
    v_mfma_f32_16x16x32_bf16 v[100:103], a[196:199], v[88:91], v[100:103]
    v_mfma_f32_16x16x32_bf16 v[100:103], a[212:215], v[92:95], v[100:103]
    v_mfma_f32_16x16x32_bf16 v[104:107], a[200:203], v[88:91], v[104:107]
    v_mfma_f32_16x16x32_bf16 v[104:107], a[216:219], v[92:95], v[104:107]
    buffer_load_dwordx4 v[84:87], v15, s[4:7], s77 offen sc1
    v_mfma_f32_16x16x32_bf16 v[108:111], a[204:207], v[88:91], v[108:111]
    v_mfma_f32_16x16x32_bf16 v[108:111], a[220:223], v[92:95], v[108:111]
    s_waitcnt vmcnt(12)
    v_mfma_f32_16x16x32_bf16 v[96:99], a[224:227], v[128:131], v[96:99]
    s_waitcnt vmcnt(11)
    v_mfma_f32_16x16x32_bf16 v[96:99], a[240:243], v[132:135], v[96:99]
    buffer_load_dwordx4 v[88:91], v15, s[4:7], s78 offen sc1
    v_mfma_f32_16x16x32_bf16 v[100:103], a[228:231], v[128:131], v[100:103]
    v_mfma_f32_16x16x32_bf16 v[100:103], a[244:247], v[132:135], v[100:103]
    v_mfma_f32_16x16x32_bf16 v[104:107], a[232:235], v[128:131], v[104:107]
    v_mfma_f32_16x16x32_bf16 v[104:107], a[248:251], v[132:135], v[104:107]
    buffer_load_dwordx4 v[92:95], v15, s[4:7], s79 offen sc1
    v_mfma_f32_16x16x32_bf16 v[108:111], a[236:239], v[128:131], v[108:111]
    v_mfma_f32_16x16x32_bf16 v[108:111], a[252:255], v[132:135], v[108:111]
    s_waitcnt vmcnt(12)
    v_mfma_f32_16x16x32_bf16 v[192:195], a[0:3], v[136:139], 0
    s_waitcnt vmcnt(11)
    v_mfma_f32_16x16x32_bf16 v[192:195], a[16:19], v[140:143], v[192:195]
    buffer_load_dwordx4 v[128:131], v15, s[4:7], s80 offen sc1
    v_mfma_f32_16x16x32_bf16 v[196:199], a[4:7], v[136:139], 0
    ds_write_b128 v44, v[96:99] offset:0
    v_mfma_f32_16x16x32_bf16 v[196:199], a[20:23], v[140:143], v[196:199]
    v_mfma_f32_16x16x32_bf16 v[200:203], a[8:11], v[136:139], 0
    v_mfma_f32_16x16x32_bf16 v[200:203], a[24:27], v[140:143], v[200:203]
    buffer_load_dwordx4 v[132:135], v15, s[4:7], s81 offen sc1
    v_mfma_f32_16x16x32_bf16 v[204:207], a[12:15], v[136:139], 0
    ds_write_b128 v44, v[100:103] offset:1024
    v_mfma_f32_16x16x32_bf16 v[204:207], a[28:31], v[140:143], v[204:207]
    s_waitcnt vmcnt(12)
    v_mfma_f32_16x16x32_bf16 v[192:195], a[32:35], v[228:231], v[192:195]
    s_waitcnt vmcnt(11)
    v_mfma_f32_16x16x32_bf16 v[192:195], a[48:51], v[232:235], v[192:195]
    buffer_load_dwordx4 v[136:139], v15, s[4:7], s82 offen sc1
    v_mfma_f32_16x16x32_bf16 v[196:199], a[36:39], v[228:231], v[196:199]
    ds_write_b128 v44, v[104:107] offset:2048
    v_mfma_f32_16x16x32_bf16 v[196:199], a[52:55], v[232:235], v[196:199]
    v_mfma_f32_16x16x32_bf16 v[200:203], a[40:43], v[228:231], v[200:203]
    v_mfma_f32_16x16x32_bf16 v[200:203], a[56:59], v[232:235], v[200:203]
    buffer_load_dwordx4 v[140:143], v15, s[4:7], s83 offen sc1
    ds_write_b128 v44, v[108:111] offset:3072
    v_mfma_f32_16x16x32_bf16 v[204:207], a[44:47], v[228:231], v[204:207]
    v_mfma_f32_16x16x32_bf16 v[204:207], a[60:63], v[232:235], v[204:207]
    s_waitcnt vmcnt(12)
    v_mfma_f32_16x16x32_bf16 v[192:195], a[64:67], v[64:67], v[192:195]
    s_waitcnt vmcnt(10)
    v_mfma_f32_16x16x32_bf16 v[192:195], a[80:83], v[68:71], v[192:195]
    buffer_load_dwordx4 v[228:231], v16, s[4:7], s68 offen sc1
    v_mfma_f32_16x16x32_bf16 v[196:199], a[68:71], v[64:67], v[196:199]
    v_mfma_f32_16x16x32_bf16 v[196:199], a[84:87], v[68:71], v[196:199]
    v_mfma_f32_16x16x32_bf16 v[200:203], a[72:75], v[64:67], v[200:203]
    v_mfma_f32_16x16x32_bf16 v[200:203], a[88:91], v[68:71], v[200:203]
    buffer_load_dwordx4 v[232:235], v16, s[4:7], s69 offen sc1
    v_mfma_f32_16x16x32_bf16 v[204:207], a[76:79], v[64:67], v[204:207]
    v_mfma_f32_16x16x32_bf16 v[204:207], a[92:95], v[68:71], v[204:207]
    s_waitcnt vmcnt(11)
    v_mfma_f32_16x16x32_bf16 v[192:195], a[96:99], v[72:75], v[192:195]
    s_waitcnt vmcnt(10)
    v_mfma_f32_16x16x32_bf16 v[192:195], a[112:115], v[76:79], v[192:195]
    buffer_load_dwordx4 v[64:67], v16, s[4:7], s70 offen sc1
    v_mfma_f32_16x16x32_bf16 v[196:199], a[100:103], v[72:75], v[196:199]
    v_mfma_f32_16x16x32_bf16 v[196:199], a[116:119], v[76:79], v[196:199]
    v_mfma_f32_16x16x32_bf16 v[200:203], a[104:107], v[72:75], v[200:203]
    v_mfma_f32_16x16x32_bf16 v[200:203], a[120:123], v[76:79], v[200:203]
    buffer_load_dwordx4 v[68:71], v16, s[4:7], s71 offen sc1
    v_mfma_f32_16x16x32_bf16 v[204:207], a[108:111], v[72:75], v[204:207]
    v_mfma_f32_16x16x32_bf16 v[204:207], a[124:127], v[76:79], v[204:207]
    s_waitcnt vmcnt(11)
    v_mfma_f32_16x16x32_bf16 v[192:195], a[128:131], v[80:83], v[192:195]
    s_waitcnt vmcnt(10)
    v_mfma_f32_16x16x32_bf16 v[192:195], a[144:147], v[84:87], v[192:195]
    buffer_load_dwordx4 v[72:75], v16, s[4:7], s72 offen sc1
    v_mfma_f32_16x16x32_bf16 v[196:199], a[132:135], v[80:83], v[196:199]
    v_mfma_f32_16x16x32_bf16 v[196:199], a[148:151], v[84:87], v[196:199]
    v_mfma_f32_16x16x32_bf16 v[200:203], a[136:139], v[80:83], v[200:203]
    v_mfma_f32_16x16x32_bf16 v[200:203], a[152:155], v[84:87], v[200:203]
    buffer_load_dwordx4 v[76:79], v16, s[4:7], s73 offen sc1
    v_mfma_f32_16x16x32_bf16 v[204:207], a[140:143], v[80:83], v[204:207]
    v_mfma_f32_16x16x32_bf16 v[204:207], a[156:159], v[84:87], v[204:207]
    s_waitcnt vmcnt(11)
    v_mfma_f32_16x16x32_bf16 v[192:195], a[160:163], v[88:91], v[192:195]
    s_waitcnt vmcnt(10)
    v_mfma_f32_16x16x32_bf16 v[192:195], a[176:179], v[92:95], v[192:195]
    buffer_load_dwordx4 v[80:83], v16, s[4:7], s74 offen sc1
    v_mfma_f32_16x16x32_bf16 v[196:199], a[164:167], v[88:91], v[196:199]
    v_mfma_f32_16x16x32_bf16 v[196:199], a[180:183], v[92:95], v[196:199]
    v_mfma_f32_16x16x32_bf16 v[200:203], a[168:171], v[88:91], v[200:203]
    v_mfma_f32_16x16x32_bf16 v[200:203], a[184:187], v[92:95], v[200:203]
    buffer_load_dwordx4 v[84:87], v16, s[4:7], s75 offen sc1
    v_mfma_f32_16x16x32_bf16 v[204:207], a[172:175], v[88:91], v[204:207]
    v_mfma_f32_16x16x32_bf16 v[204:207], a[188:191], v[92:95], v[204:207]
    s_waitcnt vmcnt(11)
    v_mfma_f32_16x16x32_bf16 v[192:195], a[192:195], v[128:131], v[192:195]
    s_waitcnt vmcnt(10)
    v_mfma_f32_16x16x32_bf16 v[192:195], a[208:211], v[132:135], v[192:195]
    buffer_load_dwordx4 v[88:91], v16, s[4:7], s76 offen sc1
    v_mfma_f32_16x16x32_bf16 v[196:199], a[196:199], v[128:131], v[196:199]
    v_mfma_f32_16x16x32_bf16 v[196:199], a[212:215], v[132:135], v[196:199]
    v_mfma_f32_16x16x32_bf16 v[200:203], a[200:203], v[128:131], v[200:203]
    v_mfma_f32_16x16x32_bf16 v[200:203], a[216:219], v[132:135], v[200:203]
    buffer_load_dwordx4 v[92:95], v16, s[4:7], s77 offen sc1
    v_mfma_f32_16x16x32_bf16 v[204:207], a[204:207], v[128:131], v[204:207]
    v_mfma_f32_16x16x32_bf16 v[204:207], a[220:223], v[132:135], v[204:207]
    s_waitcnt vmcnt(11)
    v_mfma_f32_16x16x32_bf16 v[192:195], a[224:227], v[136:139], v[192:195]
    s_waitcnt vmcnt(10)
    v_mfma_f32_16x16x32_bf16 v[192:195], a[240:243], v[140:143], v[192:195]
    buffer_load_dwordx4 v[128:131], v16, s[4:7], s78 offen sc1
    v_mfma_f32_16x16x32_bf16 v[196:199], a[228:231], v[136:139], v[196:199]
    v_mfma_f32_16x16x32_bf16 v[196:199], a[244:247], v[140:143], v[196:199]
    v_mfma_f32_16x16x32_bf16 v[200:203], a[232:235], v[136:139], v[200:203]
    v_mfma_f32_16x16x32_bf16 v[200:203], a[248:251], v[140:143], v[200:203]
    buffer_load_dwordx4 v[132:135], v16, s[4:7], s79 offen sc1
    v_mfma_f32_16x16x32_bf16 v[204:207], a[236:239], v[136:139], v[204:207]
    v_mfma_f32_16x16x32_bf16 v[204:207], a[252:255], v[140:143], v[204:207]
    s_waitcnt vmcnt(11)
    v_mfma_f32_16x16x32_bf16 v[96:99], a[0:3], v[228:231], 0
    s_waitcnt vmcnt(10)
    v_mfma_f32_16x16x32_bf16 v[96:99], a[16:19], v[232:235], v[96:99]
    buffer_load_dwordx4 v[136:139], v16, s[4:7], s80 offen sc1
    v_mfma_f32_16x16x32_bf16 v[100:103], a[4:7], v[228:231], 0
    ds_write_b128 v45, v[192:195] offset:0
    v_mfma_f32_16x16x32_bf16 v[100:103], a[20:23], v[232:235], v[100:103]
    v_mfma_f32_16x16x32_bf16 v[104:107], a[8:11], v[228:231], 0
    v_mfma_f32_16x16x32_bf16 v[104:107], a[24:27], v[232:235], v[104:107]
    buffer_load_dwordx4 v[140:143], v16, s[4:7], s81 offen sc1
    v_mfma_f32_16x16x32_bf16 v[108:111], a[12:15], v[228:231], 0
    ds_write_b128 v45, v[196:199] offset:1024
    v_mfma_f32_16x16x32_bf16 v[108:111], a[28:31], v[232:235], v[108:111]
    s_waitcnt vmcnt(11)
    v_mfma_f32_16x16x32_bf16 v[96:99], a[32:35], v[64:67], v[96:99]
    s_waitcnt vmcnt(10)
    v_mfma_f32_16x16x32_bf16 v[96:99], a[48:51], v[68:71], v[96:99]
    buffer_load_dwordx4 v[228:231], v16, s[4:7], s82 offen sc1
    v_mfma_f32_16x16x32_bf16 v[100:103], a[36:39], v[64:67], v[100:103]
    ds_write_b128 v45, v[200:203] offset:2048
    v_mfma_f32_16x16x32_bf16 v[100:103], a[52:55], v[68:71], v[100:103]
    v_mfma_f32_16x16x32_bf16 v[104:107], a[40:43], v[64:67], v[104:107]
    v_mfma_f32_16x16x32_bf16 v[104:107], a[56:59], v[68:71], v[104:107]
    buffer_load_dwordx4 v[232:235], v16, s[4:7], s83 offen sc1
    ds_write_b128 v45, v[204:207] offset:3072
    v_mfma_f32_16x16x32_bf16 v[108:111], a[44:47], v[64:67], v[108:111]
    v_mfma_f32_16x16x32_bf16 v[108:111], a[60:63], v[68:71], v[108:111]
    s_waitcnt vmcnt(11)
    v_mfma_f32_16x16x32_bf16 v[96:99], a[64:67], v[72:75], v[96:99]
    s_waitcnt vmcnt(10)
    v_mfma_f32_16x16x32_bf16 v[96:99], a[80:83], v[76:79], v[96:99]
    buffer_load_dwordx4 v[64:67], v17, s[4:7], s68 offen sc1
    v_mfma_f32_16x16x32_bf16 v[100:103], a[68:71], v[72:75], v[100:103]
    v_mfma_f32_16x16x32_bf16 v[100:103], a[84:87], v[76:79], v[100:103]
    v_mfma_f32_16x16x32_bf16 v[104:107], a[72:75], v[72:75], v[104:107]
    v_mfma_f32_16x16x32_bf16 v[104:107], a[88:91], v[76:79], v[104:107]
    buffer_load_dwordx4 v[68:71], v17, s[4:7], s69 offen sc1
    v_mfma_f32_16x16x32_bf16 v[108:111], a[76:79], v[72:75], v[108:111]
    s_mov_b32 exec_hi, 0
    v_cmp_ne_u32 vcc, s91, v248
    s_mov_b32 s3, 0
    s_cbranch_vccz L_pk_Afk
L_pl_Afk:
    s_mov_b64 exec, vcc
    buffer_load_dword v248, v24, s[4:7], 0 offen sc1
    s_add_u32 s3, s3, 1
    s_cmp_ge_u32 s3, 0x40000
    s_cbranch_scc1 L_pk_Afk
    s_waitcnt vmcnt(0)
    v_cmp_ne_u32 vcc, s91, v248
    s_nop 0
    s_cbranch_vccnz L_pl_Afk
L_pk_Afk:
    s_mov_b64 exec, -1
    v_mfma_f32_16x16x32_bf16 v[108:111], a[92:95], v[76:79], v[108:111]
    s_waitcnt vmcnt(11)
    v_mfma_f32_16x16x32_bf16 v[96:99], a[96:99], v[80:83], v[96:99]
    s_waitcnt vmcnt(10)
    v_mfma_f32_16x16x32_bf16 v[96:99], a[112:115], v[84:87], v[96:99]
    buffer_load_dwordx4 v[72:75], v17, s[4:7], s70 offen sc1
    v_mfma_f32_16x16x32_bf16 v[100:103], a[100:103], v[80:83], v[100:103]
    v_mfma_f32_16x16x32_bf16 v[100:103], a[116:119], v[84:87], v[100:103]
    v_mfma_f32_16x16x32_bf16 v[104:107], a[104:107], v[80:83], v[104:107]
    v_mfma_f32_16x16x32_bf16 v[104:107], a[120:123], v[84:87], v[104:107]
    buffer_load_dwordx4 v[76:79], v17, s[4:7], s71 offen sc1
    v_mfma_f32_16x16x32_bf16 v[108:111], a[108:111], v[80:83], v[108:111]
    v_mfma_f32_16x16x32_bf16 v[108:111], a[124:127], v[84:87], v[108:111]
    s_waitcnt vmcnt(11)
    v_mfma_f32_16x16x32_bf16 v[96:99], a[128:131], v[88:91], v[96:99]
    s_waitcnt vmcnt(10)
    v_mfma_f32_16x16x32_bf16 v[96:99], a[144:147], v[92:95], v[96:99]
    buffer_load_dwordx4 v[80:83], v17, s[4:7], s72 offen sc1
    v_mfma_f32_16x16x32_bf16 v[100:103], a[132:135], v[88:91], v[100:103]
    v_mfma_f32_16x16x32_bf16 v[100:103], a[148:151], v[92:95], v[100:103]
    v_mfma_f32_16x16x32_bf16 v[104:107], a[136:139], v[88:91], v[104:107]
    v_mfma_f32_16x16x32_bf16 v[104:107], a[152:155], v[92:95], v[104:107]
    buffer_load_dwordx4 v[84:87], v17, s[4:7], s73 offen sc1
    v_mfma_f32_16x16x32_bf16 v[108:111], a[140:143], v[88:91], v[108:111]
    v_mfma_f32_16x16x32_bf16 v[108:111], a[156:159], v[92:95], v[108:111]
    s_waitcnt vmcnt(11)
    v_mfma_f32_16x16x32_bf16 v[96:99], a[160:163], v[128:131], v[96:99]
    s_waitcnt vmcnt(10)
    v_mfma_f32_16x16x32_bf16 v[96:99], a[176:179], v[132:135], v[96:99]
    buffer_load_dwordx4 v[88:91], v17, s[4:7], s74 offen sc1
    v_mfma_f32_16x16x32_bf16 v[100:103], a[164:167], v[128:131], v[100:103]
    v_mfma_f32_16x16x32_bf16 v[100:103], a[180:183], v[132:135], v[100:103]
    v_mfma_f32_16x16x32_bf16 v[104:107], a[168:171], v[128:131], v[104:107]
    v_mfma_f32_16x16x32_bf16 v[104:107], a[184:187], v[132:135], v[104:107]
    buffer_load_dwordx4 v[92:95], v17, s[4:7], s75 offen sc1
    v_mfma_f32_16x16x32_bf16 v[108:111], a[172:175], v[128:131], v[108:111]
    v_mfma_f32_16x16x32_bf16 v[108:111], a[188:191], v[132:135], v[108:111]
    s_waitcnt vmcnt(11)
    v_mfma_f32_16x16x32_bf16 v[96:99], a[192:195], v[136:139], v[96:99]
    s_waitcnt vmcnt(10)
    v_mfma_f32_16x16x32_bf16 v[96:99], a[208:211], v[140:143], v[96:99]
    buffer_load_dwordx4 v[128:131], v17, s[4:7], s76 offen sc1
    v_mfma_f32_16x16x32_bf16 v[100:103], a[196:199], v[136:139], v[100:103]
    v_mfma_f32_16x16x32_bf16 v[100:103], a[212:215], v[140:143], v[100:103]
    v_mfma_f32_16x16x32_bf16 v[104:107], a[200:203], v[136:139], v[104:107]
    v_mfma_f32_16x16x32_bf16 v[104:107], a[216:219], v[140:143], v[104:107]
    buffer_load_dwordx4 v[132:135], v17, s[4:7], s77 offen sc1
    v_mfma_f32_16x16x32_bf16 v[108:111], a[204:207], v[136:139], v[108:111]
    v_mfma_f32_16x16x32_bf16 v[108:111], a[220:223], v[140:143], v[108:111]
    s_waitcnt vmcnt(11)
    v_mfma_f32_16x16x32_bf16 v[96:99], a[224:227], v[228:231], v[96:99]
    s_waitcnt vmcnt(10)
    v_mfma_f32_16x16x32_bf16 v[96:99], a[240:243], v[232:235], v[96:99]
    buffer_load_dwordx4 v[136:139], v17, s[4:7], s78 offen sc1
    v_mfma_f32_16x16x32_bf16 v[100:103], a[228:231], v[228:231], v[100:103]
    v_mfma_f32_16x16x32_bf16 v[100:103], a[244:247], v[232:235], v[100:103]
    v_mfma_f32_16x16x32_bf16 v[104:107], a[232:235], v[228:231], v[104:107]
    v_mfma_f32_16x16x32_bf16 v[104:107], a[248:251], v[232:235], v[104:107]
    buffer_load_dwordx4 v[140:143], v17, s[4:7], s79 offen sc1
    v_mfma_f32_16x16x32_bf16 v[108:111], a[236:239], v[228:231], v[108:111]
    v_mfma_f32_16x16x32_bf16 v[108:111], a[252:255], v[232:235], v[108:111]
    s_waitcnt vmcnt(11)
    v_mfma_f32_16x16x32_bf16 v[192:195], a[0:3], v[64:67], v[112:115]
    s_waitcnt vmcnt(10)
    v_mfma_f32_16x16x32_bf16 v[192:195], a[16:19], v[68:71], v[192:195]
    buffer_load_dwordx4 v[228:231], v17, s[4:7], s80 offen sc1
    v_mfma_f32_16x16x32_bf16 v[196:199], a[4:7], v[64:67], v[116:119]
    ds_write_b128 v46, v[96:99] offset:0
    v_mfma_f32_16x16x32_bf16 v[196:199], a[20:23], v[68:71], v[196:199]
    v_mfma_f32_16x16x32_bf16 v[200:203], a[8:11], v[64:67], v[120:123]
    ds_write_b128 v46, v[100:103] offset:1024
    v_mfma_f32_16x16x32_bf16 v[200:203], a[24:27], v[68:71], v[200:203]
    buffer_load_dwordx4 v[232:235], v17, s[4:7], s81 offen sc1
    v_mfma_f32_16x16x32_bf16 v[204:207], a[12:15], v[64:67], v[124:127]
    v_mfma_f32_16x16x32_bf16 v[204:207], a[28:31], v[68:71], v[204:207]
    s_waitcnt vmcnt(11)
    v_mfma_f32_16x16x32_bf16 v[192:195], a[32:35], v[72:75], v[192:195]
    s_waitcnt vmcnt(10)
    v_mfma_f32_16x16x32_bf16 v[192:195], a[48:51], v[76:79], v[192:195]
    buffer_load_dwordx4 v[64:67], v17, s[4:7], s82 offen sc1
    v_mfma_f32_16x16x32_bf16 v[196:199], a[36:39], v[72:75], v[196:199]
    ds_write_b128 v46, v[104:107] offset:2048
    v_mfma_f32_16x16x32_bf16 v[196:199], a[52:55], v[76:79], v[196:199]
    ds_write_b128 v46, v[108:111] offset:3072
    v_mfma_f32_16x16x32_bf16 v[200:203], a[40:43], v[72:75], v[200:203]
    v_mfma_f32_16x16x32_bf16 v[200:203], a[56:59], v[76:79], v[200:203]
    buffer_load_dwordx4 v[68:71], v17, s[4:7], s83 offen sc1
    v_mfma_f32_16x16x32_bf16 v[204:207], a[44:47], v[72:75], v[204:207]
    v_mfma_f32_16x16x32_bf16 v[204:207], a[60:63], v[76:79], v[204:207]
    s_waitcnt lgkmcnt(0)
    s_waitcnt vmcnt(11)
    v_mfma_f32_16x16x32_bf16 v[192:195], a[64:67], v[80:83], v[192:195]
    s_barrier
    s_waitcnt vmcnt(10)
    v_mfma_f32_16x16x32_bf16 v[192:195], a[80:83], v[84:87], v[192:195]
    s_add_u32 m0, s29, 127072
    s_nop 0
    buffer_load_dwordx4 v1, s[24:27], s31 offen  lds
    v_mfma_f32_16x16x32_bf16 v[196:199], a[68:71], v[80:83], v[196:199]
    ds_read_b128 v[144:147], v47 offset:0
    v_mfma_f32_16x16x32_bf16 v[196:199], a[84:87], v[84:87], v[196:199]
    ds_read_b128 v[148:151], v47 offset:1024
    v_mfma_f32_16x16x32_bf16 v[200:203], a[72:75], v[80:83], v[200:203]
    ds_read_b128 v[152:155], v47 offset:2048
    v_mfma_f32_16x16x32_bf16 v[200:203], a[88:91], v[84:87], v[200:203]
    s_add_u32 m0, s29, 131296
    s_nop 0
    buffer_load_dwordx4 v1, s[24:27], s48 offen  lds
    v_mfma_f32_16x16x32_bf16 v[204:207], a[76:79], v[80:83], v[204:207]
    ds_read_b128 v[156:159], v47 offset:3072
    v_mfma_f32_16x16x32_bf16 v[204:207], a[92:95], v[84:87], v[204:207]
    ds_read_b128 v[160:163], v47 offset:4096
    s_waitcnt vmcnt(11)
    v_mfma_f32_16x16x32_bf16 v[192:195], a[96:99], v[88:91], v[192:195]
    ds_read_b128 v[164:167], v47 offset:5120
    s_waitcnt vmcnt(10)
    v_mfma_f32_16x16x32_bf16 v[192:195], a[112:115], v[92:95], v[192:195]
    s_add_u32 m0, s29, 135520
    s_nop 0
    buffer_load_dwordx4 v1, s[24:27], s49 offen  lds
    v_mfma_f32_16x16x32_bf16 v[196:199], a[100:103], v[88:91], v[196:199]
    ds_read_b128 v[168:171], v47 offset:6144
    v_mfma_f32_16x16x32_bf16 v[196:199], a[116:119], v[92:95], v[196:199]
    ds_read_b128 v[172:175], v47 offset:7168
    v_mfma_f32_16x16x32_bf16 v[200:203], a[104:107], v[88:91], v[200:203]
    ds_read_b128 v[176:179], v47 offset:8192
    v_mfma_f32_16x16x32_bf16 v[200:203], a[120:123], v[92:95], v[200:203]
    s_add_u32 m0, s29, 140160
    s_nop 0
    buffer_load_dwordx4 v1, s[4:7], s40 offen sc1 lds
    v_mfma_f32_16x16x32_bf16 v[204:207], a[108:111], v[88:91], v[204:207]
    ds_read_b128 v[180:183], v47 offset:9216
    v_mfma_f32_16x16x32_bf16 v[204:207], a[124:127], v[92:95], v[204:207]
    ds_read_b128 v[184:187], v47 offset:10240
    ds_read_b128 v[188:191], v47 offset:11264
    s_waitcnt vmcnt(11)
    v_mfma_f32_16x16x32_bf16 v[192:195], a[128:131], v[128:131], v[192:195]
    s_waitcnt lgkmcnt(7)
    v_add_f32 v144, v144, v160
    s_waitcnt vmcnt(10)
    v_mfma_f32_16x16x32_bf16 v[192:195], a[144:147], v[132:135], v[192:195]
    s_add_u32 m0, s29, 144768
    s_nop 0
    buffer_load_dwordx4 v1, s[4:7], s41 offen sc1 lds
    v_mfma_f32_16x16x32_bf16 v[196:199], a[132:135], v[128:131], v[196:199]
    v_add_f32 v145, v145, v161
    v_add_f32 v146, v146, v162
    v_mfma_f32_16x16x32_bf16 v[196:199], a[148:151], v[132:135], v[196:199]
    v_add_f32 v147, v147, v163
    s_waitcnt lgkmcnt(6)
    v_add_f32 v148, v148, v164
    v_mfma_f32_16x16x32_bf16 v[200:203], a[136:139], v[128:131], v[200:203]
    v_add_f32 v149, v149, v165
    v_add_f32 v150, v150, v166
    v_mfma_f32_16x16x32_bf16 v[200:203], a[152:155], v[132:135], v[200:203]
    s_add_u32 m0, s29, 149376
    s_nop 0
    buffer_load_dwordx4 v1, s[4:7], s50 offen sc1 lds
    v_mfma_f32_16x16x32_bf16 v[204:207], a[140:143], v[128:131], v[204:207]
    v_add_f32 v151, v151, v167
    s_waitcnt lgkmcnt(5)
    v_add_f32 v152, v152, v168
    v_mfma_f32_16x16x32_bf16 v[204:207], a[156:159], v[132:135], v[204:207]
    v_add_f32 v153, v153, v169
    s_waitcnt vmcnt(11)
    v_mfma_f32_16x16x32_bf16 v[192:195], a[160:163], v[136:139], v[192:195]
    v_add_f32 v154, v154, v170
    s_waitcnt vmcnt(10)
    v_mfma_f32_16x16x32_bf16 v[192:195], a[176:179], v[140:143], v[192:195]
    v_add_f32 v155, v155, v171
    s_waitcnt lgkmcnt(4)
    v_add_f32 v156, v156, v172
    v_mfma_f32_16x16x32_bf16 v[196:199], a[164:167], v[136:139], v[196:199]
    v_add_f32 v157, v157, v173
    v_add_f32 v158, v158, v174
    v_mfma_f32_16x16x32_bf16 v[196:199], a[180:183], v[140:143], v[196:199]
    v_add_f32 v159, v159, v175
    s_waitcnt lgkmcnt(3)
    v_add_f32 v144, v144, v176
    v_mfma_f32_16x16x32_bf16 v[200:203], a[168:171], v[136:139], v[200:203]
    v_add_f32 v145, v145, v177
    v_add_f32 v146, v146, v178
    v_mfma_f32_16x16x32_bf16 v[200:203], a[184:187], v[140:143], v[200:203]
    v_add_f32 v147, v147, v179
    s_waitcnt lgkmcnt(2)
    v_add_f32 v148, v148, v180
    v_mfma_f32_16x16x32_bf16 v[204:207], a[172:175], v[136:139], v[204:207]
    v_add_f32 v149, v149, v181
    v_add_f32 v150, v150, v182
    v_mfma_f32_16x16x32_bf16 v[204:207], a[188:191], v[140:143], v[204:207]
    v_add_f32 v151, v151, v183
    s_waitcnt vmcnt(9)
    v_mfma_f32_16x16x32_bf16 v[192:195], a[192:195], v[228:231], v[192:195]
    s_waitcnt lgkmcnt(1)
    v_add_f32 v152, v152, v184
    s_waitcnt vmcnt(8)
    v_mfma_f32_16x16x32_bf16 v[192:195], a[208:211], v[232:235], v[192:195]
    v_add_f32 v153, v153, v185
    v_add_f32 v154, v154, v186
    v_mfma_f32_16x16x32_bf16 v[196:199], a[196:199], v[228:231], v[196:199]
    v_add_f32 v155, v155, v187
    s_waitcnt lgkmcnt(0)
    v_add_f32 v156, v156, v188
    v_mfma_f32_16x16x32_bf16 v[196:199], a[212:215], v[232:235], v[196:199]
    v_add_f32 v157, v157, v189
    v_add_f32 v158, v158, v190
    v_mfma_f32_16x16x32_bf16 v[200:203], a[200:203], v[228:231], v[200:203]
    v_add_f32 v159, v159, v191
    v_mfma_f32_16x16x32_bf16 v[200:203], a[216:219], v[232:235], v[200:203]
    v_mfma_f32_16x16x32_bf16 v[204:207], a[204:207], v[228:231], v[204:207]
    v_mfma_f32_16x16x32_bf16 v[204:207], a[220:223], v[232:235], v[204:207]
    s_waitcnt vmcnt(7)
    v_mfma_f32_16x16x32_bf16 v[192:195], a[224:227], v[64:67], v[192:195]
    s_waitcnt vmcnt(6)
    v_mfma_f32_16x16x32_bf16 v[192:195], a[240:243], v[68:71], v[192:195]
    v_mfma_f32_16x16x32_bf16 v[196:199], a[228:231], v[64:67], v[196:199]
    v_mfma_f32_16x16x32_bf16 v[196:199], a[244:247], v[68:71], v[196:199]
    v_mfma_f32_16x16x32_bf16 v[200:203], a[232:235], v[64:67], v[200:203]
    v_mfma_f32_16x16x32_bf16 v[200:203], a[248:251], v[68:71], v[200:203]
    v_mfma_f32_16x16x32_bf16 v[204:207], a[236:239], v[64:67], v[204:207]
    v_mfma_f32_16x16x32_bf16 v[204:207], a[252:255], v[68:71], v[204:207]
    s_nop 1
    v_pk_add_f32 v[192:193], v[192:193], v[144:145]
    v_pk_add_f32 v[194:195], v[194:195], v[146:147]
    v_pk_add_f32 v[196:197], v[196:197], v[148:149]
    v_pk_add_f32 v[198:199], v[198:199], v[150:151]
    v_pk_add_f32 v[200:201], v[200:201], v[152:153]
    v_pk_add_f32 v[202:203], v[202:203], v[154:155]
    v_pk_add_f32 v[204:205], v[204:205], v[156:157]
    v_pk_add_f32 v[206:207], v[206:207], v[158:159]
    v_pk_mul_f32 v[160:161], v[192:193], v[192:193]
    v_pk_mul_f32 v[162:163], v[194:195], v[194:195]
    v_pk_mul_f32 v[164:165], v[196:197], v[196:197]
    v_pk_mul_f32 v[166:167], v[198:199], v[198:199]
    v_pk_mul_f32 v[168:169], v[200:201], v[200:201]
    v_pk_mul_f32 v[170:171], v[202:203], v[202:203]
    v_pk_mul_f32 v[172:173], v[204:205], v[204:205]
    v_pk_mul_f32 v[174:175], v[206:207], v[206:207]
    v_pk_fma_f32 v[160:161], v[160:161], s[22:23], v[52:53] op_sel_hi:[1,0,0]
    v_pk_fma_f32 v[162:163], v[162:163], s[22:23], v[52:53] op_sel_hi:[1,0,0]
    v_pk_fma_f32 v[164:165], v[164:165], s[22:23], v[52:53] op_sel_hi:[1,0,0]
    v_pk_fma_f32 v[166:167], v[166:167], s[22:23], v[52:53] op_sel_hi:[1,0,0]
    v_pk_fma_f32 v[168:169], v[168:169], s[22:23], v[52:53] op_sel_hi:[1,0,0]
    v_pk_fma_f32 v[170:171], v[170:171], s[22:23], v[52:53] op_sel_hi:[1,0,0]
    v_pk_fma_f32 v[172:173], v[172:173], s[22:23], v[52:53] op_sel_hi:[1,0,0]
    v_pk_fma_f32 v[174:175], v[174:175], s[22:23], v[52:53] op_sel_hi:[1,0,0]
    v_pk_mul_f32 v[160:161], v[160:161], v[192:193]
    v_pk_mul_f32 v[162:163], v[162:163], v[194:195]
    v_pk_mul_f32 v[164:165], v[164:165], v[196:197]
    v_pk_mul_f32 v[166:167], v[166:167], v[198:199]
    v_pk_mul_f32 v[168:169], v[168:169], v[200:201]
    v_pk_mul_f32 v[170:171], v[170:171], v[202:203]
    v_pk_mul_f32 v[172:173], v[172:173], v[204:205]
    v_pk_mul_f32 v[174:175], v[174:175], v[206:207]
    v_exp_f32 v160, v160
    v_exp_f32 v161, v161
    v_exp_f32 v162, v162
    v_exp_f32 v163, v163
    v_exp_f32 v164, v164
    v_exp_f32 v165, v165
    v_exp_f32 v166, v166
    v_exp_f32 v167, v167
    v_exp_f32 v168, v168
    v_exp_f32 v169, v169
    v_exp_f32 v170, v170
    v_exp_f32 v171, v171
    v_exp_f32 v172, v172
    v_exp_f32 v173, v173
    v_exp_f32 v174, v174
    v_exp_f32 v175, v175
    v_pk_add_f32 v[160:161], v[160:161], 1.0 op_sel_hi:[1,0]
    v_pk_add_f32 v[162:163], v[162:163], 1.0 op_sel_hi:[1,0]
    v_pk_add_f32 v[164:165], v[164:165], 1.0 op_sel_hi:[1,0]
    v_pk_add_f32 v[166:167], v[166:167], 1.0 op_sel_hi:[1,0]
    v_pk_add_f32 v[168:169], v[168:169], 1.0 op_sel_hi:[1,0]
    v_pk_add_f32 v[170:171], v[170:171], 1.0 op_sel_hi:[1,0]
    v_pk_add_f32 v[172:173], v[172:173], 1.0 op_sel_hi:[1,0]
    v_pk_add_f32 v[174:175], v[174:175], 1.0 op_sel_hi:[1,0]
    v_rcp_f32 v160, v160
    v_rcp_f32 v161, v161
    v_rcp_f32 v162, v162
    v_rcp_f32 v163, v163
    v_rcp_f32 v164, v164
    v_rcp_f32 v165, v165
    v_rcp_f32 v166, v166
    v_rcp_f32 v167, v167
    v_rcp_f32 v168, v168
    v_rcp_f32 v169, v169
    v_rcp_f32 v170, v170
    v_rcp_f32 v171, v171
    v_rcp_f32 v172, v172
    v_rcp_f32 v173, v173
    v_rcp_f32 v174, v174
    v_rcp_f32 v175, v175
    v_pk_mul_f32 v[160:161], v[160:161], v[192:193]
    v_pk_mul_f32 v[162:163], v[162:163], v[194:195]
    v_pk_mul_f32 v[164:165], v[164:165], v[196:197]
    v_pk_mul_f32 v[166:167], v[166:167], v[198:199]
    v_pk_mul_f32 v[168:169], v[168:169], v[200:201]
    v_pk_mul_f32 v[170:171], v[170:171], v[202:203]
    v_pk_mul_f32 v[172:173], v[172:173], v[204:205]
    v_pk_mul_f32 v[174:175], v[174:175], v[206:207]
    v_cvt_pk_bf16_f32 v220, v160, v161
    v_cvt_pk_bf16_f32 v221, v162, v163
    v_cvt_pk_bf16_f32 v222, v164, v165
    v_cvt_pk_bf16_f32 v223, v166, v167
    v_cvt_pk_bf16_f32 v224, v168, v169
    v_cvt_pk_bf16_f32 v225, v170, v171
    v_cvt_pk_bf16_f32 v226, v172, v173
    v_cvt_pk_bf16_f32 v227, v174, v175
    buffer_store_dwordx4 v[220:223], v48, s[4:7], s23 offen offset:0 sc1
    buffer_store_dwordx4 v[224:227], v48, s[4:7], s23 offen offset:1024 sc1
L_Ajoin:
    s_waitcnt vmcnt(2)
    s_barrier
    ds_read_b64_tr_b16 v[64:65], v20 offset:32
    ds_read_b64_tr_b16 v[66:67], v20 offset:0
    ds_read_b64_tr_b16 v[128:129], v21 offset:0
    ds_read_b64_tr_b16 v[130:131], v21 offset:32
    ds_read_b64_tr_b16 v[68:69], v20 offset:288
    ds_read_b64_tr_b16 v[70:71], v20 offset:256
    ds_read_b64_tr_b16 v[132:133], v21 offset:256
    ds_read_b64_tr_b16 v[134:135], v21 offset:288
    ds_read_b64_tr_b16 v[72:73], v20 offset:544
    ds_read_b64_tr_b16 v[74:75], v20 offset:512
    ds_read_b64_tr_b16 v[136:137], v21 offset:512
    ds_read_b64_tr_b16 v[138:139], v21 offset:544
    ds_read_b64_tr_b16 v[76:77], v20 offset:800
    ds_read_b64_tr_b16 v[78:79], v20 offset:768
    ds_read_b64_tr_b16 v[140:141], v21 offset:768
    ds_read_b64_tr_b16 v[142:143], v21 offset:800
    s_waitcnt lgkmcnt(15)
    v_and_b32 v43, 0xffff0000, v65
    v_lshlrev_b32 v42, 16, v65
    v_add_f32 v43, s28, v43
    s_mov_b32 exec_lo, 0
    s_mov_b32 exec_hi, 0x1000001
    v_cvt_pk_bf16_f32 v65, v42, v43
    s_mov_b64 exec, -1
    s_waitcnt lgkmcnt(14)
    v_and_b32 v43, 0xffff0000, v67
    v_lshlrev_b32 v42, 16, v67
    v_add_f32 v43, s28, v43
    s_mov_b32 exec_lo, 0
    s_mov_b32 exec_hi, 0x10000010
    v_cvt_pk_bf16_f32 v67, v42, v43
    s_mov_b64 exec, -1
    s_waitcnt lgkmcnt(12)
    v_mfma_f32_16x16x32_bf16 v[192:195], v[64:67], v[128:131], 0
    ds_read_b64_tr_b16 v[80:81], v20 offset:1056
    s_waitcnt lgkmcnt(9)
    v_mfma_f32_16x16x32_bf16 v[196:199], v[64:67], v[132:135], 0
    ds_read_b64_tr_b16 v[82:83], v20 offset:1024
    v_mfma_f32_16x16x32_bf16 v[196:199], v[68:71], v[128:131], v[196:199]
    ds_read_b64_tr_b16 v[144:145], v21 offset:1024
    s_waitcnt lgkmcnt(7)
    v_mfma_f32_16x16x32_bf16 v[200:203], v[64:67], v[136:139], 0
    ds_read_b64_tr_b16 v[146:147], v21 offset:1056
    v_add_f32_dpp v194, v195, v194 wave_shr:1 row_mask:0xf bank_mask:0xf bound_ctrl:0
    v_mfma_f32_16x16x32_bf16 v[200:203], v[68:71], v[132:135], v[200:203]
    ds_read_b64_tr_b16 v[84:85], v20 offset:1312
    v_add_f32_dpp v193, v194, v193 wave_shr:1 row_mask:0xf bank_mask:0xf bound_ctrl:0
    v_mfma_f32_16x16x32_bf16 v[200:203], v[72:75], v[128:131], v[200:203]
    ds_read_b64_tr_b16 v[86:87], v20 offset:1280
    s_waitcnt lgkmcnt(6)
    v_mfma_f32_16x16x32_bf16 v[204:207], v[64:67], v[140:143], 0
    ds_read_b64_tr_b16 v[148:149], v21 offset:1280
    v_add_f32_dpp v216, v193, v192 wave_shr:1 row_mask:0xf bank_mask:0xf bound_ctrl:0
    v_mfma_f32_16x16x32_bf16 v[204:207], v[68:71], v[136:139], v[204:207]
    ds_read_b64_tr_b16 v[150:151], v21 offset:1312
    v_add_f32_dpp v198, v199, v198 wave_shr:1 row_mask:0xf bank_mask:0xf bound_ctrl:0
    v_mfma_f32_16x16x32_bf16 v[204:207], v[72:75], v[132:135], v[204:207]
    ds_read_b64_tr_b16 v[88:89], v20 offset:1568
    v_mov_b32_dpp v199, v195 wave_shl:1 row_mask:0xf bank_mask:0xf
    v_mfma_f32_16x16x32_bf16 v[204:207], v[76:79], v[128:131], v[204:207]
    ds_read_b64_tr_b16 v[90:91], v20 offset:1536
    s_waitcnt lgkmcnt(6)
    v_mfma_f32_16x16x32_bf16 v[208:211], v[64:67], v[144:147], 0
    ds_read_b64_tr_b16 v[152:153], v21 offset:1536
    v_add_f32_dpp v197, v198, v197 wave_shr:1 row_mask:0xf bank_mask:0xf bound_ctrl:0
    v_mfma_f32_16x16x32_bf16 v[208:211], v[68:71], v[140:143], v[208:211]
    ds_read_b64_tr_b16 v[154:155], v21 offset:1568
    v_mov_b32_dpp v198, v194 wave_shl:1 row_mask:0xf bank_mask:0xf
    v_mfma_f32_16x16x32_bf16 v[208:211], v[72:75], v[136:139], v[208:211]
    v_add_f32_dpp v217, v197, v196 wave_shr:1 row_mask:0xf bank_mask:0xf bound_ctrl:0
    v_mov_b32_dpp v197, v193 wave_shl:1 row_mask:0xf bank_mask:0xf
    v_mfma_f32_16x16x32_bf16 v[208:211], v[76:79], v[132:135], v[208:211]
    ds_read_b64_tr_b16 v[92:93], v20 offset:1824
    v_add_f32_dpp v202, v203, v202 wave_shr:1 row_mask:0xf bank_mask:0xf bound_ctrl:0
    v_mfma_f32_16x16x32_bf16 v[208:211], v[80:83], v[128:131], v[208:211]
    ds_read_b64_tr_b16 v[94:95], v20 offset:1792
    s_waitcnt lgkmcnt(6)
    v_mfma_f32_16x16x32_bf16 v[212:215], v[64:67], v[148:151], 0
    ds_read_b64_tr_b16 v[156:157], v21 offset:1792
    v_mov_b32_dpp v203, v199 wave_shl:1 row_mask:0xf bank_mask:0xf
    v_mfma_f32_16x16x32_bf16 v[212:215], v[68:71], v[144:147], v[212:215]
    ds_read_b64_tr_b16 v[158:159], v21 offset:1824
    v_add_f32_dpp v201, v202, v201 wave_shr:1 row_mask:0xf bank_mask:0xf bound_ctrl:0
    v_mfma_f32_16x16x32_bf16 v[212:215], v[72:75], v[140:143], v[212:215]
    v_mov_b32_dpp v202, v198 wave_shl:1 row_mask:0xf bank_mask:0xf
    v_add_f32_dpp v218, v201, v200 wave_shr:1 row_mask:0xf bank_mask:0xf bound_ctrl:0
    v_mfma_f32_16x16x32_bf16 v[212:215], v[76:79], v[136:139], v[212:215]
    v_mov_b32_dpp v201, v197 wave_shl:1 row_mask:0xf bank_mask:0xf
    ds_read_b64_tr_b16 v[96:97], v20 offset:2080
    v_mfma_f32_16x16x32_bf16 v[212:215], v[80:83], v[132:135], v[212:215]
    ds_read_b64_tr_b16 v[98:99], v20 offset:2048
    v_add_f32_dpp v206, v207, v206 wave_shr:1 row_mask:0xf bank_mask:0xf bound_ctrl:0
    v_mfma_f32_16x16x32_bf16 v[212:215], v[84:87], v[128:131], v[212:215]
    ds_read_b64_tr_b16 v[160:161], v21 offset:2048
    s_waitcnt lgkmcnt(7)
    v_mfma_f32_16x16x32_bf16 v[192:195], v[64:67], v[152:155], 0
    ds_read_b64_tr_b16 v[162:163], v21 offset:2080
    v_mov_b32_dpp v207, v203 wave_shl:1 row_mask:0xf bank_mask:0xf
    v_mfma_f32_16x16x32_bf16 v[192:195], v[68:71], v[148:151], v[192:195]
    v_add_f32_dpp v205, v206, v205 wave_shr:1 row_mask:0xf bank_mask:0xf bound_ctrl:0
    v_mov_b32_dpp v206, v202 wave_shl:1 row_mask:0xf bank_mask:0xf
    v_mfma_f32_16x16x32_bf16 v[192:195], v[72:75], v[144:147], v[192:195]
    v_add_f32_dpp v219, v205, v204 wave_shr:1 row_mask:0xf bank_mask:0xf bound_ctrl:0
    v_mov_b32_dpp v205, v201 wave_shl:1 row_mask:0xf bank_mask:0xf
    v_mfma_f32_16x16x32_bf16 v[192:195], v[76:79], v[140:143], v[192:195]
    ds_read_b64_tr_b16 v[100:101], v20 offset:2336
    v_add_f32_dpp v210, v211, v210 wave_shr:1 row_mask:0xf bank_mask:0xf bound_ctrl:0
    v_mfma_f32_16x16x32_bf16 v[192:195], v[80:83], v[136:139], v[192:195]
    ds_read_b64_tr_b16 v[102:103], v20 offset:2304
    v_mov_b32_dpp v211, v207 wave_shl:1 row_mask:0xf bank_mask:0xf
    v_mfma_f32_16x16x32_bf16 v[192:195], v[84:87], v[132:135], v[192:195]
    ds_read_b64_tr_b16 v[164:165], v21 offset:2304
    v_add_f32_dpp v209, v210, v209 wave_shr:1 row_mask:0xf bank_mask:0xf bound_ctrl:0
    v_mfma_f32_16x16x32_bf16 v[192:195], v[88:91], v[128:131], v[192:195]
    ds_read_b64_tr_b16 v[166:167], v21 offset:2336
    s_waitcnt lgkmcnt(8)
    v_mfma_f32_16x16x32_bf16 v[196:199], v[64:67], v[156:159], 0
    v_mov_b32_dpp v210, v206 wave_shl:1 row_mask:0xf bank_mask:0xf
    v_add_f32_dpp v220, v209, v208 wave_shr:1 row_mask:0xf bank_mask:0xf bound_ctrl:0
    v_mfma_f32_16x16x32_bf16 v[196:199], v[68:71], v[152:155], v[196:199]
    v_mov_b32_dpp v209, v205 wave_shl:1 row_mask:0xf bank_mask:0xf
    v_add_f32_dpp v214, v215, v214 wave_shr:1 row_mask:0xf bank_mask:0xf bound_ctrl:0
    v_mfma_f32_16x16x32_bf16 v[196:199], v[72:75], v[148:151], v[196:199]
    v_mov_b32_dpp v215, v211 wave_shl:1 row_mask:0xf bank_mask:0xf
    v_add_f32_dpp v213, v214, v213 wave_shr:1 row_mask:0xf bank_mask:0xf bound_ctrl:0
    v_mfma_f32_16x16x32_bf16 v[196:199], v[76:79], v[144:147], v[196:199]
    v_mov_b32_dpp v214, v210 wave_shl:1 row_mask:0xf bank_mask:0xf
    v_add_f32_dpp v221, v213, v212 wave_shr:1 row_mask:0xf bank_mask:0xf bound_ctrl:0
    v_mfma_f32_16x16x32_bf16 v[196:199], v[80:83], v[140:143], v[196:199]
    v_mov_b32_dpp v213, v209 wave_shl:1 row_mask:0xf bank_mask:0xf
    ds_read_b64_tr_b16 v[104:105], v20 offset:2592
    v_mfma_f32_16x16x32_bf16 v[196:199], v[84:87], v[136:139], v[196:199]
    ds_read_b64_tr_b16 v[106:107], v20 offset:2560
    v_add_f32_dpp v194, v195, v194 wave_shr:1 row_mask:0xf bank_mask:0xf bound_ctrl:0
    v_mfma_f32_16x16x32_bf16 v[196:199], v[88:91], v[132:135], v[196:199]
    ds_read_b64_tr_b16 v[168:169], v21 offset:2560
    v_mov_b32_dpp v195, v215 wave_shl:1 row_mask:0xf bank_mask:0xf
    v_mfma_f32_16x16x32_bf16 v[196:199], v[92:95], v[128:131], v[196:199]
    ds_read_b64_tr_b16 v[170:171], v21 offset:2592
    s_waitcnt lgkmcnt(8)
    v_mfma_f32_16x16x32_bf16 v[200:203], v[64:67], v[160:163], 0
    s_waitcnt vmcnt(0)
    v_add_f32_dpp v193, v194, v193 wave_shr:1 row_mask:0xf bank_mask:0xf bound_ctrl:0
    v_mfma_f32_16x16x32_bf16 v[200:203], v[68:71], v[156:159], v[200:203]
    s_mov_b64 exec, 1
    buffer_store_dword v34, v0, s[4:7], s94 offen sc1
    s_mov_b64 exec, -1
    v_mfma_f32_16x16x32_bf16 v[200:203], v[72:75], v[152:155], v[200:203]
    v_mov_b32_dpp v194, v214 wave_shl:1 row_mask:0xf bank_mask:0xf
    v_add_f32_dpp v222, v193, v192 wave_shr:1 row_mask:0xf bank_mask:0xf bound_ctrl:0
    v_mfma_f32_16x16x32_bf16 v[200:203], v[76:79], v[148:151], v[200:203]
    v_mov_b32_dpp v193, v213 wave_shl:1 row_mask:0xf bank_mask:0xf
    ds_read_b64_tr_b16 v[108:109], v20 offset:2848
    v_mfma_f32_16x16x32_bf16 v[200:203], v[80:83], v[144:147], v[200:203]
    ds_read_b64_tr_b16 v[110:111], v20 offset:2816
    v_add_f32_dpp v198, v199, v198 wave_shr:1 row_mask:0xf bank_mask:0xf bound_ctrl:0
    v_mfma_f32_16x16x32_bf16 v[200:203], v[84:87], v[140:143], v[200:203]
    ds_read_b64_tr_b16 v[172:173], v21 offset:2816
    v_mov_b32_dpp v199, v195 wave_shl:1 row_mask:0xf bank_mask:0xf
    v_mfma_f32_16x16x32_bf16 v[200:203], v[88:91], v[136:139], v[200:203]
    ds_read_b64_tr_b16 v[174:175], v21 offset:2848
    v_add_f32_dpp v197, v198, v197 wave_shr:1 row_mask:0xf bank_mask:0xf bound_ctrl:0
    v_mfma_f32_16x16x32_bf16 v[200:203], v[92:95], v[132:135], v[200:203]
    v_mov_b32_dpp v198, v194 wave_shl:1 row_mask:0xf bank_mask:0xf
    v_add_f32_dpp v223, v197, v196 wave_shr:1 row_mask:0xf bank_mask:0xf bound_ctrl:0
    v_mfma_f32_16x16x32_bf16 v[200:203], v[96:99], v[128:131], v[200:203]
    v_mov_b32_dpp v197, v193 wave_shl:1 row_mask:0xf bank_mask:0xf
    s_waitcnt lgkmcnt(8)
    v_mfma_f32_16x16x32_bf16 v[204:207], v[64:67], v[164:167], 0
    ds_read_b64_tr_b16 v[112:113], v20 offset:3104
    v_mov_b32 v240, v216
    v_mfma_f32_16x16x32_bf16 v[204:207], v[68:71], v[160:163], v[204:207]
    ds_read_b64_tr_b16 v[114:115], v20 offset:3072
    v_mov_b32_dpp v240, v217 row_shr:4 row_mask:0x1 bank_mask:0x2
    v_mfma_f32_16x16x32_bf16 v[204:207], v[72:75], v[156:159], v[204:207]
    v_add_f32_dpp v202, v203, v202 wave_shr:1 row_mask:0xf bank_mask:0xf bound_ctrl:0
    v_mov_b32_dpp v203, v199 wave_shl:1 row_mask:0xf bank_mask:0xf
    v_mfma_f32_16x16x32_bf16 v[204:207], v[76:79], v[152:155], v[204:207]
    v_add_f32_dpp v201, v202, v201 wave_shr:1 row_mask:0xf bank_mask:0xf bound_ctrl:0
    v_mov_b32_dpp v202, v198 wave_shl:1 row_mask:0xf bank_mask:0xf
    v_mfma_f32_16x16x32_bf16 v[204:207], v[80:83], v[148:151], v[204:207]
    v_add_f32_dpp v224, v201, v200 wave_shr:1 row_mask:0xf bank_mask:0xf bound_ctrl:0
    v_mov_b32_dpp v201, v197 wave_shl:1 row_mask:0xf bank_mask:0xf
    v_mfma_f32_16x16x32_bf16 v[204:207], v[84:87], v[144:147], v[204:207]
    ds_read_b64_tr_b16 v[176:177], v21 offset:3072
    v_cvt_pk_bf16_f32 v216, v216, v217
    v_mfma_f32_16x16x32_bf16 v[204:207], v[88:91], v[140:143], v[204:207]
    ds_read_b64_tr_b16 v[178:179], v21 offset:3104
    v_mfma_f32_16x16x32_bf16 v[204:207], v[92:95], v[136:139], v[204:207]
    ds_read_b64_tr_b16 v[116:117], v20 offset:3360
    v_mfma_f32_16x16x32_bf16 v[204:207], v[96:99], v[132:135], v[204:207]
    ds_read_b64_tr_b16 v[118:119], v20 offset:3328
    v_mfma_f32_16x16x32_bf16 v[204:207], v[100:103], v[128:131], v[204:207]
    ds_read_b64_tr_b16 v[180:181], v21 offset:3328
    s_waitcnt lgkmcnt(11)
    v_mfma_f32_16x16x32_bf16 v[208:211], v[64:67], v[168:171], 0
    ds_read_b64_tr_b16 v[182:183], v21 offset:3360
    v_mfma_f32_16x16x32_bf16 v[208:211], v[68:71], v[164:167], v[208:211]
    ds_read_b64_tr_b16 v[120:121], v20 offset:3616
    v_mfma_f32_16x16x32_bf16 v[208:211], v[72:75], v[160:163], v[208:211]
    s_nop 0
    v_add_f32_dpp v206, v207, v206 wave_shr:1 row_mask:0xf bank_mask:0xf bound_ctrl:0
    v_mov_b32_dpp v207, v203 wave_shl:1 row_mask:0xf bank_mask:0xf
    v_mfma_f32_16x16x32_bf16 v[208:211], v[76:79], v[156:159], v[208:211]
    v_add_f32_dpp v205, v206, v205 wave_shr:1 row_mask:0xf bank_mask:0xf bound_ctrl:0
    v_mov_b32_dpp v206, v202 wave_shl:1 row_mask:0xf bank_mask:0xf
    v_mfma_f32_16x16x32_bf16 v[208:211], v[80:83], v[152:155], v[208:211]
    v_add_f32_dpp v225, v205, v204 wave_shr:1 row_mask:0xf bank_mask:0xf bound_ctrl:0
    v_mov_b32_dpp v205, v201 wave_shl:1 row_mask:0xf bank_mask:0xf
    v_mfma_f32_16x16x32_bf16 v[208:211], v[84:87], v[148:151], v[208:211]
    ds_read_b64_tr_b16 v[56:57], v22 offset:32
    v_mfma_f32_16x16x32_bf16 v[208:211], v[88:91], v[144:147], v[208:211]
    ds_read_b64_tr_b16 v[58:59], v22 offset:0
    v_mfma_f32_16x16x32_bf16 v[208:211], v[92:95], v[140:143], v[208:211]
    ds_read_b64_tr_b16 a[64:65], v23 offset:0
    v_mfma_f32_16x16x32_bf16 v[208:211], v[96:99], v[136:139], v[208:211]
    ds_read_b64_tr_b16 a[66:67], v23 offset:32
    v_mfma_f32_16x16x32_bf16 v[208:211], v[100:103], v[132:135], v[208:211]
    ds_read_b64_tr_b16 a[4:5], v22 offset:288
    v_mfma_f32_16x16x32_bf16 v[208:211], v[104:107], v[128:131], v[208:211]
    ds_read_b64_tr_b16 a[6:7], v22 offset:256
    s_waitcnt lgkmcnt(15)
    v_mfma_f32_16x16x32_bf16 v[212:215], v[64:67], v[172:175], 0
    ds_read_b64_tr_b16 a[68:69], v23 offset:256
    v_mfma_f32_16x16x32_bf16 v[212:215], v[68:71], v[168:171], v[212:215]
    ds_read_b64_tr_b16 a[70:71], v23 offset:288
    v_mfma_f32_16x16x32_bf16 v[212:215], v[72:75], v[164:167], v[212:215]
    ds_read_b64_tr_b16 a[8:9], v22 offset:544
    v_add_f32_dpp v210, v211, v210 wave_shr:1 row_mask:0xf bank_mask:0xf bound_ctrl:0
    v_mfma_f32_16x16x32_bf16 v[212:215], v[76:79], v[160:163], v[212:215]
    ds_read_b64_tr_b16 a[10:11], v22 offset:512
    v_mov_b32_dpp v211, v207 wave_shl:1 row_mask:0xf bank_mask:0xf
    v_mfma_f32_16x16x32_bf16 v[212:215], v[80:83], v[156:159], v[212:215]
    ds_read_b64_tr_b16 a[72:73], v23 offset:512
    v_add_f32_dpp v209, v210, v209 wave_shr:1 row_mask:0xf bank_mask:0xf bound_ctrl:0
    v_mfma_f32_16x16x32_bf16 v[212:215], v[84:87], v[152:155], v[212:215]
    ds_read_b64_tr_b16 a[74:75], v23 offset:544
    v_mov_b32_dpp v210, v206 wave_shl:1 row_mask:0xf bank_mask:0xf
    v_mfma_f32_16x16x32_bf16 v[212:215], v[88:91], v[148:151], v[212:215]
    v_add_f32_dpp v226, v209, v208 wave_shr:1 row_mask:0xf bank_mask:0xf bound_ctrl:0
    v_mov_b32_dpp v209, v205 wave_shl:1 row_mask:0xf bank_mask:0xf
    v_mfma_f32_16x16x32_bf16 v[212:215], v[92:95], v[144:147], v[212:215]
    ds_read_b64_tr_b16 a[12:13], v22 offset:800
    v_mfma_f32_16x16x32_bf16 v[212:215], v[96:99], v[140:143], v[212:215]
    ds_read_b64_tr_b16 a[14:15], v22 offset:768
    v_mfma_f32_16x16x32_bf16 v[212:215], v[100:103], v[136:139], v[212:215]
    ds_read_b64_tr_b16 a[76:77], v23 offset:768
    v_mfma_f32_16x16x32_bf16 v[212:215], v[104:107], v[132:135], v[212:215]
    ds_read_b64_tr_b16 a[78:79], v23 offset:800
    v_mfma_f32_16x16x32_bf16 v[212:215], v[108:111], v[128:131], v[212:215]
    ds_read_b64_tr_b16 v[122:123], v20 offset:3584
    s_waitcnt lgkmcnt(15)
    v_mfma_f32_16x16x32_bf16 v[192:195], v[64:67], v[176:179], 0
    ds_read_b64_tr_b16 v[184:185], v21 offset:3584
    v_mfma_f32_16x16x32_bf16 v[192:195], v[68:71], v[172:175], v[192:195]
    ds_read_b64_tr_b16 v[186:187], v21 offset:3616
    v_mfma_f32_16x16x32_bf16 v[192:195], v[72:75], v[168:171], v[192:195]
    s_nop 0
    v_add_f32_dpp v214, v215, v214 wave_shr:1 row_mask:0xf bank_mask:0xf bound_ctrl:0
    v_mov_b32_dpp v215, v211 wave_shl:1 row_mask:0xf bank_mask:0xf
    v_mfma_f32_16x16x32_bf16 v[192:195], v[76:79], v[164:167], v[192:195]
    v_add_f32_dpp v213, v214, v213 wave_shr:1 row_mask:0xf bank_mask:0xf bound_ctrl:0
    v_mov_b32_dpp v214, v210 wave_shl:1 row_mask:0xf bank_mask:0xf
    v_mfma_f32_16x16x32_bf16 v[192:195], v[80:83], v[160:163], v[192:195]
    v_add_f32_dpp v227, v213, v212 wave_shr:1 row_mask:0xf bank_mask:0xf bound_ctrl:0
    v_mov_b32_dpp v213, v209 wave_shl:1 row_mask:0xf bank_mask:0xf
    v_mfma_f32_16x16x32_bf16 v[192:195], v[84:87], v[156:159], v[192:195]
    ds_read_b64_tr_b16 a[16:17], v22 offset:1056
    s_waitcnt lgkmcnt(15)
    v_and_b32 v43, 0xffff0000, v57
    v_mfma_f32_16x16x32_bf16 v[192:195], v[88:91], v[152:155], v[192:195]
    ds_read_b64_tr_b16 a[18:19], v22 offset:1024
    v_lshlrev_b32 v42, 16, v57
    v_mfma_f32_16x16x32_bf16 v[192:195], v[92:95], v[148:151], v[192:195]
    ds_read_b64_tr_b16 a[80:81], v23 offset:1024
    v_add_f32 v43, s30, v43
    v_mfma_f32_16x16x32_bf16 v[192:195], v[96:99], v[144:147], v[192:195]
    ds_read_b64_tr_b16 a[82:83], v23 offset:1056
    v_mfma_f32_16x16x32_bf16 v[192:195], v[100:103], v[140:143], v[192:195]
    ds_read_b64_tr_b16 a[20:21], v22 offset:1312
    v_mfma_f32_16x16x32_bf16 v[192:195], v[104:107], v[136:139], v[192:195]
    ds_read_b64_tr_b16 a[22:23], v22 offset:1280
    v_mfma_f32_16x16x32_bf16 v[192:195], v[108:111], v[132:135], v[192:195]
    ds_read_b64_tr_b16 a[84:85], v23 offset:1280
    v_mfma_f32_16x16x32_bf16 v[192:195], v[112:115], v[128:131], v[192:195]
    ds_read_b64_tr_b16 a[86:87], v23 offset:1312
    v_mfma_f32_16x16x32_bf16 v[196:199], v[64:67], v[180:183], 0
    ds_read_b64_tr_b16 v[124:125], v20 offset:3872
    v_mfma_f32_16x16x32_bf16 v[196:199], v[68:71], v[176:179], v[196:199]
    ds_read_b64_tr_b16 v[126:127], v20 offset:3840
    v_mfma_f32_16x16x32_bf16 v[196:199], v[72:75], v[172:175], v[196:199]
    s_nop 1
    v_add_f32_dpp v194, v195, v194 wave_shr:1 row_mask:0xf bank_mask:0xf bound_ctrl:0
    v_mov_b32_dpp v195, v215 wave_shl:1 row_mask:0xf bank_mask:0xf
    v_mfma_f32_16x16x32_bf16 v[196:199], v[76:79], v[168:171], v[196:199]
    v_add_f32_dpp v193, v194, v193 wave_shr:1 row_mask:0xf bank_mask:0xf bound_ctrl:0
    v_mov_b32_dpp v194, v214 wave_shl:1 row_mask:0xf bank_mask:0xf
    v_mfma_f32_16x16x32_bf16 v[196:199], v[80:83], v[164:167], v[196:199]
    v_add_f32_dpp v228, v193, v192 wave_shr:1 row_mask:0xf bank_mask:0xf bound_ctrl:0
    v_mov_b32_dpp v193, v213 wave_shl:1 row_mask:0xf bank_mask:0xf
    v_mfma_f32_16x16x32_bf16 v[196:199], v[84:87], v[160:163], v[196:199]
    ds_read_b64_tr_b16 v[188:189], v21 offset:3840
    v_mfma_f32_16x16x32_bf16 v[196:199], v[88:91], v[156:159], v[196:199]
    ds_read_b64_tr_b16 v[190:191], v21 offset:3872
    v_mfma_f32_16x16x32_bf16 v[196:199], v[92:95], v[152:155], v[196:199]
    ds_read_b64_tr_b16 a[24:25], v22 offset:1568
    v_mfma_f32_16x16x32_bf16 v[196:199], v[96:99], v[148:151], v[196:199]
    ds_read_b64_tr_b16 a[26:27], v22 offset:1536
    v_mfma_f32_16x16x32_bf16 v[196:199], v[100:103], v[144:147], v[196:199]
    ds_read_b64_tr_b16 a[88:89], v23 offset:1536
    v_mfma_f32_16x16x32_bf16 v[196:199], v[104:107], v[140:143], v[196:199]
    ds_read_b64_tr_b16 a[90:91], v23 offset:1568
    v_mfma_f32_16x16x32_bf16 v[196:199], v[108:111], v[136:139], v[196:199]
    ds_read_b64_tr_b16 a[28:29], v22 offset:1824
    v_mfma_f32_16x16x32_bf16 v[196:199], v[112:115], v[132:135], v[196:199]
    ds_read_b64_tr_b16 a[30:31], v22 offset:1792
    v_mfma_f32_16x16x32_bf16 v[196:199], v[116:119], v[128:131], v[196:199]
    ds_read_b64_tr_b16 a[92:93], v23 offset:1792
    s_waitcnt lgkmcnt(15)
    v_mfma_f32_16x16x32_bf16 v[200:203], v[64:67], v[184:187], 0
    ds_read_b64_tr_b16 a[94:95], v23 offset:1824
    v_mfma_f32_16x16x32_bf16 v[200:203], v[68:71], v[180:183], v[200:203]
    ds_read_b64_tr_b16 a[32:33], v22 offset:2080
    v_mfma_f32_16x16x32_bf16 v[200:203], v[72:75], v[176:179], v[200:203]
    s_nop 0
    v_add_f32_dpp v198, v199, v198 wave_shr:1 row_mask:0xf bank_mask:0xf bound_ctrl:0
    v_mov_b32_dpp v199, v195 wave_shl:1 row_mask:0xf bank_mask:0xf
    v_mfma_f32_16x16x32_bf16 v[200:203], v[76:79], v[172:175], v[200:203]
    v_add_f32_dpp v197, v198, v197 wave_shr:1 row_mask:0xf bank_mask:0xf bound_ctrl:0
    v_mov_b32_dpp v198, v194 wave_shl:1 row_mask:0xf bank_mask:0xf
    v_mfma_f32_16x16x32_bf16 v[200:203], v[80:83], v[168:171], v[200:203]
    v_add_f32_dpp v229, v197, v196 wave_shr:1 row_mask:0xf bank_mask:0xf bound_ctrl:0
    v_mov_b32_dpp v197, v193 wave_shl:1 row_mask:0xf bank_mask:0xf
    v_mfma_f32_16x16x32_bf16 v[200:203], v[84:87], v[164:167], v[200:203]
    ds_read_b64_tr_b16 a[34:35], v22 offset:2048
    v_mfma_f32_16x16x32_bf16 v[200:203], v[88:91], v[160:163], v[200:203]
    ds_read_b64_tr_b16 a[96:97], v23 offset:2048
    v_mfma_f32_16x16x32_bf16 v[200:203], v[92:95], v[156:159], v[200:203]
    ds_read_b64_tr_b16 a[98:99], v23 offset:2080
    v_mfma_f32_16x16x32_bf16 v[200:203], v[96:99], v[152:155], v[200:203]
    s_mov_b32 exec_lo, 0
    s_mov_b32 exec_hi, 0x1000001
    v_cvt_pk_bf16_f32 v57, v42, v43
    s_mov_b64 exec, -1
    v_mfma_f32_16x16x32_bf16 v[200:203], v[100:103], v[148:151], v[200:203]
    v_and_b32 v43, 0xffff0000, v59
    v_lshlrev_b32 v42, 16, v59
    v_mfma_f32_16x16x32_bf16 v[200:203], v[104:107], v[144:147], v[200:203]
    v_add_f32 v43, s30, v43
    ds_read_b64_tr_b16 a[36:37], v22 offset:2336
    v_mfma_f32_16x16x32_bf16 v[200:203], v[108:111], v[140:143], v[200:203]
    s_mov_b32 exec_lo, 0
    s_mov_b32 exec_hi, 0x10000010
    v_cvt_pk_bf16_f32 v59, v42, v43
    s_mov_b64 exec, -1
    v_mfma_f32_16x16x32_bf16 v[200:203], v[112:115], v[136:139], v[200:203]
    ds_read_b64_tr_b16 a[38:39], v22 offset:2304
    v_mfma_f32_16x16x32_bf16 v[200:203], v[116:119], v[132:135], v[200:203]
    ds_read_b64_tr_b16 a[100:101], v23 offset:2304
    v_mfma_f32_16x16x32_bf16 v[200:203], v[120:123], v[128:131], v[200:203]
    ds_read_b64_tr_b16 a[102:103], v23 offset:2336
    s_waitcnt lgkmcnt(15)
    v_mfma_f32_16x16x32_bf16 v[204:207], v[64:67], v[188:191], 0
    ds_read_b64_tr_b16 a[40:41], v22 offset:2592
    v_mfma_f32_16x16x32_bf16 v[204:207], v[68:71], v[184:187], v[204:207]
    ds_read_b64_tr_b16 a[42:43], v22 offset:2560
    v_mfma_f32_16x16x32_bf16 v[204:207], v[72:75], v[180:183], v[204:207]
    s_nop 0
    v_add_f32_dpp v202, v203, v202 wave_shr:1 row_mask:0xf bank_mask:0xf bound_ctrl:0
    v_mov_b32_dpp v203, v199 wave_shl:1 row_mask:0xf bank_mask:0xf
    v_mfma_f32_16x16x32_bf16 v[204:207], v[76:79], v[176:179], v[204:207]
    v_add_f32_dpp v201, v202, v201 wave_shr:1 row_mask:0xf bank_mask:0xf bound_ctrl:0
    v_mov_b32_dpp v202, v198 wave_shl:1 row_mask:0xf bank_mask:0xf
    v_mfma_f32_16x16x32_bf16 v[204:207], v[80:83], v[172:175], v[204:207]
    v_add_f32_dpp v230, v201, v200 wave_shr:1 row_mask:0xf bank_mask:0xf bound_ctrl:0
    v_mov_b32_dpp v201, v197 wave_shl:1 row_mask:0xf bank_mask:0xf
    v_mfma_f32_16x16x32_bf16 v[204:207], v[84:87], v[168:171], v[204:207]
    ds_read_b64_tr_b16 a[104:105], v23 offset:2560
    v_mfma_f32_16x16x32_bf16 v[204:207], v[88:91], v[164:167], v[204:207]
    ds_read_b64_tr_b16 a[106:107], v23 offset:2592
    v_mfma_f32_16x16x32_bf16 v[204:207], v[92:95], v[160:163], v[204:207]
    ds_write_b16 v29, v216 offset:0
    v_mfma_f32_16x16x32_bf16 v[204:207], v[96:99], v[156:159], v[204:207]
    ds_write_b16_d16_hi v29, v216 offset:128
    v_mfma_f32_16x16x32_bf16 v[204:207], v[100:103], v[152:155], v[204:207]
    v_mov_b32_dpp v240, v218 row_shr:8 row_mask:0x1 bank_mask:0x4
    s_nop 1
    v_mov_b32_dpp v240, v219 row_shr:12 row_mask:0x1 bank_mask:0x8
    v_mfma_f32_16x16x32_bf16 v[204:207], v[104:107], v[148:151], v[204:207]
    v_cvt_pk_bf16_f32 v218, v218, v219
    ds_read_b64_tr_b16 a[44:45], v22 offset:2848
    v_mfma_f32_16x16x32_bf16 v[204:207], v[108:111], v[144:147], v[204:207]
    ds_write_b16 v29, v218 offset:256
    v_mfma_f32_16x16x32_bf16 v[204:207], v[112:115], v[140:143], v[204:207]
    ds_write_b16_d16_hi v29, v218 offset:384
    v_mfma_f32_16x16x32_bf16 v[204:207], v[116:119], v[136:139], v[204:207]
    v_mov_b32 v241, v220
    s_nop 1
    v_mov_b32_dpp v241, v221 row_shr:4 row_mask:0x1 bank_mask:0x2
    v_mfma_f32_16x16x32_bf16 v[204:207], v[120:123], v[132:135], v[204:207]
    v_cvt_pk_bf16_f32 v220, v220, v221
    ds_read_b64_tr_b16 a[46:47], v22 offset:2816
    v_mfma_f32_16x16x32_bf16 v[204:207], v[124:127], v[128:131], v[204:207]
    ds_read_b64_tr_b16 a[108:109], v23 offset:2816
    v_mfma_f32_16x16x32_bf16 v[208:211], v[56:59], a[68:71], 0
    ds_write_b16 v29, v220 offset:512
    v_mfma_f32_16x16x32_bf16 v[208:211], a[4:7], a[64:67], v[208:211]
    ds_read_b64_tr_b16 a[110:111], v23 offset:2848
    v_mfma_f32_16x16x32_bf16 v[212:215], v[56:59], a[76:79], 0
    s_nop 1
    v_add_f32_dpp v206, v207, v206 wave_shr:1 row_mask:0xf bank_mask:0xf bound_ctrl:0
    v_mov_b32_dpp v207, v203 wave_shl:1 row_mask:0xf bank_mask:0xf
    v_mfma_f32_16x16x32_bf16 v[212:215], a[4:7], a[72:75], v[212:215]
    v_add_f32_dpp v205, v206, v205 wave_shr:1 row_mask:0xf bank_mask:0xf bound_ctrl:0
    v_mov_b32_dpp v206, v202 wave_shl:1 row_mask:0xf bank_mask:0xf
    v_mfma_f32_16x16x32_bf16 v[212:215], a[8:11], a[68:71], v[212:215]
    v_add_f32_dpp v231, v205, v204 wave_shr:1 row_mask:0xf bank_mask:0xf bound_ctrl:0
    v_mov_b32_dpp v205, v201 wave_shl:1 row_mask:0xf bank_mask:0xf
    v_mfma_f32_16x16x32_bf16 v[212:215], a[12:15], a[64:67], v[212:215]
    ds_read_b64_tr_b16 a[48:49], v22 offset:3104
    v_mfma_f32_16x16x32_bf16 v[192:195], v[56:59], a[84:87], 0
    s_mov_b32 exec_lo, 0
    s_mov_b32 exec_hi, 0xffff0000
    ds_write_b128 v25, v[204:207]
    s_mov_b64 exec, -1
    v_mfma_f32_16x16x32_bf16 v[192:195], a[4:7], a[80:83], v[192:195]
    ds_write_b16_d16_hi v29, v220 offset:640
    v_mfma_f32_16x16x32_bf16 v[192:195], a[8:11], a[76:79], v[192:195]
    v_mov_b32_dpp v241, v222 row_shr:8 row_mask:0x1 bank_mask:0x4
    s_nop 1
    v_mov_b32_dpp v241, v223 row_shr:12 row_mask:0x1 bank_mask:0x8
    v_mfma_f32_16x16x32_bf16 v[192:195], a[12:15], a[72:75], v[192:195]
    v_cvt_pk_bf16_f32 v222, v222, v223
    ds_write_b16 v29, v222 offset:768
    ds_write_b16_d16_hi v29, v222 offset:896
    v_mov_b32 v242, v224
    s_nop 1
    v_mov_b32_dpp v242, v225 row_shr:4 row_mask:0x1 bank_mask:0x2
    v_cvt_pk_bf16_f32 v224, v224, v225
    ds_write_b16 v29, v224 offset:1024
    ds_write_b16_d16_hi v29, v224 offset:1152
    v_mov_b32_dpp v242, v226 row_shr:8 row_mask:0x1 bank_mask:0x4
    s_nop 1
    v_mov_b32_dpp v242, v227 row_shr:12 row_mask:0x1 bank_mask:0x8
    v_cvt_pk_bf16_f32 v226, v226, v227
    ds_write_b16 v29, v226 offset:1280
    ds_write_b16_d16_hi v29, v226 offset:1408
    v_mov_b32 v243, v228
    s_nop 1
    v_mov_b32_dpp v243, v229 row_shr:4 row_mask:0x1 bank_mask:0x2
    v_cvt_pk_bf16_f32 v228, v228, v229
    ds_write_b16 v29, v228 offset:1536
    ds_write_b16_d16_hi v29, v228 offset:1664
    v_mov_b32_dpp v243, v230 row_shr:8 row_mask:0x1 bank_mask:0x4
    s_nop 1
    v_mov_b32_dpp v243, v231 row_shr:12 row_mask:0x1 bank_mask:0x8
    v_cvt_pk_bf16_f32 v230, v230, v231
    ds_write_b16 v29, v230 offset:1792
    ds_write_b16_d16_hi v29, v230 offset:1920
    v_mfma_f32_16x16x32_bf16 v[192:195], a[16:19], a[68:71], v[192:195]
    v_add_f32_dpp v210, v211, v210 wave_shr:1 row_mask:0xf bank_mask:0xf bound_ctrl:0
    s_nop 1
    v_add_f32_dpp v209, v210, v209 wave_shr:1 row_mask:0xf bank_mask:0xf bound_ctrl:0
    s_nop 1
    v_add_f32_dpp v232, v209, v208 wave_shr:1 row_mask:0xf bank_mask:0xf bound_ctrl:0
    v_mfma_f32_16x16x32_bf16 v[192:195], a[20:23], a[64:67], v[192:195]
    s_waitcnt lgkmcnt(11)
    s_barrier
    v_mfma_f32_16x16x32_bf16 v[196:199], v[56:59], a[92:95], 0
    ds_read2_b32 v[246:247], v27 offset0:1 offset1:33
    v_add_f32_dpp v214, v215, v214 wave_shr:1 row_mask:0xf bank_mask:0xf bound_ctrl:0
    v_mfma_f32_16x16x32_bf16 v[196:199], a[4:7], a[88:91], v[196:199]
    ds_read2_b32 v[248:249], v27 offset0:65 offset1:97
    v_mov_b32_dpp v215, v211 wave_shl:1 row_mask:0xf bank_mask:0xf
    v_mfma_f32_16x16x32_bf16 v[196:199], a[8:11], a[84:87], v[196:199]
    v_add_f32_dpp v213, v214, v213 wave_shr:1 row_mask:0xf bank_mask:0xf bound_ctrl:0
    v_mov_b32_dpp v214, v210 wave_shl:1 row_mask:0xf bank_mask:0xf
    s_nop 0
    v_add_f32_dpp v233, v213, v212 wave_shr:1 row_mask:0xf bank_mask:0xf bound_ctrl:0
    v_mov_b32_dpp v213, v209 wave_shl:1 row_mask:0xf bank_mask:0xf
    v_mfma_f32_16x16x32_bf16 v[196:199], a[12:15], a[80:83], v[196:199]
    v_add_f32_dpp v194, v195, v194 wave_shr:1 row_mask:0xf bank_mask:0xf bound_ctrl:0
    v_mov_b32_dpp v195, v215 wave_shl:1 row_mask:0xf bank_mask:0xf
    v_mfma_f32_16x16x32_bf16 v[196:199], a[16:19], a[76:79], v[196:199]
    v_add_f32_dpp v193, v194, v193 wave_shr:1 row_mask:0xf bank_mask:0xf bound_ctrl:0
    v_mov_b32_dpp v194, v214 wave_shl:1 row_mask:0xf bank_mask:0xf
    v_mfma_f32_16x16x32_bf16 v[196:199], a[20:23], a[72:75], v[196:199]
    v_add_f32_dpp v234, v193, v192 wave_shr:1 row_mask:0xf bank_mask:0xf bound_ctrl:0
    v_mov_b32_dpp v193, v213 wave_shl:1 row_mask:0xf bank_mask:0xf
    v_mfma_f32_16x16x32_bf16 v[196:199], a[24:27], a[68:71], v[196:199]
    ds_read_b64_tr_b16 a[50:51], v22 offset:3072
    v_mfma_f32_16x16x32_bf16 v[196:199], a[28:31], a[64:67], v[196:199]
    ds_read_b64_tr_b16 a[112:113], v23 offset:3072
    v_mfma_f32_16x16x32_bf16 v[200:203], v[56:59], a[100:103], 0
    ds_read_b64_tr_b16 a[114:115], v23 offset:3104
    s_waitcnt lgkmcnt(4)
    v_add_f32 v240, v240, v246
    v_mfma_f32_16x16x32_bf16 v[200:203], a[4:7], a[96:99], v[200:203]
    ds_read_b64_tr_b16 a[52:53], v22 offset:3360
    v_add_f32 v241, v241, v247
    v_mfma_f32_16x16x32_bf16 v[200:203], a[8:11], a[92:95], v[200:203]
    ds_read_b64_tr_b16 a[54:55], v22 offset:3328
    v_add_f32_dpp v198, v199, v198 wave_shr:1 row_mask:0xf bank_mask:0xf bound_ctrl:0
    v_mfma_f32_16x16x32_bf16 v[200:203], a[12:15], a[88:91], v[200:203]
    ds_read_b64_tr_b16 a[116:117], v23 offset:3328
    v_mov_b32_dpp v199, v195 wave_shl:1 row_mask:0xf bank_mask:0xf
    v_mfma_f32_16x16x32_bf16 v[200:203], a[16:19], a[84:87], v[200:203]
    ds_read_b64_tr_b16 a[118:119], v23 offset:3360
    v_add_f32_dpp v197, v198, v197 wave_shr:1 row_mask:0xf bank_mask:0xf bound_ctrl:0
    v_mfma_f32_16x16x32_bf16 v[200:203], a[20:23], a[80:83], v[200:203]
    v_mov_b32_dpp v198, v194 wave_shl:1 row_mask:0xf bank_mask:0xf
    v_add_f32_dpp v235, v197, v196 wave_shr:1 row_mask:0xf bank_mask:0xf bound_ctrl:0
    v_mfma_f32_16x16x32_bf16 v[200:203], a[24:27], a[76:79], v[200:203]
    v_mov_b32_dpp v197, v193 wave_shl:1 row_mask:0xf bank_mask:0xf
    v_cvt_pk_bf16_f32 v240, v240, v241
    v_mfma_f32_16x16x32_bf16 v[200:203], a[28:31], a[72:75], v[200:203]
    s_mov_b64 exec, 0x7777
    ds_write_b16 v252, v240 offset:0
    ds_write_b16_d16_hi v252, v240 offset:512
    s_mov_b64 exec, -1
    v_mfma_f32_16x16x32_bf16 v[200:203], a[32:35], a[68:71], v[200:203]
    ds_read_b128 v[216:219], v30 offset:0
    s_waitcnt lgkmcnt(10)
    v_add_f32 v242, v242, v248
    v_mfma_f32_16x16x32_bf16 v[200:203], a[36:39], a[64:67], v[200:203]
    v_add_f32 v243, v243, v249
    v_cvt_pk_bf16_f32 v242, v242, v243
    s_mov_b64 exec, 0x7777
    ds_write_b16 v252, v242 offset:1024
    ds_write_b16_d16_hi v252, v242 offset:1536
    s_mov_b64 exec, -1
    ds_read_b128 v[220:223], v30 offset:1024
    v_mfma_f32_16x16x32_bf16 v[204:207], v[56:59], a[108:111], 0
    ds_read_b64_tr_b16 a[56:57], v22 offset:3616
    v_mfma_f32_16x16x32_bf16 v[204:207], a[4:7], a[104:107], v[204:207]
    ds_read_b64_tr_b16 a[58:59], v22 offset:3584
    v_mfma_f32_16x16x32_bf16 v[204:207], a[8:11], a[100:103], v[204:207]
    ds_read_b64_tr_b16 a[120:121], v23 offset:3584
    v_add_f32_dpp v202, v203, v202 wave_shr:1 row_mask:0xf bank_mask:0xf bound_ctrl:0
    v_mfma_f32_16x16x32_bf16 v[204:207], a[12:15], a[96:99], v[204:207]
    ds_read_b64_tr_b16 a[122:123], v23 offset:3616
    v_mov_b32_dpp v203, v199 wave_shl:1 row_mask:0xf bank_mask:0xf
    v_mfma_f32_16x16x32_bf16 v[204:207], a[16:19], a[92:95], v[204:207]
    v_add_f32_dpp v201, v202, v201 wave_shr:1 row_mask:0xf bank_mask:0xf bound_ctrl:0
    v_mov_b32_dpp v202, v198 wave_shl:1 row_mask:0xf bank_mask:0xf
    v_mfma_f32_16x16x32_bf16 v[204:207], a[20:23], a[88:91], v[204:207]
    v_add_f32_dpp v236, v201, v200 wave_shr:1 row_mask:0xf bank_mask:0xf bound_ctrl:0
    v_mov_b32_dpp v201, v197 wave_shl:1 row_mask:0xf bank_mask:0xf
    v_mfma_f32_16x16x32_bf16 v[204:207], a[24:27], a[84:87], v[204:207]
    ds_read_b64_tr_b16 a[60:61], v22 offset:3872
    v_mfma_f32_16x16x32_bf16 v[204:207], a[28:31], a[80:83], v[204:207]
    ds_read_b64_tr_b16 a[62:63], v22 offset:3840
    v_mfma_f32_16x16x32_bf16 v[204:207], a[32:35], a[76:79], v[204:207]
    s_waitcnt lgkmcnt(9)
    buffer_store_dwordx4 v[216:219], v31, s[4:7], 0 offen sc1
    s_waitcnt lgkmcnt(6)
    buffer_store_dwordx4 v[220:223], v31, s[4:7], 0 offen offset:2048 sc1
    v_mfma_f32_16x16x32_bf16 v[204:207], a[36:39], a[72:75], v[204:207]
    ds_read_b64_tr_b16 a[124:125], v23 offset:3840
    v_mov_b32 v244, v232
    v_mfma_f32_16x16x32_bf16 v[204:207], a[40:43], a[68:71], v[204:207]
    ds_read_b64_tr_b16 a[126:127], v23 offset:3872
    v_mov_b32_dpp v244, v233 row_shr:4 row_mask:0x1 bank_mask:0x2
    v_mfma_f32_16x16x32_bf16 v[204:207], a[44:47], a[64:67], v[204:207]
    v_cvt_pk_bf16_f32 v232, v232, v233
    v_mfma_f32_16x16x32_bf16 v[208:211], v[56:59], a[116:119], 0
    ds_write_b16 v29, v232 offset:2048
    v_mfma_f32_16x16x32_bf16 v[208:211], a[4:7], a[112:115], v[208:211]
    ds_write_b16_d16_hi v29, v232 offset:2176
    v_mfma_f32_16x16x32_bf16 v[208:211], a[8:11], a[108:111], v[208:211]
    s_nop 1
    v_add_f32_dpp v206, v207, v206 wave_shr:1 row_mask:0xf bank_mask:0xf bound_ctrl:0
    v_mov_b32_dpp v207, v203 wave_shl:1 row_mask:0xf bank_mask:0xf
    v_mfma_f32_16x16x32_bf16 v[208:211], a[12:15], a[104:107], v[208:211]
    v_add_f32_dpp v205, v206, v205 wave_shr:1 row_mask:0xf bank_mask:0xf bound_ctrl:0
    v_mov_b32_dpp v206, v202 wave_shl:1 row_mask:0xf bank_mask:0xf
    v_mfma_f32_16x16x32_bf16 v[208:211], a[16:19], a[100:103], v[208:211]
    v_add_f32_dpp v237, v205, v204 wave_shr:1 row_mask:0xf bank_mask:0xf bound_ctrl:0
    v_mov_b32_dpp v205, v201 wave_shl:1 row_mask:0xf bank_mask:0xf
    v_mfma_f32_16x16x32_bf16 v[208:211], a[20:23], a[96:99], v[208:211]
    v_mov_b32_dpp v244, v234 row_shr:8 row_mask:0x1 bank_mask:0x4
    s_nop 1
    v_mov_b32_dpp v244, v235 row_shr:12 row_mask:0x1 bank_mask:0x8
    v_mfma_f32_16x16x32_bf16 v[208:211], a[24:27], a[92:95], v[208:211]
    v_cvt_pk_bf16_f32 v234, v234, v235
    v_mfma_f32_16x16x32_bf16 v[208:211], a[28:31], a[88:91], v[208:211]
    ds_write_b16 v29, v234 offset:2304
    v_mfma_f32_16x16x32_bf16 v[208:211], a[32:35], a[84:87], v[208:211]
    ds_write_b16_d16_hi v29, v234 offset:2432
    v_mfma_f32_16x16x32_bf16 v[208:211], a[36:39], a[80:83], v[208:211]
    v_mov_b32 v245, v236
    s_nop 1
    v_mov_b32_dpp v245, v237 row_shr:4 row_mask:0x1 bank_mask:0x2
    v_mfma_f32_16x16x32_bf16 v[208:211], a[40:43], a[76:79], v[208:211]
    v_cvt_pk_bf16_f32 v236, v236, v237
    v_mfma_f32_16x16x32_bf16 v[208:211], a[44:47], a[72:75], v[208:211]
    ds_write_b16 v29, v236 offset:2560
    v_mfma_f32_16x16x32_bf16 v[208:211], a[48:51], a[68:71], v[208:211]
    ds_write_b16_d16_hi v29, v236 offset:2688
    v_mfma_f32_16x16x32_bf16 v[208:211], a[52:55], a[64:67], v[208:211]
    s_waitcnt lgkmcnt(6)
    v_mfma_f32_16x16x32_bf16 v[212:215], v[56:59], a[124:127], 0
    v_mfma_f32_16x16x32_bf16 v[212:215], a[4:7], a[120:123], v[212:215]
    v_mfma_f32_16x16x32_bf16 v[212:215], a[8:11], a[116:119], v[212:215]
    s_nop 3
    v_add_f32_dpp v210, v211, v210 wave_shr:1 row_mask:0xf bank_mask:0xf bound_ctrl:0
    v_mov_b32_dpp v211, v207 wave_shl:1 row_mask:0xf bank_mask:0xf
    v_mfma_f32_16x16x32_bf16 v[212:215], a[12:15], a[112:115], v[212:215]
    v_add_f32_dpp v209, v210, v209 wave_shr:1 row_mask:0xf bank_mask:0xf bound_ctrl:0
    v_mov_b32_dpp v210, v206 wave_shl:1 row_mask:0xf bank_mask:0xf
    v_mfma_f32_16x16x32_bf16 v[212:215], a[16:19], a[108:111], v[212:215]
    v_add_f32_dpp v238, v209, v208 wave_shr:1 row_mask:0xf bank_mask:0xf bound_ctrl:0
    v_mov_b32_dpp v209, v205 wave_shl:1 row_mask:0xf bank_mask:0xf
    v_mfma_f32_16x16x32_bf16 v[212:215], a[20:23], a[104:107], v[212:215]
    v_mfma_f32_16x16x32_bf16 v[212:215], a[24:27], a[100:103], v[212:215]
    v_mfma_f32_16x16x32_bf16 v[212:215], a[28:31], a[96:99], v[212:215]
    v_mfma_f32_16x16x32_bf16 v[212:215], a[32:35], a[92:95], v[212:215]
    v_mfma_f32_16x16x32_bf16 v[212:215], a[36:39], a[88:91], v[212:215]
    v_mfma_f32_16x16x32_bf16 v[212:215], a[40:43], a[84:87], v[212:215]
    v_mfma_f32_16x16x32_bf16 v[212:215], a[44:47], a[80:83], v[212:215]
    v_mfma_f32_16x16x32_bf16 v[212:215], a[48:51], a[76:79], v[212:215]
    v_mfma_f32_16x16x32_bf16 v[212:215], a[52:55], a[72:75], v[212:215]
    v_mfma_f32_16x16x32_bf16 v[212:215], a[56:59], a[68:71], v[212:215]
    v_mfma_f32_16x16x32_bf16 v[212:215], a[60:63], a[64:67], v[212:215]
    s_nop 0
    s_nop 6
    v_add_f32_dpp v214, v215, v214 wave_shr:1 row_mask:0xf bank_mask:0xf bound_ctrl:0
    v_mov_b32_dpp v215, v211 wave_shl:1 row_mask:0xf bank_mask:0xf
    s_nop 0
    v_add_f32_dpp v213, v214, v213 wave_shr:1 row_mask:0xf bank_mask:0xf bound_ctrl:0
    v_mov_b32_dpp v214, v210 wave_shl:1 row_mask:0xf bank_mask:0xf
    s_nop 0
    v_add_f32_dpp v239, v213, v212 wave_shr:1 row_mask:0xf bank_mask:0xf bound_ctrl:0
    v_mov_b32_dpp v213, v209 wave_shl:1 row_mask:0xf bank_mask:0xf
    s_mov_b32 exec_lo, 0
    s_mov_b32 exec_hi, 0xff000000
    ds_write_b128 v26, v[212:215]
    s_mov_b64 exec, -1
    v_mov_b32_dpp v245, v238 row_shr:8 row_mask:0x1 bank_mask:0x4
    s_nop 1
    v_mov_b32_dpp v245, v239 row_shr:12 row_mask:0x1 bank_mask:0x8
    v_cvt_pk_bf16_f32 v238, v238, v239
    ds_write_b16 v29, v238 offset:2816
    ds_write_b16_d16_hi v29, v238 offset:2944
    s_waitcnt lgkmcnt(2)
    s_barrier
    ds_read2_b32 v[250:251], v28 offset0:1 offset1:65
    s_waitcnt vmcnt(0)
    s_mov_b64 exec, 1
    buffer_store_dword v34, v0, s[4:7], s95 offen sc1
    s_mov_b64 exec, -1
    s_waitcnt lgkmcnt(0)
    v_add_f32 v244, v244, v250
    v_add_f32 v245, v245, v251
    v_cvt_pk_bf16_f32 v244, v244, v245
    s_mov_b64 exec, 0x7777
    ds_write_b16 v252, v244 offset:2048
    ds_write_b16_d16_hi v252, v244 offset:2560
    s_mov_b64 exec, -1
    ds_read_b128 v[224:227], v30 offset:2048
    s_waitcnt lgkmcnt(0)
    buffer_store_dwordx4 v[224:227], v32, s[4:7], 0 offen sc1
    s_add_u32 s95, s89, 128
    s_mul_i32 s95, s95, 128
    s_lshl2_add_u32 s95, s84, s95
    s_add_u32 s95, s95, 10158096
    s_waitcnt vmcnt(0)
    s_mov_b64 exec, 1
    buffer_store_dword v34, v0, s[4:7], s95 offen sc1
    s_mov_b64 exec, -1
    s_cmp_lg_u32 s89, 31
    s_cbranch_scc1 L_Adone
    v_lshl_add_u32 v35, s84, 5, v0
    v_mul_u32_u24 v35, 64, v35
    v_add_u32 v35, 10059776, v35
    s_mov_b32 exec_hi, 0
    buffer_load_dword v248, v35, s[4:7], 0 offen sc1
    s_mov_b64 exec, -1
    s_mov_b32 exec_hi, 0
    s_waitcnt vmcnt(0)
    v_cmp_ne_u32 vcc, s91, v248
    s_mov_b32 s3, 0
    s_cbranch_vccz L_pk_Ae0
L_pl_Ae0:
    s_mov_b64 exec, vcc
    buffer_load_dword v248, v35, s[4:7], 0 offen sc1
    s_add_u32 s3, s3, 1
    s_cmp_ge_u32 s3, 0x40000
    s_cbranch_scc1 L_pk_Ae0
    s_waitcnt vmcnt(0)
    v_cmp_ne_u32 vcc, s91, v248
    s_nop 0
    s_cbranch_vccnz L_pl_Ae0
L_pk_Ae0:
    s_mov_b64 exec, -1
    s_mul_i32 s32, s84, 120
    s_add_u32 s32, s32, 0
    v_add_u32 v35, s32, v0
    v_mul_u32_u24 v35, 64, v35
    v_add_u32 v35, 10092544, v35
    s_mov_b32 exec_hi, 0xfffffff
    buffer_load_dword v18, v35, s[4:7], 0 offen sc1
    s_mov_b64 exec, -1
    s_mov_b32 exec_hi, 0xfffffff
    s_waitcnt vmcnt(0)
    v_cmp_ne_u32 vcc, s91, v18
    s_mov_b32 s3, 0
    s_cbranch_vccz L_pk_Ae1
L_pl_Ae1:
    s_mov_b64 exec, vcc
    buffer_load_dword v18, v35, s[4:7], 0 offen sc1
    s_add_u32 s3, s3, 1
    s_cmp_ge_u32 s3, 0x40000
    s_cbranch_scc1 L_pk_Ae1
    s_waitcnt vmcnt(0)
    v_cmp_ne_u32 vcc, s91, v18
    s_nop 0
    s_cbranch_vccnz L_pl_Ae1
L_pk_Ae1:
    s_mov_b64 exec, -1
    s_mul_i32 s32, s84, 120
    s_add_u32 s32, s32, 60
    v_add_u32 v35, s32, v0
    v_mul_u32_u24 v35, 64, v35
    v_add_u32 v35, 10092544, v35
    s_mov_b32 exec_hi, 0xfffffff
    buffer_load_dword v18, v35, s[4:7], 0 offen sc1
    s_mov_b64 exec, -1
    s_mov_b32 exec_hi, 0xfffffff
    s_waitcnt vmcnt(0)
    v_cmp_ne_u32 vcc, s91, v18
    s_mov_b32 s3, 0
    s_cbranch_vccz L_pk_Ae2
L_pl_Ae2:
    s_mov_b64 exec, vcc
    buffer_load_dword v18, v35, s[4:7], 0 offen sc1
    s_add_u32 s3, s3, 1
    s_cmp_ge_u32 s3, 0x40000
    s_cbranch_scc1 L_pk_Ae2
    s_waitcnt vmcnt(0)
    v_cmp_ne_u32 vcc, s91, v18
    s_nop 0
    s_cbranch_vccnz L_pl_Ae2
L_pk_Ae2:
    s_mov_b64 exec, -1
    v_lshl_add_u32 v35, s84, 5, v0
    v_mul_u32_u24 v35, 128, v35
    v_add_u32 v35, 10178304, v35
    s_mov_b64 exec, 0x3
    buffer_load_dwordx4 v[248:251], v35, s[4:7], 0 offen sc1
    s_mov_b64 exec, -1
    s_mov_b64 exec, 0x3
    s_waitcnt vmcnt(0)
    v_xor_b32 v248, s91, v248
    v_bitop3_b32 v248, v248, v249, v34 bitop3:0xf6
    v_bitop3_b32 v248, v248, v250, v34 bitop3:0xf6
    v_bitop3_b32 v248, v248, v251, v34 bitop3:0xf6
    v_cmp_ne_u32 vcc, 0, v248
    s_mov_b32 s3, 0
    s_cbranch_vccz L_pk_Ae3
L_pl_Ae3:
    s_mov_b64 exec, vcc
    buffer_load_dwordx4 v[248:251], v35, s[4:7], 0 offen sc1
    s_add_u32 s3, s3, 1
    s_cmp_ge_u32 s3, 0x40000
    s_cbranch_scc1 L_pk_Ae3
    s_waitcnt vmcnt(0)
    v_xor_b32 v248, s91, v248
    v_bitop3_b32 v248, v248, v249, v34 bitop3:0xf6
    v_bitop3_b32 v248, v248, v250, v34 bitop3:0xf6
    v_bitop3_b32 v248, v248, v251, v34 bitop3:0xf6
    v_cmp_ne_u32 vcc, 0, v248
    s_nop 0
    s_cbranch_vccnz L_pl_Ae3
L_pk_Ae3:
    s_mov_b64 exec, -1
    s_barrier
    s_mov_b32 s32, 10223616
    s_mov_b64 exec, 1
    buffer_store_dword v34, v0, s[4:7], s32 offen sc1
    s_mov_b64 exec, -1
L_Adone:
    s_endpgm
L_Aspare:
    s_lshl2_add_u32 s20, s85, s87
    s_add_u32 s20, s20, 2
    s_lshl_b32 s20, s20, 17
    s_lshl1_add_u32 s21, s85, s87
    s_add_u32 s21, s21, 32
    s_lshl_b32 s21, s21, 16
    v_lshrrev_b32 v42, 3, v0
    v_lshlrev_b32 v42, 12, v42
    v_and_b32 v43, 7, v0
    v_lshl_add_u32 v43, s84, 3, v43
    v_lshl_add_u32 v42, v43, 7, v42
    s_waitcnt vmcnt(0)
    v_readfirstlane_b32 s91, v49
    s_nop 0
    s_add_u32 s91, s91, 0x9e3779b9
    v_mov_b32 v34, s91
    s_add_u32 s32, s20, 0
    buffer_load_dword v64, v42, s[24:27], s32 offen
    s_add_u32 s32, s20, 32768
    buffer_load_dword v65, v42, s[24:27], s32 offen
    s_add_u32 s32, s20, 65536
    buffer_load_dword v66, v42, s[24:27], s32 offen
    s_add_u32 s32, s20, 98304
    buffer_load_dword v67, v42, s[24:27], s32 offen
    s_add_u32 s32, s21, 0
    buffer_load_dword v68, v42, s[24:27], s32 offen
    s_add_u32 s32, s21, 32768
    buffer_load_dword v69, v42, s[24:27], s32 offen
    s_add_u32 m0, s29, 127072
    s_nop 0
    buffer_load_dwordx4 v1, s[24:27], s31 offen  lds
    s_add_u32 m0, s29, 131296
    s_nop 0
    buffer_load_dwordx4 v1, s[24:27], s48 offen  lds
    s_add_u32 m0, s29, 135520
    s_nop 0
    buffer_load_dwordx4 v1, s[24:27], s49 offen  lds
    s_mov_b32 exec_hi, 0
    buffer_load_dword v248, v24, s[4:7], 0 offen sc1
    s_mov_b64 exec, -1
    s_mov_b32 exec_hi, 0
    s_waitcnt vmcnt(0)
    v_cmp_ne_u32 vcc, s91, v248
    s_mov_b32 s3, 0
    s_cbranch_vccz L_pk_Afs
L_pl_Afs:
    s_mov_b64 exec, vcc
    buffer_load_dword v248, v24, s[4:7], 0 offen sc1
    s_add_u32 s3, s3, 1
    s_cmp_ge_u32 s3, 0x40000
    s_cbranch_scc1 L_pk_Afs
    s_waitcnt vmcnt(0)
    v_cmp_ne_u32 vcc, s91, v248
    s_nop 0
    s_cbranch_vccnz L_pl_Afs
L_pk_Afs:
    s_mov_b64 exec, -1
    s_add_u32 m0, s29, 140160
    s_nop 0
    buffer_load_dwordx4 v1, s[4:7], s40 offen sc1 lds
    s_add_u32 m0, s29, 144768
    s_nop 0
    buffer_load_dwordx4 v1, s[4:7], s41 offen sc1 lds
    s_add_u32 m0, s29, 149376
    s_nop 0
    buffer_load_dwordx4 v1, s[4:7], s50 offen sc1 lds
    s_waitcnt vmcnt(0) lgkmcnt(0)
    s_branch L_Ajoin
L_end:
    s_endpgm
.section .rodata,"a"
.p2align 6
.amdhsa_kernel gated_mix__ssm_conv_h3__mixer_token_mlp__prompt_kernel
  .amdhsa_next_free_vgpr 512
  .amdhsa_next_free_sgpr 102
  .amdhsa_accum_offset 256
  .amdhsa_group_segment_fixed_size 0
  .amdhsa_kernarg_size 120
  .amdhsa_user_sgpr_count 2
  .amdhsa_user_sgpr_kernarg_segment_ptr 1
  .amdhsa_system_sgpr_workgroup_id_x 1
  .amdhsa_float_denorm_mode_32 3
.end_amdhsa_kernel
```
